```python
import torch

def _softmax(x, axis=-1):
    return torch.softmax(x, dim=axis)

def _gelu(x):
    return torch.nn.functional.gelu(x, approximate='tanh')

def _silu(x):
    return torch.nn.functional.silu(x)

def _sigmoid(x):
    return torch.sigmoid(x)

def _layernorm(x, axis=-1, eps=1e-05):
    m = x.mean(dim=axis, keepdim=True)
    v = x.var(dim=axis, keepdim=True, unbiased=False)
    return (x - m) / torch.sqrt(v + eps)

def _scatter_add(tgt, idx, src, axis=0):
    return tgt.clone().index_add_(axis, idx, src)

def _segment_sum(src, seg, n):
    out = torch.zeros((n,) + src.shape[1:], dtype=src.dtype)
    return out.index_add_(0, seg, src)

def _pad(x, pw):
    flat = tuple((v for pair in reversed(pw) for v in pair))
    return torch.nn.functional.pad(x, flat)
kernel_name = 'adaLN_cond__gqa_block_cached__mixer_gmlp__prompt'

def setup_inputs():

    _w = lambda a: (lambda t: t.to(torch.bfloat16) if t.is_floating_point() else t)(torch.as_tensor(a))

    def _A_setup():
        B, Sq, D = (1, 2048, 576)
        Hq, Hkv, Sk, Dh = (32, 16, 2048, 128)
        assert Hq % Hkv == 0, (Hq, Hkv)
        return {'x': _w((lambda *s: torch.randn(*s, dtype=torch.bfloat16) * 0.05)(B, Sq, D)), 'k_cache': _w((lambda *s: torch.randn(*s, dtype=torch.bfloat16) * 3.2)(B, Hkv, Sk, Dh)), 'v_cache': _w((lambda *s: torch.randn(*s, dtype=torch.bfloat16) * 0.4)(B, Hkv, Sk, Dh)), 'wq': _w((lambda *s: torch.randn(*s, dtype=torch.bfloat16) * 3.2)(D, Hq * Dh) * D ** (-0.5)), 'wo': _w((lambda *s: torch.randn(*s, dtype=torch.bfloat16) * 0.4)(Hq * Dh, D) * (Hq * Dh) ** (-0.5))}
    _A_in = _A_setup()

    def _B_setup():
        B, S, D, F = (1, 2048, 576, 4608)
        Fh = F // 2
        return {'x': _w((lambda *s: torch.randn(*s, dtype=torch.bfloat16) * 0.05)(B, S, D)), 'w_in': _w((lambda *s: torch.randn(*s, dtype=torch.bfloat16) * 1.6)(D, 2 * Fh)), 'w_sp': _w(0.01 * (lambda *s: torch.randn(*s, dtype=torch.bfloat16) * 1.6)(S, S)), 'b_sp': _w(1.0 + 0.01 * (lambda *s: torch.randn(*s, dtype=torch.bfloat16) * 0.05)(S)), 'w_out': _w((lambda *s: torch.randn(*s, dtype=torch.bfloat16) * 0.05)(Fh, D))}
    _B_in = _B_setup()
    return {'A_x': _A_in['x'], 'A_k_cache': _A_in['k_cache'], 'A_v_cache': _A_in['v_cache'], 'A_wq': _A_in['wq'], 'A_wo': _A_in['wo'], 'B_x': _B_in['x'], 'B_w_in': _B_in['w_in'], 'B_w_sp': _B_in['w_sp'], 'B_b_sp': _B_in['b_sp'], 'B_w_out': _B_in['w_out'], 'c': _w((lambda *s: torch.randn(*s, dtype=torch.bfloat16) * 0.2)(1, 576) * 8.0), 'w_mod': _w((lambda *s: torch.randn(*s, dtype=torch.bfloat16) * 0.2)(576, 6 * 576) * 576 ** (-0.5) * 8.0)}

def reference(A_x, A_k_cache, A_v_cache, A_wq, A_wo, B_x, B_w_in, B_w_sp, B_b_sp, B_w_out, c, w_mod):

    def _A_ref(x, k_cache, v_cache, wq, wo):
        B, Sq, D = x.shape
        Hq, Dh = (32, 128)
        Hkv = k_cache.shape[1]
        rep = Hq // Hkv
        q = (lambda x, *d: x.permute(*d))((x @ wq).reshape(B, Sq, Hq, Dh), 0, 2, 1, 3)
        k = (lambda x, n, axis: torch.repeat_interleave(x, n, dim=axis))(k_cache, rep, axis=1)
        v = (lambda x, n, axis: torch.repeat_interleave(x, n, dim=axis))(v_cache, rep, axis=1)
        scores = torch.einsum('bhqd,bhkd->bhqk', q, k) * Dh ** (-0.5)
        p = _softmax(scores, axis=-1)
        o = torch.einsum('bhqk,bhkd->bhqd', p, v)
        return (lambda x, *d: x.permute(*d))(o, 0, 2, 1, 3).reshape(B, Sq, Hq * Dh) @ wo

    def _B_ref(x, w_in, w_sp, b_sp, w_out):
        B, S, D = x.shape
        F = w_in.shape[-1]
        Fh = F // 2
        z = _gelu(torch.einsum('bsd,df->bsf', x, w_in))
        z1 = z[..., :Fh].clone()
        z2 = _layernorm(z[..., Fh:], axis=-1)
        g = torch.einsum('ts,bsf->btf', w_sp, z2) + b_sp[None, :, None]
        return torch.einsum('bsf,fd->bsd', z1 * g, w_out)
    x = A_x
    mod = (_silu(c) @ w_mod).reshape(c.shape[0], 6, 1, -1)
    sa, ca, ga, sb, cb, gb = (mod[:, 0].clone(), mod[:, 1].clone(), mod[:, 2].clone(), mod[:, 3].clone(), mod[:, 4].clone(), mod[:, 5].clone())
    h = _layernorm(x, axis=-1) * (1 + ca) + sa
    x = x + ga * _A_ref(h, A_k_cache, A_v_cache, A_wq, A_wo)
    h = _layernorm(x, axis=-1) * (1 + cb) + sb
    x = x + gb * _B_ref(h, B_w_in, B_w_sp, B_b_sp, B_w_out)
    return x
```

```asm
; @launch kernel=mod_kernel grid=(764,1,1) block=(256,1,1) lds=36864
; @launch kernel=attn_kernel grid=(256,1,1) block=(512,1,1) lds=147456
; @launch kernel=g2_kernel grid=(256,1,1) block=(512,1,1) lds=73728
; @launch kernel=ln2_kernel grid=(128,1,1) block=(256,1,1) lds=1024
; @launch kernel=g3_kernel grid=(256,1,1) block=(512,1,1) lds=147456
; @launch kernel=lnz_kernel grid=(256,1,1) block=(768,1,1) lds=41472
; @launch kernel=g4_kernel grid=(256,1,1) block=(512,1,1) lds=73728
; @launch kernel=g5_kernel grid=(256,1,1) block=(512,1,1) lds=163840
.amdgcn_target "amdgcn-amd-amdhsa--gfx950"
.text
.globl mod_kernel
.type mod_kernel,@function
.p2align 8
mod_kernel:
    s_cmp_ge_u32 s2, 364
    s_cbranch_scc1 mod_kernel_prep2
    s_cmp_ge_u32 s2, 108
    s_cbranch_scc1 mod_kernel_ln3
    s_load_dwordx2 s[4:5], s[0:1], 80
    s_load_dwordx2 s[6:7], s[0:1], 88
    s_load_dwordx2 s[8:9], s[0:1], 112
    v_lshrrev_b32 v1, 6, v0
    v_and_b32 v2, 63, v0
    v_readfirstlane_b32 s3, v1
    v_lshrrev_b32 v10, 4, v2
    v_and_b32 v11, 15, v2
    v_mul_u32_u24 v3, 6912, v10
    v_lshl_add_u32 v3, v11, 2, v3
    s_mul_i32 s24, s3, 144*6912
    s_lshl_b32 s25, s2, 6
    s_add_u32 s24, s24, s25
    v_lshlrev_b32 v4, 1, v0
    s_waitcnt lgkmcnt(0)
    s_mov_b32 s12, s4
    s_mov_b32 s13, s5
    s_mov_b32 s14, 0x480
    s_mov_b32 s15, 0x00020000
    s_mov_b32 s16, s6
    s_mov_b32 s17, s7
    s_mov_b32 s18, 0x3cc000
    s_mov_b32 s19, 0x00020000
    s_add_u32 s20, s8, 0x0
    s_addc_u32 s21, s9, 0
    s_mov_b32 s22, 0x8000
    s_mov_b32 s23, 0x00020000
    buffer_load_ushort v5, v4, s[12:15], 0 offen offset:0
    buffer_load_ushort v6, v4, s[12:15], 0 offen offset:512
    buffer_load_ushort v7, v4, s[12:15], 0 offen offset:1024
    buffer_load_dword v16, v3, s[16:19], s24 offen
    s_add_u32 s24, s24, 4*6912
    buffer_load_dword v17, v3, s[16:19], s24 offen
    s_add_u32 s24, s24, 4*6912
    buffer_load_dword v18, v3, s[16:19], s24 offen
    s_add_u32 s24, s24, 4*6912
    buffer_load_dword v19, v3, s[16:19], s24 offen
    s_add_u32 s24, s24, 4*6912
    buffer_load_dword v20, v3, s[16:19], s24 offen
    s_add_u32 s24, s24, 4*6912
    buffer_load_dword v21, v3, s[16:19], s24 offen
    s_add_u32 s24, s24, 4*6912
    buffer_load_dword v22, v3, s[16:19], s24 offen
    s_add_u32 s24, s24, 4*6912
    buffer_load_dword v23, v3, s[16:19], s24 offen
    s_add_u32 s24, s24, 4*6912
    buffer_load_dword v24, v3, s[16:19], s24 offen
    s_add_u32 s24, s24, 4*6912
    buffer_load_dword v25, v3, s[16:19], s24 offen
    s_add_u32 s24, s24, 4*6912
    buffer_load_dword v26, v3, s[16:19], s24 offen
    s_add_u32 s24, s24, 4*6912
    buffer_load_dword v27, v3, s[16:19], s24 offen
    s_add_u32 s24, s24, 4*6912
    buffer_load_dword v28, v3, s[16:19], s24 offen
    s_add_u32 s24, s24, 4*6912
    buffer_load_dword v29, v3, s[16:19], s24 offen
    s_add_u32 s24, s24, 4*6912
    buffer_load_dword v30, v3, s[16:19], s24 offen
    s_add_u32 s24, s24, 4*6912
    buffer_load_dword v31, v3, s[16:19], s24 offen
    s_add_u32 s24, s24, 4*6912
    buffer_load_dword v32, v3, s[16:19], s24 offen
    s_add_u32 s24, s24, 4*6912
    buffer_load_dword v33, v3, s[16:19], s24 offen
    s_add_u32 s24, s24, 4*6912
    buffer_load_dword v34, v3, s[16:19], s24 offen
    s_add_u32 s24, s24, 4*6912
    buffer_load_dword v35, v3, s[16:19], s24 offen
    s_add_u32 s24, s24, 4*6912
    buffer_load_dword v36, v3, s[16:19], s24 offen
    s_add_u32 s24, s24, 4*6912
    buffer_load_dword v37, v3, s[16:19], s24 offen
    s_add_u32 s24, s24, 4*6912
    buffer_load_dword v38, v3, s[16:19], s24 offen
    s_add_u32 s24, s24, 4*6912
    buffer_load_dword v39, v3, s[16:19], s24 offen
    s_add_u32 s24, s24, 4*6912
    buffer_load_dword v40, v3, s[16:19], s24 offen
    s_add_u32 s24, s24, 4*6912
    buffer_load_dword v41, v3, s[16:19], s24 offen
    s_add_u32 s24, s24, 4*6912
    buffer_load_dword v42, v3, s[16:19], s24 offen
    s_add_u32 s24, s24, 4*6912
    buffer_load_dword v43, v3, s[16:19], s24 offen
    s_add_u32 s24, s24, 4*6912
    buffer_load_dword v44, v3, s[16:19], s24 offen
    s_add_u32 s24, s24, 4*6912
    buffer_load_dword v45, v3, s[16:19], s24 offen
    s_add_u32 s24, s24, 4*6912
    buffer_load_dword v46, v3, s[16:19], s24 offen
    s_add_u32 s24, s24, 4*6912
    buffer_load_dword v47, v3, s[16:19], s24 offen
    s_add_u32 s24, s24, 4*6912
    buffer_load_dword v48, v3, s[16:19], s24 offen
    s_add_u32 s24, s24, 4*6912
    buffer_load_dword v49, v3, s[16:19], s24 offen
    s_add_u32 s24, s24, 4*6912
    buffer_load_dword v50, v3, s[16:19], s24 offen
    s_add_u32 s24, s24, 4*6912
    buffer_load_dword v51, v3, s[16:19], s24 offen
    s_waitcnt vmcnt(36)
    v_lshlrev_b32 v9, 2, v0
    v_lshlrev_b32 v5, 16, v5
    v_mul_f32 v12, 0xbfb8aa3b, v5
    v_exp_f32 v12, v12
    s_nop 0
    v_add_f32 v12, 1.0, v12
    v_rcp_f32 v12, v12
    s_nop 0
    v_mul_f32 v12, v5, v12
    v_cvt_pk_bf16_f32 v12, v12, v12
    v_and_b32 v12, 0xffff0000, v12
    ds_write_b32 v9, v12 offset:0
    v_lshlrev_b32 v6, 16, v6
    v_mul_f32 v12, 0xbfb8aa3b, v6
    v_exp_f32 v12, v12
    s_nop 0
    v_add_f32 v12, 1.0, v12
    v_rcp_f32 v12, v12
    s_nop 0
    v_mul_f32 v12, v6, v12
    v_cvt_pk_bf16_f32 v12, v12, v12
    v_and_b32 v12, 0xffff0000, v12
    ds_write_b32 v9, v12 offset:1024
    v_lshlrev_b32 v7, 16, v7
    v_mul_f32 v12, 0xbfb8aa3b, v7
    v_exp_f32 v12, v12
    s_nop 0
    v_add_f32 v12, 1.0, v12
    v_rcp_f32 v12, v12
    s_nop 0
    v_mul_f32 v12, v7, v12
    v_cvt_pk_bf16_f32 v12, v12, v12
    v_and_b32 v12, 0xffff0000, v12
    ds_write_b32 v9, v12 offset:2048
    s_waitcnt lgkmcnt(0)
    s_barrier
    s_mul_i32 s26, s3, 576
    v_lshl_add_u32 v12, v10, 2, s26
    ds_read_b32 v56, v12 offset:0
    ds_read_b32 v57, v12 offset:16
    ds_read_b32 v58, v12 offset:32
    ds_read_b32 v59, v12 offset:48
    ds_read_b32 v60, v12 offset:64
    ds_read_b32 v61, v12 offset:80
    ds_read_b32 v62, v12 offset:96
    ds_read_b32 v63, v12 offset:112
    ds_read_b32 v64, v12 offset:128
    ds_read_b32 v65, v12 offset:144
    ds_read_b32 v66, v12 offset:160
    ds_read_b32 v67, v12 offset:176
    s_waitcnt lgkmcnt(0)
    ds_read_b32 v68, v12 offset:192
    ds_read_b32 v69, v12 offset:208
    ds_read_b32 v70, v12 offset:224
    ds_read_b32 v71, v12 offset:240
    ds_read_b32 v72, v12 offset:256
    ds_read_b32 v73, v12 offset:272
    ds_read_b32 v74, v12 offset:288
    ds_read_b32 v75, v12 offset:304
    ds_read_b32 v76, v12 offset:320
    ds_read_b32 v77, v12 offset:336
    ds_read_b32 v78, v12 offset:352
    ds_read_b32 v79, v12 offset:368
    s_waitcnt lgkmcnt(0)
    ds_read_b32 v80, v12 offset:384
    ds_read_b32 v81, v12 offset:400
    ds_read_b32 v82, v12 offset:416
    ds_read_b32 v83, v12 offset:432
    ds_read_b32 v84, v12 offset:448
    ds_read_b32 v85, v12 offset:464
    ds_read_b32 v86, v12 offset:480
    ds_read_b32 v87, v12 offset:496
    ds_read_b32 v88, v12 offset:512
    ds_read_b32 v89, v12 offset:528
    ds_read_b32 v90, v12 offset:544
    ds_read_b32 v91, v12 offset:560
    s_waitcnt lgkmcnt(0)
    v_mov_b32 v12, 0
    v_mov_b32 v13, 0
    s_waitcnt vmcnt(0)
    v_lshlrev_b32 v14, 16, v16
    v_and_b32 v15, 0xffff0000, v16
    v_fmac_f32 v12, v14, v56
    v_fmac_f32 v13, v15, v56
    v_lshlrev_b32 v14, 16, v17
    v_and_b32 v15, 0xffff0000, v17
    v_fmac_f32 v12, v14, v57
    v_fmac_f32 v13, v15, v57
    v_lshlrev_b32 v14, 16, v18
    v_and_b32 v15, 0xffff0000, v18
    v_fmac_f32 v12, v14, v58
    v_fmac_f32 v13, v15, v58
    v_lshlrev_b32 v14, 16, v19
    v_and_b32 v15, 0xffff0000, v19
    v_fmac_f32 v12, v14, v59
    v_fmac_f32 v13, v15, v59
    v_lshlrev_b32 v14, 16, v20
    v_and_b32 v15, 0xffff0000, v20
    v_fmac_f32 v12, v14, v60
    v_fmac_f32 v13, v15, v60
    v_lshlrev_b32 v14, 16, v21
    v_and_b32 v15, 0xffff0000, v21
    v_fmac_f32 v12, v14, v61
    v_fmac_f32 v13, v15, v61
    v_lshlrev_b32 v14, 16, v22
    v_and_b32 v15, 0xffff0000, v22
    v_fmac_f32 v12, v14, v62
    v_fmac_f32 v13, v15, v62
    v_lshlrev_b32 v14, 16, v23
    v_and_b32 v15, 0xffff0000, v23
    v_fmac_f32 v12, v14, v63
    v_fmac_f32 v13, v15, v63
    v_lshlrev_b32 v14, 16, v24
    v_and_b32 v15, 0xffff0000, v24
    v_fmac_f32 v12, v14, v64
    v_fmac_f32 v13, v15, v64
    v_lshlrev_b32 v14, 16, v25
    v_and_b32 v15, 0xffff0000, v25
    v_fmac_f32 v12, v14, v65
    v_fmac_f32 v13, v15, v65
    v_lshlrev_b32 v14, 16, v26
    v_and_b32 v15, 0xffff0000, v26
    v_fmac_f32 v12, v14, v66
    v_fmac_f32 v13, v15, v66
    v_lshlrev_b32 v14, 16, v27
    v_and_b32 v15, 0xffff0000, v27
    v_fmac_f32 v12, v14, v67
    v_fmac_f32 v13, v15, v67
    v_lshlrev_b32 v14, 16, v28
    v_and_b32 v15, 0xffff0000, v28
    v_fmac_f32 v12, v14, v68
    v_fmac_f32 v13, v15, v68
    v_lshlrev_b32 v14, 16, v29
    v_and_b32 v15, 0xffff0000, v29
    v_fmac_f32 v12, v14, v69
    v_fmac_f32 v13, v15, v69
    v_lshlrev_b32 v14, 16, v30
    v_and_b32 v15, 0xffff0000, v30
    v_fmac_f32 v12, v14, v70
    v_fmac_f32 v13, v15, v70
    v_lshlrev_b32 v14, 16, v31
    v_and_b32 v15, 0xffff0000, v31
    v_fmac_f32 v12, v14, v71
    v_fmac_f32 v13, v15, v71
    v_lshlrev_b32 v14, 16, v32
    v_and_b32 v15, 0xffff0000, v32
    v_fmac_f32 v12, v14, v72
    v_fmac_f32 v13, v15, v72
    v_lshlrev_b32 v14, 16, v33
    v_and_b32 v15, 0xffff0000, v33
    v_fmac_f32 v12, v14, v73
    v_fmac_f32 v13, v15, v73
    v_lshlrev_b32 v14, 16, v34
    v_and_b32 v15, 0xffff0000, v34
    v_fmac_f32 v12, v14, v74
    v_fmac_f32 v13, v15, v74
    v_lshlrev_b32 v14, 16, v35
    v_and_b32 v15, 0xffff0000, v35
    v_fmac_f32 v12, v14, v75
    v_fmac_f32 v13, v15, v75
    v_lshlrev_b32 v14, 16, v36
    v_and_b32 v15, 0xffff0000, v36
    v_fmac_f32 v12, v14, v76
    v_fmac_f32 v13, v15, v76
    v_lshlrev_b32 v14, 16, v37
    v_and_b32 v15, 0xffff0000, v37
    v_fmac_f32 v12, v14, v77
    v_fmac_f32 v13, v15, v77
    v_lshlrev_b32 v14, 16, v38
    v_and_b32 v15, 0xffff0000, v38
    v_fmac_f32 v12, v14, v78
    v_fmac_f32 v13, v15, v78
    v_lshlrev_b32 v14, 16, v39
    v_and_b32 v15, 0xffff0000, v39
    v_fmac_f32 v12, v14, v79
    v_fmac_f32 v13, v15, v79
    v_lshlrev_b32 v14, 16, v40
    v_and_b32 v15, 0xffff0000, v40
    v_fmac_f32 v12, v14, v80
    v_fmac_f32 v13, v15, v80
    v_lshlrev_b32 v14, 16, v41
    v_and_b32 v15, 0xffff0000, v41
    v_fmac_f32 v12, v14, v81
    v_fmac_f32 v13, v15, v81
    v_lshlrev_b32 v14, 16, v42
    v_and_b32 v15, 0xffff0000, v42
    v_fmac_f32 v12, v14, v82
    v_fmac_f32 v13, v15, v82
    v_lshlrev_b32 v14, 16, v43
    v_and_b32 v15, 0xffff0000, v43
    v_fmac_f32 v12, v14, v83
    v_fmac_f32 v13, v15, v83
    v_lshlrev_b32 v14, 16, v44
    v_and_b32 v15, 0xffff0000, v44
    v_fmac_f32 v12, v14, v84
    v_fmac_f32 v13, v15, v84
    v_lshlrev_b32 v14, 16, v45
    v_and_b32 v15, 0xffff0000, v45
    v_fmac_f32 v12, v14, v85
    v_fmac_f32 v13, v15, v85
    v_lshlrev_b32 v14, 16, v46
    v_and_b32 v15, 0xffff0000, v46
    v_fmac_f32 v12, v14, v86
    v_fmac_f32 v13, v15, v86
    v_lshlrev_b32 v14, 16, v47
    v_and_b32 v15, 0xffff0000, v47
    v_fmac_f32 v12, v14, v87
    v_fmac_f32 v13, v15, v87
    v_lshlrev_b32 v14, 16, v48
    v_and_b32 v15, 0xffff0000, v48
    v_fmac_f32 v12, v14, v88
    v_fmac_f32 v13, v15, v88
    v_lshlrev_b32 v14, 16, v49
    v_and_b32 v15, 0xffff0000, v49
    v_fmac_f32 v12, v14, v89
    v_fmac_f32 v13, v15, v89
    v_lshlrev_b32 v14, 16, v50
    v_and_b32 v15, 0xffff0000, v50
    v_fmac_f32 v12, v14, v90
    v_fmac_f32 v13, v15, v90
    v_lshlrev_b32 v14, 16, v51
    v_and_b32 v15, 0xffff0000, v51
    v_fmac_f32 v12, v14, v91
    v_fmac_f32 v13, v15, v91
    v_lshlrev_b32 v9, 3, v0
    ds_write_b64 v9, v[12:13] offset:4096
    s_waitcnt lgkmcnt(0)
    s_barrier
    s_cmp_lg_u32 s3, 0
    s_cbranch_scc1 mod_kernel_done1
    v_and_b32 v9, 31, v2
    v_lshlrev_b32 v9, 2, v9
    ds_read_b32 v16, v9 offset:4096
    ds_read_b32 v17, v9 offset:4224
    ds_read_b32 v18, v9 offset:4352
    ds_read_b32 v19, v9 offset:4480
    ds_read_b32 v20, v9 offset:4608
    ds_read_b32 v21, v9 offset:4736
    ds_read_b32 v22, v9 offset:4864
    ds_read_b32 v23, v9 offset:4992
    ds_read_b32 v24, v9 offset:5120
    ds_read_b32 v25, v9 offset:5248
    ds_read_b32 v26, v9 offset:5376
    ds_read_b32 v27, v9 offset:5504
    ds_read_b32 v28, v9 offset:5632
    ds_read_b32 v29, v9 offset:5760
    ds_read_b32 v30, v9 offset:5888
    ds_read_b32 v31, v9 offset:6016
    s_waitcnt lgkmcnt(0)
    v_add_f32 v16, v16, v17
    v_add_f32 v16, v16, v18
    v_add_f32 v16, v16, v19
    v_add_f32 v16, v16, v20
    v_add_f32 v16, v16, v21
    v_add_f32 v16, v16, v22
    v_add_f32 v16, v16, v23
    v_add_f32 v16, v16, v24
    v_add_f32 v16, v16, v25
    v_add_f32 v16, v16, v26
    v_add_f32 v16, v16, v27
    v_add_f32 v16, v16, v28
    v_add_f32 v16, v16, v29
    v_add_f32 v16, v16, v30
    v_add_f32 v16, v16, v31
    v_cvt_pk_bf16_f32 v16, v16, v16
    v_and_b32 v16, 0xffff0000, v16
    s_lshl_b32 s25, s2, 7
    buffer_store_dword v16, v9, s[20:23], s25 offen
    v_add_f32 v17, 1.0, v16
    v_cvt_pk_bf16_f32 v17, v17, v17
    v_and_b32 v17, 0xffff0000, v17
    s_add_u32 s25, s25, 16384
    buffer_store_dword v17, v9, s[20:23], s25 offen
mod_kernel_done1:
    s_endpgm
mod_kernel_ln3:
    s_load_dwordx2 s[4:5], s[0:1], 0
    s_load_dwordx2 s[6:7], s[0:1], 112
    v_lshrrev_b32 v1, 5, v0
    v_and_b32 v2, 31, v0
    s_sub_u32 s3, s2, 108
    s_lshl_b32 s3, s3, 3
    v_add_u32 v1, s3, v1
    v_mul_u32_u24 v3, 1152, v1
    v_lshl_add_u32 v3, v2, 2, v3
    s_waitcnt lgkmcnt(0)
    s_mov_b32 s12, s4
    s_mov_b32 s13, s5
    s_mov_b32 s14, 0x240000
    s_mov_b32 s15, 0x00020000
    s_add_u32 s20, s6, 0x10000
    s_addc_u32 s21, s7, 0
    s_mov_b32 s22, 0x240000
    s_mov_b32 s23, 0x00020000
    buffer_load_dword v40, v3, s[12:15], 0 offen offset:0
    buffer_load_dword v41, v3, s[12:15], 0 offen offset:128
    buffer_load_dword v42, v3, s[12:15], 0 offen offset:256
    buffer_load_dword v43, v3, s[12:15], 0 offen offset:384
    buffer_load_dword v44, v3, s[12:15], 0 offen offset:512
    buffer_load_dword v45, v3, s[12:15], 0 offen offset:640
    buffer_load_dword v46, v3, s[12:15], 0 offen offset:768
    buffer_load_dword v47, v3, s[12:15], 0 offen offset:896
    buffer_load_dword v48, v3, s[12:15], 0 offen offset:1024
    v_lshrrev_b32 v5, 4, v1
    v_mul_u32_u24 v5, 18432, v5
    v_lshrrev_b32 v6, 4, v2
    v_lshl_add_u32 v5, v6, 10, v5
    v_bfe_u32 v6, v2, 2, 2
    v_lshl_add_u32 v5, v6, 8, v5
    v_and_b32 v6, 15, v1
    v_lshl_add_u32 v5, v6, 4, v5
    v_and_b32 v6, 3, v2
    v_lshl_add_u32 v5, v6, 2, v5
    s_waitcnt vmcnt(0)
    v_lshlrev_b32 v16, 16, v40
    v_and_b32 v17, 0xffff0000, v40
    v_lshlrev_b32 v18, 16, v41
    v_and_b32 v19, 0xffff0000, v41
    v_lshlrev_b32 v20, 16, v42
    v_and_b32 v21, 0xffff0000, v42
    v_lshlrev_b32 v22, 16, v43
    v_and_b32 v23, 0xffff0000, v43
    v_lshlrev_b32 v24, 16, v44
    v_and_b32 v25, 0xffff0000, v44
    v_lshlrev_b32 v26, 16, v45
    v_and_b32 v27, 0xffff0000, v45
    v_lshlrev_b32 v28, 16, v46
    v_and_b32 v29, 0xffff0000, v46
    v_lshlrev_b32 v30, 16, v47
    v_and_b32 v31, 0xffff0000, v47
    v_lshlrev_b32 v32, 16, v48
    v_and_b32 v33, 0xffff0000, v48
    v_add_f32 v6, v16, v17
    v_add_f32 v7, v18, v19
    v_add_f32 v6, v6, v20
    v_add_f32 v7, v7, v21
    v_add_f32 v6, v6, v22
    v_add_f32 v7, v7, v23
    v_add_f32 v6, v6, v24
    v_add_f32 v7, v7, v25
    v_add_f32 v6, v6, v26
    v_add_f32 v7, v7, v27
    v_add_f32 v6, v6, v28
    v_add_f32 v7, v7, v29
    v_add_f32 v6, v6, v30
    v_add_f32 v7, v7, v31
    v_add_f32 v6, v6, v32
    v_add_f32 v7, v7, v33
    v_add_f32 v6, v6, v7
    s_nop 1
    v_add_f32_dpp v6, v6, v6 quad_perm:[1,0,3,2] row_mask:0xf bank_mask:0xf
    s_nop 1
    v_add_f32_dpp v6, v6, v6 quad_perm:[2,3,0,1] row_mask:0xf bank_mask:0xf
    s_nop 1
    v_add_f32_dpp v6, v6, v6 row_half_mirror row_mask:0xf bank_mask:0xf
    s_nop 1
    v_add_f32_dpp v6, v6, v6 row_mirror row_mask:0xf bank_mask:0xf
    ds_swizzle_b32 v7, v6 offset:0x401F
    s_waitcnt lgkmcnt(0)
    v_add_f32 v6, v6, v7
    v_mul_f32 v8, 0x3ae38e39, v6
    v_sub_f32 v16, v16, v8
    v_sub_f32 v17, v17, v8
    v_sub_f32 v18, v18, v8
    v_sub_f32 v19, v19, v8
    v_sub_f32 v20, v20, v8
    v_sub_f32 v21, v21, v8
    v_sub_f32 v22, v22, v8
    v_sub_f32 v23, v23, v8
    v_sub_f32 v24, v24, v8
    v_sub_f32 v25, v25, v8
    v_sub_f32 v26, v26, v8
    v_sub_f32 v27, v27, v8
    v_sub_f32 v28, v28, v8
    v_sub_f32 v29, v29, v8
    v_sub_f32 v30, v30, v8
    v_sub_f32 v31, v31, v8
    v_sub_f32 v32, v32, v8
    v_sub_f32 v33, v33, v8
    v_mul_f32 v9, v16, v16
    v_mul_f32 v6, v17, v17
    v_fmac_f32 v9, v18, v18
    v_fmac_f32 v6, v19, v19
    v_fmac_f32 v9, v20, v20
    v_fmac_f32 v6, v21, v21
    v_fmac_f32 v9, v22, v22
    v_fmac_f32 v6, v23, v23
    v_fmac_f32 v9, v24, v24
    v_fmac_f32 v6, v25, v25
    v_fmac_f32 v9, v26, v26
    v_fmac_f32 v6, v27, v27
    v_fmac_f32 v9, v28, v28
    v_fmac_f32 v6, v29, v29
    v_fmac_f32 v9, v30, v30
    v_fmac_f32 v6, v31, v31
    v_fmac_f32 v9, v32, v32
    v_fmac_f32 v6, v33, v33
    v_add_f32 v9, v9, v6
    s_nop 1
    v_add_f32_dpp v9, v9, v9 quad_perm:[1,0,3,2] row_mask:0xf bank_mask:0xf
    s_nop 1
    v_add_f32_dpp v9, v9, v9 quad_perm:[2,3,0,1] row_mask:0xf bank_mask:0xf
    s_nop 1
    v_add_f32_dpp v9, v9, v9 row_half_mirror row_mask:0xf bank_mask:0xf
    s_nop 1
    v_add_f32_dpp v9, v9, v9 row_mirror row_mask:0xf bank_mask:0xf
    ds_swizzle_b32 v7, v9 offset:0x401F
    s_waitcnt lgkmcnt(0)
    v_add_f32 v9, v9, v7
    v_mov_b32 v7, 0x3727c5ac
    v_fmac_f32 v7, 0x3ae38e39, v9
    v_rsq_f32 v10, v7
    s_nop 0
    v_mul_f32 v6, v7, v10
    v_fma_f32 v6, -v6, v10, 1.0
    v_mul_f32 v8, 0.5, v10
    v_fmac_f32 v10, v6, v8
    v_mul_f32 v16, v16, v10
    v_mul_f32 v17, v17, v10
    v_cvt_pk_bf16_f32 v16, v16, v17
    s_mov_b32 s36, 0
    buffer_store_dword v16, v5, s[20:23], s36 offen
    v_mul_f32 v18, v18, v10
    v_mul_f32 v19, v19, v10
    v_cvt_pk_bf16_f32 v18, v18, v19
    s_mov_b32 s36, 2048
    buffer_store_dword v18, v5, s[20:23], s36 offen
    v_mul_f32 v20, v20, v10
    v_mul_f32 v21, v21, v10
    v_cvt_pk_bf16_f32 v20, v20, v21
    s_mov_b32 s36, 4096
    buffer_store_dword v20, v5, s[20:23], s36 offen
    v_mul_f32 v22, v22, v10
    v_mul_f32 v23, v23, v10
    v_cvt_pk_bf16_f32 v22, v22, v23
    s_mov_b32 s36, 6144
    buffer_store_dword v22, v5, s[20:23], s36 offen
    v_mul_f32 v24, v24, v10
    v_mul_f32 v25, v25, v10
    v_cvt_pk_bf16_f32 v24, v24, v25
    s_mov_b32 s36, 8192
    buffer_store_dword v24, v5, s[20:23], s36 offen
    v_mul_f32 v26, v26, v10
    v_mul_f32 v27, v27, v10
    v_cvt_pk_bf16_f32 v26, v26, v27
    s_mov_b32 s36, 10240
    buffer_store_dword v26, v5, s[20:23], s36 offen
    v_mul_f32 v28, v28, v10
    v_mul_f32 v29, v29, v10
    v_cvt_pk_bf16_f32 v28, v28, v29
    s_mov_b32 s36, 12288
    buffer_store_dword v28, v5, s[20:23], s36 offen
    v_mul_f32 v30, v30, v10
    v_mul_f32 v31, v31, v10
    v_cvt_pk_bf16_f32 v30, v30, v31
    s_mov_b32 s36, 14336
    buffer_store_dword v30, v5, s[20:23], s36 offen
    v_mul_f32 v32, v32, v10
    v_mul_f32 v33, v33, v10
    v_cvt_pk_bf16_f32 v32, v32, v33
    s_mov_b32 s36, 16384
    buffer_store_dword v32, v5, s[20:23], s36 offen
    s_endpgm
mod_kernel_prep2:
    v_lshrrev_b32 v1, 6, v0
    v_and_b32 v2, 63, v0
    v_readfirstlane_b32 s3, v1
    s_nop 3
    s_cmp_ge_u32 s3, 4
    s_cbranch_scc1 mod_kernel_done1
    s_sub_u32 s30, s2, 364
    s_mul_i32 s30, s30, 4
    s_add_u32 s30, s30, s3
    s_mul_i32 s31, s3, 9216
    s_cmp_lt_u32 s30, 1024
    s_cbranch_scc1 mod_kernel_prep_v4
    s_cmp_lt_u32 s30, 1600
    s_cbranch_scc1 mod_kernel_prep_wq5
    s_branch mod_kernel_done1
mod_kernel_prep_v4:
    s_load_dwordx2 s[4:5], s[0:1], 16
    s_load_dwordx2 s[6:7], s[0:1], 112
    s_waitcnt lgkmcnt(0)
    s_mov_b32 s12, s4
    s_mov_b32 s13, s5
    s_mov_b32 s14, 0x800000
    s_mov_b32 s15, 0x00020000
    s_add_u32 s16, s6, 0x6ed0000
    s_addc_u32 s17, s7, 0
    s_mov_b32 s18, 0x800000
    s_mov_b32 s19, 0x00020000
    s_mov_b32 s21, s30
    s_mul_i32 s22, s21, 1
    s_sub_u32 s22, s30, s22
    s_mul_i32 s23, s21, 8192
    s_mul_i32 s24, s22, 256
    s_add_u32 s23, s23, s24
    s_mov_b32 s25, 256
    v_add_u32 v3, 0, v2
    v_mul_u32_u24 v4, 4097, v3
    v_lshrrev_b32 v4, 16, v4
    v_mul_u32_u24 v5, 16, v4
    v_sub_u32 v5, v3, v5
    v_mul_lo_u32 v4, v4, s25
    v_lshl_add_u32 v4, v5, 4, v4
    s_add_u32 m0, s31, 0
    s_nop 0
    buffer_load_dwordx4 v4, s[12:15], s23 offen lds
    v_add_u32 v3, 64, v2
    v_mul_u32_u24 v4, 4097, v3
    v_lshrrev_b32 v4, 16, v4
    v_mul_u32_u24 v5, 16, v4
    v_sub_u32 v5, v3, v5
    v_mul_lo_u32 v4, v4, s25
    v_lshl_add_u32 v4, v5, 4, v4
    s_add_u32 m0, s31, 1024
    s_nop 0
    buffer_load_dwordx4 v4, s[12:15], s23 offen lds
    v_add_u32 v3, 128, v2
    v_mul_u32_u24 v4, 4097, v3
    v_lshrrev_b32 v4, 16, v4
    v_mul_u32_u24 v5, 16, v4
    v_sub_u32 v5, v3, v5
    v_mul_lo_u32 v4, v4, s25
    v_lshl_add_u32 v4, v5, 4, v4
    s_add_u32 m0, s31, 2048
    s_nop 0
    buffer_load_dwordx4 v4, s[12:15], s23 offen lds
    v_add_u32 v3, 192, v2
    v_mul_u32_u24 v4, 4097, v3
    v_lshrrev_b32 v4, 16, v4
    v_mul_u32_u24 v5, 16, v4
    v_sub_u32 v5, v3, v5
    v_mul_lo_u32 v4, v4, s25
    v_lshl_add_u32 v4, v5, 4, v4
    s_add_u32 m0, s31, 3072
    s_nop 0
    buffer_load_dwordx4 v4, s[12:15], s23 offen lds
    v_add_u32 v3, 256, v2
    v_mul_u32_u24 v4, 4097, v3
    v_lshrrev_b32 v4, 16, v4
    v_mul_u32_u24 v5, 16, v4
    v_sub_u32 v5, v3, v5
    v_mul_lo_u32 v4, v4, s25
    v_lshl_add_u32 v4, v5, 4, v4
    s_add_u32 m0, s31, 4096
    s_nop 0
    buffer_load_dwordx4 v4, s[12:15], s23 offen lds
    v_add_u32 v3, 320, v2
    v_mul_u32_u24 v4, 4097, v3
    v_lshrrev_b32 v4, 16, v4
    v_mul_u32_u24 v5, 16, v4
    v_sub_u32 v5, v3, v5
    v_mul_lo_u32 v4, v4, s25
    v_lshl_add_u32 v4, v5, 4, v4
    s_add_u32 m0, s31, 5120
    s_nop 0
    buffer_load_dwordx4 v4, s[12:15], s23 offen lds
    v_add_u32 v3, 384, v2
    v_mul_u32_u24 v4, 4097, v3
    v_lshrrev_b32 v4, 16, v4
    v_mul_u32_u24 v5, 16, v4
    v_sub_u32 v5, v3, v5
    v_mul_lo_u32 v4, v4, s25
    v_lshl_add_u32 v4, v5, 4, v4
    s_add_u32 m0, s31, 6144
    s_nop 0
    buffer_load_dwordx4 v4, s[12:15], s23 offen lds
    v_add_u32 v3, 448, v2
    v_mul_u32_u24 v4, 4097, v3
    v_lshrrev_b32 v4, 16, v4
    v_mul_u32_u24 v5, 16, v4
    v_sub_u32 v5, v3, v5
    v_mul_lo_u32 v4, v4, s25
    v_lshl_add_u32 v4, v5, 4, v4
    s_add_u32 m0, s31, 7168
    s_nop 0
    buffer_load_dwordx4 v4, s[12:15], s23 offen lds
    v_lshrrev_b32 v3, 4, v2
    v_bfe_u32 v4, v2, 2, 2
    v_lshl_add_u32 v4, v3, 2, v4
    v_mul_u32_u24 v4, 256, v4
    v_and_b32 v5, 3, v2
    v_lshl_add_u32 v4, v5, 3, v4
    v_add_u32 v4, s31, v4
    s_mul_i32 s26, s21, 8192
    s_mul_i32 s27, s22, 8192
    s_add_u32 s26, s26, s27
    v_lshlrev_b32 v5, 4, v2
    s_waitcnt vmcnt(0)
    ds_read_b64_tr_b16 v[8:9], v4 offset:0
    ds_read_b64_tr_b16 v[10:11], v4 offset:4096
    ds_read_b64_tr_b16 v[12:13], v4 offset:32
    ds_read_b64_tr_b16 v[14:15], v4 offset:4128
    ds_read_b64_tr_b16 v[16:17], v4 offset:64
    ds_read_b64_tr_b16 v[18:19], v4 offset:4160
    ds_read_b64_tr_b16 v[20:21], v4 offset:96
    ds_read_b64_tr_b16 v[22:23], v4 offset:4192
    ds_read_b64_tr_b16 v[24:25], v4 offset:128
    ds_read_b64_tr_b16 v[26:27], v4 offset:4224
    ds_read_b64_tr_b16 v[28:29], v4 offset:160
    ds_read_b64_tr_b16 v[30:31], v4 offset:4256
    ds_read_b64_tr_b16 v[32:33], v4 offset:192
    ds_read_b64_tr_b16 v[34:35], v4 offset:4288
    ds_read_b64_tr_b16 v[36:37], v4 offset:224
    ds_read_b64_tr_b16 v[38:39], v4 offset:4320
    s_waitcnt lgkmcnt(0)
    buffer_store_dwordx4 v[8:11], v5, s[16:19], s26 offen offset:0 sc0 sc1
    buffer_store_dwordx4 v[12:15], v5, s[16:19], s26 offen offset:1024 sc0 sc1
    buffer_store_dwordx4 v[16:19], v5, s[16:19], s26 offen offset:2048 sc0 sc1
    buffer_store_dwordx4 v[20:23], v5, s[16:19], s26 offen offset:3072 sc0 sc1
    s_add_u32 s26, s26, 4096
    buffer_store_dwordx4 v[24:27], v5, s[16:19], s26 offen offset:0 sc0 sc1
    buffer_store_dwordx4 v[28:31], v5, s[16:19], s26 offen offset:1024 sc0 sc1
    buffer_store_dwordx4 v[32:35], v5, s[16:19], s26 offen offset:2048 sc0 sc1
    buffer_store_dwordx4 v[36:39], v5, s[16:19], s26 offen offset:3072 sc0 sc1
    s_endpgm
mod_kernel_prep_wq5:
    s_sub_u32 s30, s30, 1024
    s_load_dwordx2 s[4:5], s[0:1], 24
    s_load_dwordx2 s[6:7], s[0:1], 112
    s_waitcnt lgkmcnt(0)
    s_mov_b32 s12, s4
    s_mov_b32 s13, s5
    s_mov_b32 s14, 0x480000
    s_mov_b32 s15, 0x00020000
    s_add_u32 s16, s6, 0x76d0000
    s_addc_u32 s17, s7, 0
    s_mov_b32 s18, 0x480000
    s_mov_b32 s19, 0x00020000
    s_mov_b32 s20, 134217729
    s_mul_hi_u32 s21, s30, s20
    s_mul_i32 s22, s21, 32
    s_sub_u32 s22, s30, s22
    s_mul_i32 s23, s21, 262144
    s_mul_i32 s24, s22, 256
    s_add_u32 s23, s23, s24
    s_mov_b32 s25, 8192
    v_add_u32 v3, 0, v2
    v_mul_u32_u24 v4, 4097, v3
    v_lshrrev_b32 v4, 16, v4
    v_mul_u32_u24 v5, 16, v4
    v_sub_u32 v5, v3, v5
    v_mul_lo_u32 v4, v4, s25
    v_lshl_add_u32 v4, v5, 4, v4
    s_add_u32 m0, s31, 0
    s_nop 0
    buffer_load_dwordx4 v4, s[12:15], s23 offen lds
    v_add_u32 v3, 64, v2
    v_mul_u32_u24 v4, 4097, v3
    v_lshrrev_b32 v4, 16, v4
    v_mul_u32_u24 v5, 16, v4
    v_sub_u32 v5, v3, v5
    v_mul_lo_u32 v4, v4, s25
    v_lshl_add_u32 v4, v5, 4, v4
    s_add_u32 m0, s31, 1024
    s_nop 0
    buffer_load_dwordx4 v4, s[12:15], s23 offen lds
    v_add_u32 v3, 128, v2
    v_mul_u32_u24 v4, 4097, v3
    v_lshrrev_b32 v4, 16, v4
    v_mul_u32_u24 v5, 16, v4
    v_sub_u32 v5, v3, v5
    v_mul_lo_u32 v4, v4, s25
    v_lshl_add_u32 v4, v5, 4, v4
    s_add_u32 m0, s31, 2048
    s_nop 0
    buffer_load_dwordx4 v4, s[12:15], s23 offen lds
    v_add_u32 v3, 192, v2
    v_mul_u32_u24 v4, 4097, v3
    v_lshrrev_b32 v4, 16, v4
    v_mul_u32_u24 v5, 16, v4
    v_sub_u32 v5, v3, v5
    v_mul_lo_u32 v4, v4, s25
    v_lshl_add_u32 v4, v5, 4, v4
    s_add_u32 m0, s31, 3072
    s_nop 0
    buffer_load_dwordx4 v4, s[12:15], s23 offen lds
    v_add_u32 v3, 256, v2
    v_mul_u32_u24 v4, 4097, v3
    v_lshrrev_b32 v4, 16, v4
    v_mul_u32_u24 v5, 16, v4
    v_sub_u32 v5, v3, v5
    v_mul_lo_u32 v4, v4, s25
    v_lshl_add_u32 v4, v5, 4, v4
    s_add_u32 m0, s31, 4096
    s_nop 0
    buffer_load_dwordx4 v4, s[12:15], s23 offen lds
    v_add_u32 v3, 320, v2
    v_mul_u32_u24 v4, 4097, v3
    v_lshrrev_b32 v4, 16, v4
    v_mul_u32_u24 v5, 16, v4
    v_sub_u32 v5, v3, v5
    v_mul_lo_u32 v4, v4, s25
    v_lshl_add_u32 v4, v5, 4, v4
    s_add_u32 m0, s31, 5120
    s_nop 0
    buffer_load_dwordx4 v4, s[12:15], s23 offen lds
    v_add_u32 v3, 384, v2
    v_mul_u32_u24 v4, 4097, v3
    v_lshrrev_b32 v4, 16, v4
    v_mul_u32_u24 v5, 16, v4
    v_sub_u32 v5, v3, v5
    v_mul_lo_u32 v4, v4, s25
    v_lshl_add_u32 v4, v5, 4, v4
    s_add_u32 m0, s31, 6144
    s_nop 0
    buffer_load_dwordx4 v4, s[12:15], s23 offen lds
    v_add_u32 v3, 448, v2
    v_mul_u32_u24 v4, 4097, v3
    v_lshrrev_b32 v4, 16, v4
    v_mul_u32_u24 v5, 16, v4
    v_sub_u32 v5, v3, v5
    v_mul_lo_u32 v4, v4, s25
    v_lshl_add_u32 v4, v5, 4, v4
    s_add_u32 m0, s31, 7168
    s_nop 0
    buffer_load_dwordx4 v4, s[12:15], s23 offen lds
    v_lshrrev_b32 v3, 4, v2
    v_bfe_u32 v4, v2, 2, 2
    v_lshl_add_u32 v4, v3, 3, v4
    v_mul_u32_u24 v4, 256, v4
    v_and_b32 v5, 3, v2
    v_lshl_add_u32 v4, v5, 4, v4
    v_add_u32 v4, s31, v4
    s_mul_i32 s26, s22, 147456
    s_mul_i32 s27, s21, 8192
    s_add_u32 s26, s26, s27
    v_lshlrev_b32 v5, 4, v2
    s_waitcnt vmcnt(0)
    ds_read_b64_tr_b16 v[8:9], v4 offset:0
    ds_read_b64_tr_b16 v[10:11], v4 offset:1024
    ds_read_b64_tr_b16 v[12:13], v4 offset:8
    ds_read_b64_tr_b16 v[14:15], v4 offset:1032
    ds_read_b64_tr_b16 v[16:17], v4 offset:64
    ds_read_b64_tr_b16 v[18:19], v4 offset:1088
    ds_read_b64_tr_b16 v[20:21], v4 offset:72
    ds_read_b64_tr_b16 v[22:23], v4 offset:1096
    ds_read_b64_tr_b16 v[24:25], v4 offset:128
    ds_read_b64_tr_b16 v[26:27], v4 offset:1152
    ds_read_b64_tr_b16 v[28:29], v4 offset:136
    ds_read_b64_tr_b16 v[30:31], v4 offset:1160
    ds_read_b64_tr_b16 v[32:33], v4 offset:192
    ds_read_b64_tr_b16 v[34:35], v4 offset:1216
    ds_read_b64_tr_b16 v[36:37], v4 offset:200
    ds_read_b64_tr_b16 v[38:39], v4 offset:1224
    s_waitcnt lgkmcnt(0)
    buffer_store_dwordx4 v[8:11], v5, s[16:19], s26 offen offset:0 sc0 sc1
    buffer_store_dwordx4 v[12:15], v5, s[16:19], s26 offen offset:1024 sc0 sc1
    buffer_store_dwordx4 v[16:19], v5, s[16:19], s26 offen offset:2048 sc0 sc1
    buffer_store_dwordx4 v[20:23], v5, s[16:19], s26 offen offset:3072 sc0 sc1
    s_add_u32 s26, s26, 4096
    buffer_store_dwordx4 v[24:27], v5, s[16:19], s26 offen offset:0 sc0 sc1
    buffer_store_dwordx4 v[28:31], v5, s[16:19], s26 offen offset:1024 sc0 sc1
    buffer_store_dwordx4 v[32:35], v5, s[16:19], s26 offen offset:2048 sc0 sc1
    buffer_store_dwordx4 v[36:39], v5, s[16:19], s26 offen offset:3072 sc0 sc1
    s_endpgm
.globl attn_kernel
.type attn_kernel,@function
.p2align 8
attn_kernel:
    s_cmp_ge_u32 s2, 256
    s_cbranch_scc1 attn_kernel_done1
    s_load_dwordx2 s[4:5], s[0:1], 8
    s_load_dwordx2 s[6:7], s[0:1], 16
    s_load_dwordx2 s[8:9], s[0:1], 24
    s_load_dwordx2 s[10:11], s[0:1], 112
    s_and_b32 s40, s2, 7
    s_lshr_b32 s41, s2, 3
    s_lshr_b32 s42, s41, 4
    s_lshl_b32 s43, s40, 1
    s_add_u32 s42, s42, s43
    s_bfe_u32 s43, s41, 0x10003
    s_lshl_b32 s44, s42, 1
    s_add_u32 s43, s43, s44
    s_and_b32 s44, s41, 7
    v_lshrrev_b32 v1, 6, v0
    v_and_b32 v2, 63, v0
    v_readfirstlane_b32 s45, v1
    s_waitcnt lgkmcnt(0)
    s_mov_b32 s12, s4
    s_mov_b32 s13, s5
    s_mov_b32 s14, 0x800000
    s_mov_b32 s15, 0x00020000
    s_add_u32 s16, s10, 0x6ed0000
    s_addc_u32 s17, s11, 0
    s_mov_b32 s18, 0x800000
    s_mov_b32 s19, 0x00020000
    s_add_u32 s20, s10, 0x76d0000
    s_addc_u32 s21, s11, 0
    s_mov_b32 s22, 0x480000
    s_mov_b32 s23, 0x00020000
    s_add_u32 s24, s10, 0x10000
    s_addc_u32 s25, s11, 0
    s_mov_b32 s26, 0x240000
    s_mov_b32 s27, 0x00020000
    s_add_u32 s28, s10, 0x250000
    s_addc_u32 s29, s11, 0
    s_mov_b32 s30, 0x1000000
    s_mov_b32 s31, 0x00020000
    s_mov_b32 s62, 0x3e0293ee
    s_mov_b32 s63, 0xbf800000
    v_and_b32 v3, 15, v2
    v_lshrrev_b32 v4, 4, v2
    s_lshl_b32 s46, s44, 8
    s_lshl_b32 s47, s45, 5
    s_add_u32 s46, s46, s47
    s_mul_i32 s47, s46, 1152
    v_lshlrev_b32 v8, 4, v2
    v_add_u32 v8, s47, v8
    v_xor_b32 v6, v3, v4
    v_lshlrev_b32 v7, 8, v3
    v_xor_b32 v1, 0, v6
    v_lshl_add_u32 v232, v1, 4, v7
    v_xor_b32 v1, 4, v6
    v_lshl_add_u32 v233, v1, 4, v7
    v_xor_b32 v1, 8, v6
    v_lshl_add_u32 v234, v1, 4, v7
    v_xor_b32 v1, 12, v6
    v_lshl_add_u32 v235, v1, 4, v7
    v_lshlrev_b32 v9, 4, v2
    v_add_u32 v247, 0x10000, v9
    v_lshrrev_b32 v5, 4, v2
    v_and_b32 v6, 15, v2
    s_lshl_b32 s47, s45, 3
    v_add_u32 v7, s47, v5
    v_and_b32 v1, 15, v7
    v_xor_b32 v1, v1, v6
    v_lshlrev_b32 v0, 8, v7
    v_lshl_add_u32 v244, v1, 4, v0
    v_add_u32 v7, s47, v5
    v_add_u32 v7, 4, v7
    v_and_b32 v1, 15, v7
    v_xor_b32 v1, v1, v6
    v_lshlrev_b32 v0, 8, v7
    v_lshl_add_u32 v245, v1, 4, v0
    s_lshl_b32 s50, s45, 11
    v_lshlrev_b32 v246, 4, v2
    v_add_u32 v246, s50, v246
    s_mul_i32 s51, s43, 147456
    s_lshl_b32 s52, s42, 19
    s_mov_b32 s53, s52
    s_add_u32 s57, s52, 0x80000
    s_mov_b32 s59, 0x70000000
    s_add_u32 s32, s10, 0x0
    s_addc_u32 s33, s11, 0
    s_mov_b32 s34, 0x8000
    s_mov_b32 s35, 0x00020000
    s_mul_i32 s36, s45, 768
    s_cmp_ge_u32 s45, 3
    s_cselect_b32 s37, 16384, 0
    s_add_u32 s37, s37, s36
    s_cmp_ge_u32 s45, 6
    s_cselect_b32 s37, s59, s37
    s_add_u32 m0, s36, 131072
    s_mov_b32 s38, -1
    s_mov_b32 s39, 0xffff
    s_mov_b64 exec, s[38:39]
    buffer_load_dwordx4 v9, s[32:35], s37 offen lds
    s_mov_b64 exec, -1
    v_lshrrev_b32 v1, 4, v2
    v_lshlrev_b32 v1, 5, v1
    v_add_u32 v10, 131072, v1
    s_add_u32 m0, s50, 114688
    s_nop 0
    buffer_load_dwordx4 v246, s[20:23], s51 offen lds
    s_add_u32 m0, s50, 114688
    s_nop 0
    buffer_load_dwordx4 v246, s[20:23], s51 offen offset:1024 lds
    s_add_u32 s51, s51, 16384
    s_mov_b32 s54, 0
    buffer_load_dwordx4 v[104:107], v8, s[24:27], s54 offen offset:0
    s_mov_b32 s54, 18432
    buffer_load_dwordx4 v[108:111], v8, s[24:27], s54 offen offset:0
    s_mov_b32 s54, 0
    buffer_load_dwordx4 v[112:115], v8, s[24:27], s54 offen offset:1024
    s_mov_b32 s54, 18432
    buffer_load_dwordx4 v[116:119], v8, s[24:27], s54 offen offset:1024
    s_add_u32 m0, s50, 65536
    s_nop 0
    buffer_load_dwordx4 v246, s[20:23], s51 offen lds
    s_add_u32 m0, s50, 65536
    s_nop 0
    buffer_load_dwordx4 v246, s[20:23], s51 offen offset:1024 lds
    s_add_u32 s51, s51, 16384
    s_mov_b32 s54, 2048
    buffer_load_dwordx4 v[120:123], v8, s[24:27], s54 offen offset:0
    s_mov_b32 s54, 20480
    buffer_load_dwordx4 v[124:127], v8, s[24:27], s54 offen offset:0
    s_mov_b32 s54, 2048
    buffer_load_dwordx4 v[128:131], v8, s[24:27], s54 offen offset:1024
    s_mov_b32 s54, 20480
    buffer_load_dwordx4 v[132:135], v8, s[24:27], s54 offen offset:1024
    s_add_u32 m0, s50, 81920
    s_nop 0
    buffer_load_dwordx4 v246, s[20:23], s51 offen lds
    s_add_u32 m0, s50, 81920
    s_nop 0
    buffer_load_dwordx4 v246, s[20:23], s51 offen offset:1024 lds
    s_add_u32 s51, s51, 16384
    s_mov_b32 s54, 4096
    buffer_load_dwordx4 v[136:139], v8, s[24:27], s54 offen offset:0
    s_mov_b32 s54, 22528
    buffer_load_dwordx4 v[140:143], v8, s[24:27], s54 offen offset:0
    s_mov_b32 s54, 4096
    buffer_load_dwordx4 v[144:147], v8, s[24:27], s54 offen offset:1024
    s_mov_b32 s54, 22528
    buffer_load_dwordx4 v[148:151], v8, s[24:27], s54 offen offset:1024
    s_load_dwordx2 s[64:65], s[0:1], 32
    s_load_dwordx2 s[66:67], s[0:1], 48
    s_load_dwordx2 s[68:69], s[0:1], 72
    s_load_dwordx2 s[70:71], s[0:1], 56
    s_add_u32 s80, s10, 0x7b4c000
    s_addc_u32 s81, s11, 0
    s_mov_b32 s82, 0x1424000
    s_mov_b32 s83, 0x00020000
    s_lshl_b32 s72, s2, 3
    s_add_u32 s72, s72, s45
    s_mov_b32 s79, 0x00020000
    s_add_u32 s73, s50, 131072
    s_waitcnt lgkmcnt(0)
    v_mov_b32 v40, 0
    v_mov_b32 v41, 0
    v_mov_b32 v42, 0
    v_mov_b32 v43, 0
    v_mov_b32 v44, 0
    v_mov_b32 v45, 0
    v_mov_b32 v46, 0
    v_mov_b32 v47, 0
    v_mov_b32 v48, 0
    v_mov_b32 v49, 0
    v_mov_b32 v50, 0
    v_mov_b32 v51, 0
    v_mov_b32 v52, 0
    v_mov_b32 v53, 0
    v_mov_b32 v54, 0
    v_mov_b32 v55, 0
    v_mov_b32 v56, 0
    v_mov_b32 v57, 0
    v_mov_b32 v58, 0
    v_mov_b32 v59, 0
    v_mov_b32 v60, 0
    v_mov_b32 v61, 0
    v_mov_b32 v62, 0
    v_mov_b32 v63, 0
    v_mov_b32 v64, 0
    v_mov_b32 v65, 0
    v_mov_b32 v66, 0
    v_mov_b32 v67, 0
    v_mov_b32 v68, 0
    v_mov_b32 v69, 0
    v_mov_b32 v70, 0
    v_mov_b32 v71, 0
    v_mov_b32 v72, 0
    v_mov_b32 v73, 0
    v_mov_b32 v74, 0
    v_mov_b32 v75, 0
    v_mov_b32 v76, 0
    v_mov_b32 v77, 0
    v_mov_b32 v78, 0
    v_mov_b32 v79, 0
    v_mov_b32 v80, 0
    v_mov_b32 v81, 0
    v_mov_b32 v82, 0
    v_mov_b32 v83, 0
    v_mov_b32 v84, 0
    v_mov_b32 v85, 0
    v_mov_b32 v86, 0
    v_mov_b32 v87, 0
    v_mov_b32 v88, 0
    v_mov_b32 v89, 0
    v_mov_b32 v90, 0
    v_mov_b32 v91, 0
    v_mov_b32 v92, 0
    v_mov_b32 v93, 0
    v_mov_b32 v94, 0
    v_mov_b32 v95, 0
    v_mov_b32 v96, 0
    v_mov_b32 v97, 0
    v_mov_b32 v98, 0
    v_mov_b32 v99, 0
    v_mov_b32 v100, 0
    v_mov_b32 v101, 0
    v_mov_b32 v102, 0
    v_mov_b32 v103, 0
    s_waitcnt vmcnt(12)
    s_barrier
    ds_read_b128 v[12:15], v10 offset:2304
    ds_read_b128 v[16:19], v10 offset:2320
    ds_read_b128 v[20:23], v10 offset:0
    ds_read_b128 v[24:27], v10 offset:16
    s_waitcnt lgkmcnt(0)
    v_lshlrev_b32 v28, 16, v104
    v_and_b32 v29, 0xffff0000, v104
    v_fma_f32 v28, v28, v12, v20
    v_fma_f32 v29, v29, v13, v21
    v_cvt_pk_bf16_f32 v104, v28, v29
    v_lshlrev_b32 v30, 16, v105
    v_and_b32 v31, 0xffff0000, v105
    v_fma_f32 v30, v30, v14, v22
    v_fma_f32 v31, v31, v15, v23
    v_cvt_pk_bf16_f32 v105, v30, v31
    v_lshlrev_b32 v32, 16, v106
    v_and_b32 v33, 0xffff0000, v106
    v_fma_f32 v32, v32, v16, v24
    v_fma_f32 v33, v33, v17, v25
    v_cvt_pk_bf16_f32 v106, v32, v33
    v_lshlrev_b32 v34, 16, v107
    v_and_b32 v35, 0xffff0000, v107
    v_fma_f32 v34, v34, v18, v26
    v_fma_f32 v35, v35, v19, v27
    v_cvt_pk_bf16_f32 v107, v34, v35
    v_lshlrev_b32 v28, 16, v108
    v_and_b32 v29, 0xffff0000, v108
    v_fma_f32 v28, v28, v12, v20
    v_fma_f32 v29, v29, v13, v21
    v_cvt_pk_bf16_f32 v108, v28, v29
    v_lshlrev_b32 v30, 16, v109
    v_and_b32 v31, 0xffff0000, v109
    v_fma_f32 v30, v30, v14, v22
    v_fma_f32 v31, v31, v15, v23
    v_cvt_pk_bf16_f32 v109, v30, v31
    v_lshlrev_b32 v32, 16, v110
    v_and_b32 v33, 0xffff0000, v110
    v_fma_f32 v32, v32, v16, v24
    v_fma_f32 v33, v33, v17, v25
    v_cvt_pk_bf16_f32 v110, v32, v33
    v_lshlrev_b32 v34, 16, v111
    v_and_b32 v35, 0xffff0000, v111
    v_fma_f32 v34, v34, v18, v26
    v_fma_f32 v35, v35, v19, v27
    v_cvt_pk_bf16_f32 v111, v34, v35
    ds_read_b128 v[12:15], v10 offset:2432
    ds_read_b128 v[16:19], v10 offset:2448
    ds_read_b128 v[20:23], v10 offset:128
    ds_read_b128 v[24:27], v10 offset:144
    s_waitcnt lgkmcnt(0)
    v_lshlrev_b32 v28, 16, v112
    v_and_b32 v29, 0xffff0000, v112
    v_fma_f32 v28, v28, v12, v20
    v_fma_f32 v29, v29, v13, v21
    v_cvt_pk_bf16_f32 v112, v28, v29
    v_lshlrev_b32 v30, 16, v113
    v_and_b32 v31, 0xffff0000, v113
    v_fma_f32 v30, v30, v14, v22
    v_fma_f32 v31, v31, v15, v23
    v_cvt_pk_bf16_f32 v113, v30, v31
    v_lshlrev_b32 v32, 16, v114
    v_and_b32 v33, 0xffff0000, v114
    v_fma_f32 v32, v32, v16, v24
    v_fma_f32 v33, v33, v17, v25
    v_cvt_pk_bf16_f32 v114, v32, v33
    v_lshlrev_b32 v34, 16, v115
    v_and_b32 v35, 0xffff0000, v115
    v_fma_f32 v34, v34, v18, v26
    v_fma_f32 v35, v35, v19, v27
    v_cvt_pk_bf16_f32 v115, v34, v35
    v_lshlrev_b32 v28, 16, v116
    v_and_b32 v29, 0xffff0000, v116
    v_fma_f32 v28, v28, v12, v20
    v_fma_f32 v29, v29, v13, v21
    v_cvt_pk_bf16_f32 v116, v28, v29
    v_lshlrev_b32 v30, 16, v117
    v_and_b32 v31, 0xffff0000, v117
    v_fma_f32 v30, v30, v14, v22
    v_fma_f32 v31, v31, v15, v23
    v_cvt_pk_bf16_f32 v117, v30, v31
    v_lshlrev_b32 v32, 16, v118
    v_and_b32 v33, 0xffff0000, v118
    v_fma_f32 v32, v32, v16, v24
    v_fma_f32 v33, v33, v17, v25
    v_cvt_pk_bf16_f32 v118, v32, v33
    v_lshlrev_b32 v34, 16, v119
    v_and_b32 v35, 0xffff0000, v119
    v_fma_f32 v34, v34, v18, v26
    v_fma_f32 v35, v35, v19, v27
    v_cvt_pk_bf16_f32 v119, v34, v35
    ds_read_b128 v[200:203], v247 offset:49152
    ds_read_b128 v[204:207], v247 offset:50176
    ds_read_b128 v[208:211], v247 offset:51200
    ds_read_b128 v[212:215], v247 offset:52224
    ds_read_b128 v[216:219], v247 offset:53248
    ds_read_b128 v[220:223], v247 offset:54272
    ds_read_b128 v[224:227], v247 offset:55296
    s_waitcnt lgkmcnt(6)
    v_mfma_f32_16x16x32_bf16 v[40:43], v[200:203], v[104:107], v[40:43]
    v_mfma_f32_16x16x32_bf16 v[44:47], v[200:203], v[108:111], v[44:47]
    ds_read_b128 v[228:231], v247 offset:56320
    s_waitcnt lgkmcnt(6)
    v_mfma_f32_16x16x32_bf16 v[48:51], v[204:207], v[104:107], v[48:51]
    v_mfma_f32_16x16x32_bf16 v[52:55], v[204:207], v[108:111], v[52:55]
    s_add_u32 m0, s50, 98304
    s_nop 0
    buffer_load_dwordx4 v246, s[20:23], s51 offen lds
    ds_read_b128 v[200:203], v247 offset:57344
    s_waitcnt lgkmcnt(6)
    v_mfma_f32_16x16x32_bf16 v[56:59], v[208:211], v[104:107], v[56:59]
    v_mfma_f32_16x16x32_bf16 v[60:63], v[208:211], v[108:111], v[60:63]
    ds_read_b128 v[204:207], v247 offset:58368
    s_waitcnt lgkmcnt(6)
    v_mfma_f32_16x16x32_bf16 v[64:67], v[212:215], v[104:107], v[64:67]
    v_mfma_f32_16x16x32_bf16 v[68:71], v[212:215], v[108:111], v[68:71]
    s_add_u32 m0, s50, 98304
    s_nop 0
    buffer_load_dwordx4 v246, s[20:23], s51 offen offset:1024 lds
    s_add_u32 s51, s51, 16384
    ds_read_b128 v[208:211], v247 offset:59392
    s_waitcnt lgkmcnt(6)
    v_mfma_f32_16x16x32_bf16 v[72:75], v[216:219], v[104:107], v[72:75]
    v_mfma_f32_16x16x32_bf16 v[76:79], v[216:219], v[108:111], v[76:79]
    s_waitcnt vmcnt(8)
    ds_read_b128 v[12:15], v10 offset:2560
    ds_read_b128 v[16:19], v10 offset:2576
    ds_read_b128 v[20:23], v10 offset:256
    ds_read_b128 v[24:27], v10 offset:272
    ds_read_b128 v[212:215], v247 offset:60416
    s_waitcnt lgkmcnt(10)
    v_mfma_f32_16x16x32_bf16 v[80:83], v[220:223], v[104:107], v[80:83]
    v_mfma_f32_16x16x32_bf16 v[84:87], v[220:223], v[108:111], v[84:87]
    s_mov_b32 s54, 6144
    buffer_load_dwordx4 v[152:155], v8, s[24:27], s54 offen offset:0
    s_waitcnt lgkmcnt(1)
    v_lshlrev_b32 v28, 16, v120
    v_and_b32 v29, 0xffff0000, v120
    v_fma_f32 v28, v28, v12, v20
    v_fma_f32 v29, v29, v13, v21
    v_cvt_pk_bf16_f32 v120, v28, v29
    ds_read_b128 v[216:219], v247 offset:61440
    v_mfma_f32_16x16x32_bf16 v[88:91], v[224:227], v[104:107], v[88:91]
    v_mfma_f32_16x16x32_bf16 v[92:95], v[224:227], v[108:111], v[92:95]
    v_lshlrev_b32 v30, 16, v121
    v_and_b32 v31, 0xffff0000, v121
    v_fma_f32 v30, v30, v14, v22
    v_fma_f32 v31, v31, v15, v23
    v_cvt_pk_bf16_f32 v121, v30, v31
    v_lshlrev_b32 v32, 16, v122
    v_and_b32 v33, 0xffff0000, v122
    v_fma_f32 v32, v32, v16, v24
    v_fma_f32 v33, v33, v17, v25
    v_cvt_pk_bf16_f32 v122, v32, v33
    ds_read_b128 v[220:223], v247 offset:62464
    v_mfma_f32_16x16x32_bf16 v[96:99], v[228:231], v[104:107], v[96:99]
    v_mfma_f32_16x16x32_bf16 v[100:103], v[228:231], v[108:111], v[100:103]
    s_mov_b32 s54, 24576
    buffer_load_dwordx4 v[156:159], v8, s[24:27], s54 offen offset:0
    v_lshlrev_b32 v34, 16, v123
    v_and_b32 v35, 0xffff0000, v123
    v_fma_f32 v34, v34, v18, v26
    v_fma_f32 v35, v35, v19, v27
    v_cvt_pk_bf16_f32 v123, v34, v35
    v_lshlrev_b32 v28, 16, v124
    v_and_b32 v29, 0xffff0000, v124
    v_fma_f32 v28, v28, v12, v20
    v_fma_f32 v29, v29, v13, v21
    v_cvt_pk_bf16_f32 v124, v28, v29
    ds_read_b128 v[224:227], v247 offset:63488
    v_mfma_f32_16x16x32_bf16 v[40:43], v[200:203], v[112:115], v[40:43]
    v_mfma_f32_16x16x32_bf16 v[44:47], v[200:203], v[116:119], v[44:47]
    v_lshlrev_b32 v30, 16, v125
    v_and_b32 v31, 0xffff0000, v125
    v_fma_f32 v30, v30, v14, v22
    v_fma_f32 v31, v31, v15, v23
    v_cvt_pk_bf16_f32 v125, v30, v31
    v_lshlrev_b32 v32, 16, v126
    v_and_b32 v33, 0xffff0000, v126
    v_fma_f32 v32, v32, v16, v24
    v_fma_f32 v33, v33, v17, v25
    v_cvt_pk_bf16_f32 v126, v32, v33
    ds_read_b128 v[228:231], v247 offset:64512
    v_mfma_f32_16x16x32_bf16 v[48:51], v[204:207], v[112:115], v[48:51]
    v_mfma_f32_16x16x32_bf16 v[52:55], v[204:207], v[116:119], v[52:55]
    s_mov_b32 s54, 6144
    buffer_load_dwordx4 v[160:163], v8, s[24:27], s54 offen offset:1024
    v_lshlrev_b32 v34, 16, v127
    v_and_b32 v35, 0xffff0000, v127
    v_fma_f32 v34, v34, v18, v26
    v_fma_f32 v35, v35, v19, v27
    v_cvt_pk_bf16_f32 v127, v34, v35
    ds_read_b128 v[12:15], v10 offset:2688
    ds_read_b128 v[16:19], v10 offset:2704
    ds_read_b128 v[20:23], v10 offset:384
    ds_read_b128 v[24:27], v10 offset:400
    v_mfma_f32_16x16x32_bf16 v[56:59], v[208:211], v[112:115], v[56:59]
    v_mfma_f32_16x16x32_bf16 v[60:63], v[208:211], v[116:119], v[60:63]
    s_waitcnt lgkmcnt(0)
    v_mfma_f32_16x16x32_bf16 v[64:67], v[212:215], v[112:115], v[64:67]
    v_mfma_f32_16x16x32_bf16 v[68:71], v[212:215], v[116:119], v[68:71]
    s_mov_b32 s54, 24576
    buffer_load_dwordx4 v[164:167], v8, s[24:27], s54 offen offset:1024
    v_lshlrev_b32 v28, 16, v128
    v_and_b32 v29, 0xffff0000, v128
    v_fma_f32 v28, v28, v12, v20
    v_fma_f32 v29, v29, v13, v21
    v_cvt_pk_bf16_f32 v128, v28, v29
    v_lshlrev_b32 v30, 16, v129
    v_and_b32 v31, 0xffff0000, v129
    v_fma_f32 v30, v30, v14, v22
    v_fma_f32 v31, v31, v15, v23
    v_cvt_pk_bf16_f32 v129, v30, v31
    v_mfma_f32_16x16x32_bf16 v[72:75], v[216:219], v[112:115], v[72:75]
    v_mfma_f32_16x16x32_bf16 v[76:79], v[216:219], v[116:119], v[76:79]
    v_lshlrev_b32 v32, 16, v130
    v_and_b32 v33, 0xffff0000, v130
    v_fma_f32 v32, v32, v16, v24
    v_fma_f32 v33, v33, v17, v25
    v_cvt_pk_bf16_f32 v130, v32, v33
    v_lshlrev_b32 v34, 16, v131
    v_and_b32 v35, 0xffff0000, v131
    v_fma_f32 v34, v34, v18, v26
    v_fma_f32 v35, v35, v19, v27
    v_cvt_pk_bf16_f32 v131, v34, v35
    v_mfma_f32_16x16x32_bf16 v[80:83], v[220:223], v[112:115], v[80:83]
    v_mfma_f32_16x16x32_bf16 v[84:87], v[220:223], v[116:119], v[84:87]
    v_lshlrev_b32 v28, 16, v132
    v_and_b32 v29, 0xffff0000, v132
    v_fma_f32 v28, v28, v12, v20
    v_fma_f32 v29, v29, v13, v21
    v_cvt_pk_bf16_f32 v132, v28, v29
    v_lshlrev_b32 v30, 16, v133
    v_and_b32 v31, 0xffff0000, v133
    v_fma_f32 v30, v30, v14, v22
    v_fma_f32 v31, v31, v15, v23
    v_cvt_pk_bf16_f32 v133, v30, v31
    v_mfma_f32_16x16x32_bf16 v[88:91], v[224:227], v[112:115], v[88:91]
    v_mfma_f32_16x16x32_bf16 v[92:95], v[224:227], v[116:119], v[92:95]
    v_lshlrev_b32 v32, 16, v134
    v_and_b32 v33, 0xffff0000, v134
    v_fma_f32 v32, v32, v16, v24
    v_fma_f32 v33, v33, v17, v25
    v_cvt_pk_bf16_f32 v134, v32, v33
    v_lshlrev_b32 v34, 16, v135
    v_and_b32 v35, 0xffff0000, v135
    v_fma_f32 v34, v34, v18, v26
    v_fma_f32 v35, v35, v19, v27
    v_cvt_pk_bf16_f32 v135, v34, v35
    v_mfma_f32_16x16x32_bf16 v[96:99], v[228:231], v[112:115], v[96:99]
    v_mfma_f32_16x16x32_bf16 v[100:103], v[228:231], v[116:119], v[100:103]
    s_barrier
    ds_read_b128 v[200:203], v247 offset:0
    ds_read_b128 v[204:207], v247 offset:1024
    ds_read_b128 v[208:211], v247 offset:2048
    ds_read_b128 v[212:215], v247 offset:3072
    ds_read_b128 v[216:219], v247 offset:4096
    ds_read_b128 v[220:223], v247 offset:5120
    ds_read_b128 v[224:227], v247 offset:6144
    s_waitcnt lgkmcnt(6)
    v_mfma_f32_16x16x32_bf16 v[40:43], v[200:203], v[120:123], v[40:43]
    v_mfma_f32_16x16x32_bf16 v[44:47], v[200:203], v[124:127], v[44:47]
    ds_read_b128 v[228:231], v247 offset:7168
    s_waitcnt lgkmcnt(6)
    v_mfma_f32_16x16x32_bf16 v[48:51], v[204:207], v[120:123], v[48:51]
    v_mfma_f32_16x16x32_bf16 v[52:55], v[204:207], v[124:127], v[52:55]
    s_add_u32 m0, s50, 114688
    s_nop 0
    buffer_load_dwordx4 v246, s[20:23], s51 offen lds
    ds_read_b128 v[200:203], v247 offset:8192
    s_waitcnt lgkmcnt(6)
    v_mfma_f32_16x16x32_bf16 v[56:59], v[208:211], v[120:123], v[56:59]
    v_mfma_f32_16x16x32_bf16 v[60:63], v[208:211], v[124:127], v[60:63]
    ds_read_b128 v[204:207], v247 offset:9216
    s_waitcnt lgkmcnt(6)
    v_mfma_f32_16x16x32_bf16 v[64:67], v[212:215], v[120:123], v[64:67]
    v_mfma_f32_16x16x32_bf16 v[68:71], v[212:215], v[124:127], v[68:71]
    s_add_u32 m0, s50, 114688
    s_nop 0
    buffer_load_dwordx4 v246, s[20:23], s51 offen offset:1024 lds
    s_add_u32 s51, s51, 16384
    ds_read_b128 v[208:211], v247 offset:10240
    s_waitcnt lgkmcnt(6)
    v_mfma_f32_16x16x32_bf16 v[72:75], v[216:219], v[120:123], v[72:75]
    v_mfma_f32_16x16x32_bf16 v[76:79], v[216:219], v[124:127], v[76:79]
    s_waitcnt vmcnt(8)
    ds_read_b128 v[12:15], v10 offset:2816
    ds_read_b128 v[16:19], v10 offset:2832
    ds_read_b128 v[20:23], v10 offset:512
    ds_read_b128 v[24:27], v10 offset:528
    ds_read_b128 v[212:215], v247 offset:11264
    s_waitcnt lgkmcnt(10)
    v_mfma_f32_16x16x32_bf16 v[80:83], v[220:223], v[120:123], v[80:83]
    v_mfma_f32_16x16x32_bf16 v[84:87], v[220:223], v[124:127], v[84:87]
    s_mov_b32 s54, 8192
    buffer_load_dwordx4 v[168:171], v8, s[24:27], s54 offen offset:0
    s_waitcnt lgkmcnt(1)
    v_lshlrev_b32 v28, 16, v136
    v_and_b32 v29, 0xffff0000, v136
    v_fma_f32 v28, v28, v12, v20
    v_fma_f32 v29, v29, v13, v21
    v_cvt_pk_bf16_f32 v136, v28, v29
    ds_read_b128 v[216:219], v247 offset:12288
    v_mfma_f32_16x16x32_bf16 v[88:91], v[224:227], v[120:123], v[88:91]
    v_mfma_f32_16x16x32_bf16 v[92:95], v[224:227], v[124:127], v[92:95]
    v_lshlrev_b32 v30, 16, v137
    v_and_b32 v31, 0xffff0000, v137
    v_fma_f32 v30, v30, v14, v22
    v_fma_f32 v31, v31, v15, v23
    v_cvt_pk_bf16_f32 v137, v30, v31
    v_lshlrev_b32 v32, 16, v138
    v_and_b32 v33, 0xffff0000, v138
    v_fma_f32 v32, v32, v16, v24
    v_fma_f32 v33, v33, v17, v25
    v_cvt_pk_bf16_f32 v138, v32, v33
    ds_read_b128 v[220:223], v247 offset:13312
    v_mfma_f32_16x16x32_bf16 v[96:99], v[228:231], v[120:123], v[96:99]
    v_mfma_f32_16x16x32_bf16 v[100:103], v[228:231], v[124:127], v[100:103]
    s_mov_b32 s54, 26624
    buffer_load_dwordx4 v[172:175], v8, s[24:27], s54 offen offset:0
    v_lshlrev_b32 v34, 16, v139
    v_and_b32 v35, 0xffff0000, v139
    v_fma_f32 v34, v34, v18, v26
    v_fma_f32 v35, v35, v19, v27
    v_cvt_pk_bf16_f32 v139, v34, v35
    v_lshlrev_b32 v28, 16, v140
    v_and_b32 v29, 0xffff0000, v140
    v_fma_f32 v28, v28, v12, v20
    v_fma_f32 v29, v29, v13, v21
    v_cvt_pk_bf16_f32 v140, v28, v29
    ds_read_b128 v[224:227], v247 offset:14336
    v_mfma_f32_16x16x32_bf16 v[40:43], v[200:203], v[128:131], v[40:43]
    v_mfma_f32_16x16x32_bf16 v[44:47], v[200:203], v[132:135], v[44:47]
    v_lshlrev_b32 v30, 16, v141
    v_and_b32 v31, 0xffff0000, v141
    v_fma_f32 v30, v30, v14, v22
    v_fma_f32 v31, v31, v15, v23
    v_cvt_pk_bf16_f32 v141, v30, v31
    v_lshlrev_b32 v32, 16, v142
    v_and_b32 v33, 0xffff0000, v142
    v_fma_f32 v32, v32, v16, v24
    v_fma_f32 v33, v33, v17, v25
    v_cvt_pk_bf16_f32 v142, v32, v33
    ds_read_b128 v[228:231], v247 offset:15360
    v_mfma_f32_16x16x32_bf16 v[48:51], v[204:207], v[128:131], v[48:51]
    v_mfma_f32_16x16x32_bf16 v[52:55], v[204:207], v[132:135], v[52:55]
    s_mov_b32 s54, 8192
    buffer_load_dwordx4 v[176:179], v8, s[24:27], s54 offen offset:1024
    v_lshlrev_b32 v34, 16, v143
    v_and_b32 v35, 0xffff0000, v143
    v_fma_f32 v34, v34, v18, v26
    v_fma_f32 v35, v35, v19, v27
    v_cvt_pk_bf16_f32 v143, v34, v35
    ds_read_b128 v[12:15], v10 offset:2944
    ds_read_b128 v[16:19], v10 offset:2960
    ds_read_b128 v[20:23], v10 offset:640
    ds_read_b128 v[24:27], v10 offset:656
    v_mfma_f32_16x16x32_bf16 v[56:59], v[208:211], v[128:131], v[56:59]
    v_mfma_f32_16x16x32_bf16 v[60:63], v[208:211], v[132:135], v[60:63]
    s_waitcnt lgkmcnt(0)
    v_mfma_f32_16x16x32_bf16 v[64:67], v[212:215], v[128:131], v[64:67]
    v_mfma_f32_16x16x32_bf16 v[68:71], v[212:215], v[132:135], v[68:71]
    s_mov_b32 s54, 26624
    buffer_load_dwordx4 v[180:183], v8, s[24:27], s54 offen offset:1024
    v_lshlrev_b32 v28, 16, v144
    v_and_b32 v29, 0xffff0000, v144
    v_fma_f32 v28, v28, v12, v20
    v_fma_f32 v29, v29, v13, v21
    v_cvt_pk_bf16_f32 v144, v28, v29
    v_lshlrev_b32 v30, 16, v145
    v_and_b32 v31, 0xffff0000, v145
    v_fma_f32 v30, v30, v14, v22
    v_fma_f32 v31, v31, v15, v23
    v_cvt_pk_bf16_f32 v145, v30, v31
    v_mfma_f32_16x16x32_bf16 v[72:75], v[216:219], v[128:131], v[72:75]
    v_mfma_f32_16x16x32_bf16 v[76:79], v[216:219], v[132:135], v[76:79]
    v_lshlrev_b32 v32, 16, v146
    v_and_b32 v33, 0xffff0000, v146
    v_fma_f32 v32, v32, v16, v24
    v_fma_f32 v33, v33, v17, v25
    v_cvt_pk_bf16_f32 v146, v32, v33
    v_lshlrev_b32 v34, 16, v147
    v_and_b32 v35, 0xffff0000, v147
    v_fma_f32 v34, v34, v18, v26
    v_fma_f32 v35, v35, v19, v27
    v_cvt_pk_bf16_f32 v147, v34, v35
    v_mfma_f32_16x16x32_bf16 v[80:83], v[220:223], v[128:131], v[80:83]
    v_mfma_f32_16x16x32_bf16 v[84:87], v[220:223], v[132:135], v[84:87]
    v_lshlrev_b32 v28, 16, v148
    v_and_b32 v29, 0xffff0000, v148
    v_fma_f32 v28, v28, v12, v20
    v_fma_f32 v29, v29, v13, v21
    v_cvt_pk_bf16_f32 v148, v28, v29
    v_lshlrev_b32 v30, 16, v149
    v_and_b32 v31, 0xffff0000, v149
    v_fma_f32 v30, v30, v14, v22
    v_fma_f32 v31, v31, v15, v23
    v_cvt_pk_bf16_f32 v149, v30, v31
    v_mfma_f32_16x16x32_bf16 v[88:91], v[224:227], v[128:131], v[88:91]
    v_mfma_f32_16x16x32_bf16 v[92:95], v[224:227], v[132:135], v[92:95]
    v_lshlrev_b32 v32, 16, v150
    v_and_b32 v33, 0xffff0000, v150
    v_fma_f32 v32, v32, v16, v24
    v_fma_f32 v33, v33, v17, v25
    v_cvt_pk_bf16_f32 v150, v32, v33
    v_lshlrev_b32 v34, 16, v151
    v_and_b32 v35, 0xffff0000, v151
    v_fma_f32 v34, v34, v18, v26
    v_fma_f32 v35, v35, v19, v27
    v_cvt_pk_bf16_f32 v151, v34, v35
    v_mfma_f32_16x16x32_bf16 v[96:99], v[228:231], v[128:131], v[96:99]
    v_mfma_f32_16x16x32_bf16 v[100:103], v[228:231], v[132:135], v[100:103]
    s_barrier
    ds_read_b128 v[200:203], v247 offset:16384
    ds_read_b128 v[204:207], v247 offset:17408
    ds_read_b128 v[208:211], v247 offset:18432
    ds_read_b128 v[212:215], v247 offset:19456
    ds_read_b128 v[216:219], v247 offset:20480
    ds_read_b128 v[220:223], v247 offset:21504
    ds_read_b128 v[224:227], v247 offset:22528
    s_waitcnt lgkmcnt(6)
    v_mfma_f32_16x16x32_bf16 v[40:43], v[200:203], v[136:139], v[40:43]
    v_mfma_f32_16x16x32_bf16 v[44:47], v[200:203], v[140:143], v[44:47]
    ds_read_b128 v[228:231], v247 offset:23552
    s_waitcnt lgkmcnt(6)
    v_mfma_f32_16x16x32_bf16 v[48:51], v[204:207], v[136:139], v[48:51]
    v_mfma_f32_16x16x32_bf16 v[52:55], v[204:207], v[140:143], v[52:55]
    s_add_u32 m0, s50, 65536
    s_nop 0
    buffer_load_dwordx4 v246, s[20:23], s51 offen lds
    ds_read_b128 v[200:203], v247 offset:24576
    s_waitcnt lgkmcnt(6)
    v_mfma_f32_16x16x32_bf16 v[56:59], v[208:211], v[136:139], v[56:59]
    v_mfma_f32_16x16x32_bf16 v[60:63], v[208:211], v[140:143], v[60:63]
    ds_read_b128 v[204:207], v247 offset:25600
    s_waitcnt lgkmcnt(6)
    v_mfma_f32_16x16x32_bf16 v[64:67], v[212:215], v[136:139], v[64:67]
    v_mfma_f32_16x16x32_bf16 v[68:71], v[212:215], v[140:143], v[68:71]
    s_add_u32 m0, s50, 65536
    s_nop 0
    buffer_load_dwordx4 v246, s[20:23], s51 offen offset:1024 lds
    s_add_u32 s51, s51, 16384
    ds_read_b128 v[208:211], v247 offset:26624
    s_waitcnt lgkmcnt(6)
    v_mfma_f32_16x16x32_bf16 v[72:75], v[216:219], v[136:139], v[72:75]
    v_mfma_f32_16x16x32_bf16 v[76:79], v[216:219], v[140:143], v[76:79]
    s_waitcnt vmcnt(8)
    ds_read_b128 v[12:15], v10 offset:3072
    ds_read_b128 v[16:19], v10 offset:3088
    ds_read_b128 v[20:23], v10 offset:768
    ds_read_b128 v[24:27], v10 offset:784
    ds_read_b128 v[212:215], v247 offset:27648
    s_waitcnt lgkmcnt(10)
    v_mfma_f32_16x16x32_bf16 v[80:83], v[220:223], v[136:139], v[80:83]
    v_mfma_f32_16x16x32_bf16 v[84:87], v[220:223], v[140:143], v[84:87]
    s_mov_b32 s54, 10240
    buffer_load_dwordx4 v[184:187], v8, s[24:27], s54 offen offset:0
    s_waitcnt lgkmcnt(1)
    v_lshlrev_b32 v28, 16, v152
    v_and_b32 v29, 0xffff0000, v152
    v_fma_f32 v28, v28, v12, v20
    v_fma_f32 v29, v29, v13, v21
    v_cvt_pk_bf16_f32 v152, v28, v29
    ds_read_b128 v[216:219], v247 offset:28672
    v_mfma_f32_16x16x32_bf16 v[88:91], v[224:227], v[136:139], v[88:91]
    v_mfma_f32_16x16x32_bf16 v[92:95], v[224:227], v[140:143], v[92:95]
    v_lshlrev_b32 v30, 16, v153
    v_and_b32 v31, 0xffff0000, v153
    v_fma_f32 v30, v30, v14, v22
    v_fma_f32 v31, v31, v15, v23
    v_cvt_pk_bf16_f32 v153, v30, v31
    v_lshlrev_b32 v32, 16, v154
    v_and_b32 v33, 0xffff0000, v154
    v_fma_f32 v32, v32, v16, v24
    v_fma_f32 v33, v33, v17, v25
    v_cvt_pk_bf16_f32 v154, v32, v33
    ds_read_b128 v[220:223], v247 offset:29696
    v_mfma_f32_16x16x32_bf16 v[96:99], v[228:231], v[136:139], v[96:99]
    v_mfma_f32_16x16x32_bf16 v[100:103], v[228:231], v[140:143], v[100:103]
    s_mov_b32 s54, 28672
    buffer_load_dwordx4 v[188:191], v8, s[24:27], s54 offen offset:0
    v_lshlrev_b32 v34, 16, v155
    v_and_b32 v35, 0xffff0000, v155
    v_fma_f32 v34, v34, v18, v26
    v_fma_f32 v35, v35, v19, v27
    v_cvt_pk_bf16_f32 v155, v34, v35
    v_lshlrev_b32 v28, 16, v156
    v_and_b32 v29, 0xffff0000, v156
    v_fma_f32 v28, v28, v12, v20
    v_fma_f32 v29, v29, v13, v21
    v_cvt_pk_bf16_f32 v156, v28, v29
    ds_read_b128 v[224:227], v247 offset:30720
    v_mfma_f32_16x16x32_bf16 v[40:43], v[200:203], v[144:147], v[40:43]
    v_mfma_f32_16x16x32_bf16 v[44:47], v[200:203], v[148:151], v[44:47]
    v_lshlrev_b32 v30, 16, v157
    v_and_b32 v31, 0xffff0000, v157
    v_fma_f32 v30, v30, v14, v22
    v_fma_f32 v31, v31, v15, v23
    v_cvt_pk_bf16_f32 v157, v30, v31
    v_lshlrev_b32 v32, 16, v158
    v_and_b32 v33, 0xffff0000, v158
    v_fma_f32 v32, v32, v16, v24
    v_fma_f32 v33, v33, v17, v25
    v_cvt_pk_bf16_f32 v158, v32, v33
    ds_read_b128 v[228:231], v247 offset:31744
    v_mfma_f32_16x16x32_bf16 v[48:51], v[204:207], v[144:147], v[48:51]
    v_mfma_f32_16x16x32_bf16 v[52:55], v[204:207], v[148:151], v[52:55]
    s_mov_b32 s54, 10240
    buffer_load_dwordx4 v[192:195], v8, s[24:27], s54 offen offset:1024
    v_lshlrev_b32 v34, 16, v159
    v_and_b32 v35, 0xffff0000, v159
    v_fma_f32 v34, v34, v18, v26
    v_fma_f32 v35, v35, v19, v27
    v_cvt_pk_bf16_f32 v159, v34, v35
    ds_read_b128 v[12:15], v10 offset:3200
    ds_read_b128 v[16:19], v10 offset:3216
    ds_read_b128 v[20:23], v10 offset:896
    ds_read_b128 v[24:27], v10 offset:912
    v_mfma_f32_16x16x32_bf16 v[56:59], v[208:211], v[144:147], v[56:59]
    v_mfma_f32_16x16x32_bf16 v[60:63], v[208:211], v[148:151], v[60:63]
    s_waitcnt lgkmcnt(0)
    v_mfma_f32_16x16x32_bf16 v[64:67], v[212:215], v[144:147], v[64:67]
    v_mfma_f32_16x16x32_bf16 v[68:71], v[212:215], v[148:151], v[68:71]
    s_mov_b32 s54, 28672
    buffer_load_dwordx4 v[196:199], v8, s[24:27], s54 offen offset:1024
    v_lshlrev_b32 v28, 16, v160
    v_and_b32 v29, 0xffff0000, v160
    v_fma_f32 v28, v28, v12, v20
    v_fma_f32 v29, v29, v13, v21
    v_cvt_pk_bf16_f32 v160, v28, v29
    v_lshlrev_b32 v30, 16, v161
    v_and_b32 v31, 0xffff0000, v161
    v_fma_f32 v30, v30, v14, v22
    v_fma_f32 v31, v31, v15, v23
    v_cvt_pk_bf16_f32 v161, v30, v31
    v_mfma_f32_16x16x32_bf16 v[72:75], v[216:219], v[144:147], v[72:75]
    v_mfma_f32_16x16x32_bf16 v[76:79], v[216:219], v[148:151], v[76:79]
    v_lshlrev_b32 v32, 16, v162
    v_and_b32 v33, 0xffff0000, v162
    v_fma_f32 v32, v32, v16, v24
    v_fma_f32 v33, v33, v17, v25
    v_cvt_pk_bf16_f32 v162, v32, v33
    v_lshlrev_b32 v34, 16, v163
    v_and_b32 v35, 0xffff0000, v163
    v_fma_f32 v34, v34, v18, v26
    v_fma_f32 v35, v35, v19, v27
    v_cvt_pk_bf16_f32 v163, v34, v35
    v_mfma_f32_16x16x32_bf16 v[80:83], v[220:223], v[144:147], v[80:83]
    v_mfma_f32_16x16x32_bf16 v[84:87], v[220:223], v[148:151], v[84:87]
    v_lshlrev_b32 v28, 16, v164
    v_and_b32 v29, 0xffff0000, v164
    v_fma_f32 v28, v28, v12, v20
    v_fma_f32 v29, v29, v13, v21
    v_cvt_pk_bf16_f32 v164, v28, v29
    v_lshlrev_b32 v30, 16, v165
    v_and_b32 v31, 0xffff0000, v165
    v_fma_f32 v30, v30, v14, v22
    v_fma_f32 v31, v31, v15, v23
    v_cvt_pk_bf16_f32 v165, v30, v31
    v_mfma_f32_16x16x32_bf16 v[88:91], v[224:227], v[144:147], v[88:91]
    v_mfma_f32_16x16x32_bf16 v[92:95], v[224:227], v[148:151], v[92:95]
    v_lshlrev_b32 v32, 16, v166
    v_and_b32 v33, 0xffff0000, v166
    v_fma_f32 v32, v32, v16, v24
    v_fma_f32 v33, v33, v17, v25
    v_cvt_pk_bf16_f32 v166, v32, v33
    v_lshlrev_b32 v34, 16, v167
    v_and_b32 v35, 0xffff0000, v167
    v_fma_f32 v34, v34, v18, v26
    v_fma_f32 v35, v35, v19, v27
    v_cvt_pk_bf16_f32 v167, v34, v35
    v_mfma_f32_16x16x32_bf16 v[96:99], v[228:231], v[144:147], v[96:99]
    v_mfma_f32_16x16x32_bf16 v[100:103], v[228:231], v[148:151], v[100:103]
    s_barrier
    ds_read_b128 v[200:203], v247 offset:32768
    ds_read_b128 v[204:207], v247 offset:33792
    ds_read_b128 v[208:211], v247 offset:34816
    ds_read_b128 v[212:215], v247 offset:35840
    ds_read_b128 v[216:219], v247 offset:36864
    ds_read_b128 v[220:223], v247 offset:37888
    ds_read_b128 v[224:227], v247 offset:38912
    s_waitcnt lgkmcnt(6)
    v_mfma_f32_16x16x32_bf16 v[40:43], v[200:203], v[152:155], v[40:43]
    v_mfma_f32_16x16x32_bf16 v[44:47], v[200:203], v[156:159], v[44:47]
    ds_read_b128 v[228:231], v247 offset:39936
    s_waitcnt lgkmcnt(6)
    v_mfma_f32_16x16x32_bf16 v[48:51], v[204:207], v[152:155], v[48:51]
    v_mfma_f32_16x16x32_bf16 v[52:55], v[204:207], v[156:159], v[52:55]
    s_add_u32 m0, s50, 81920
    s_nop 0
    buffer_load_dwordx4 v246, s[20:23], s51 offen lds
    ds_read_b128 v[200:203], v247 offset:40960
    s_waitcnt lgkmcnt(6)
    v_mfma_f32_16x16x32_bf16 v[56:59], v[208:211], v[152:155], v[56:59]
    v_mfma_f32_16x16x32_bf16 v[60:63], v[208:211], v[156:159], v[60:63]
    ds_read_b128 v[204:207], v247 offset:41984
    s_waitcnt lgkmcnt(6)
    v_mfma_f32_16x16x32_bf16 v[64:67], v[212:215], v[152:155], v[64:67]
    v_mfma_f32_16x16x32_bf16 v[68:71], v[212:215], v[156:159], v[68:71]
    s_add_u32 m0, s50, 81920
    s_nop 0
    buffer_load_dwordx4 v246, s[20:23], s51 offen offset:1024 lds
    s_add_u32 s51, s51, 16384
    ds_read_b128 v[208:211], v247 offset:43008
    s_waitcnt lgkmcnt(6)
    v_mfma_f32_16x16x32_bf16 v[72:75], v[216:219], v[152:155], v[72:75]
    v_mfma_f32_16x16x32_bf16 v[76:79], v[216:219], v[156:159], v[76:79]
    s_waitcnt vmcnt(8)
    ds_read_b128 v[12:15], v10 offset:3328
    ds_read_b128 v[16:19], v10 offset:3344
    ds_read_b128 v[20:23], v10 offset:1024
    ds_read_b128 v[24:27], v10 offset:1040
    ds_read_b128 v[212:215], v247 offset:44032
    s_waitcnt lgkmcnt(10)
    v_mfma_f32_16x16x32_bf16 v[80:83], v[220:223], v[152:155], v[80:83]
    v_mfma_f32_16x16x32_bf16 v[84:87], v[220:223], v[156:159], v[84:87]
    s_mov_b32 s54, 12288
    buffer_load_dwordx4 v[104:107], v8, s[24:27], s54 offen offset:0
    s_waitcnt lgkmcnt(1)
    v_lshlrev_b32 v28, 16, v168
    v_and_b32 v29, 0xffff0000, v168
    v_fma_f32 v28, v28, v12, v20
    v_fma_f32 v29, v29, v13, v21
    v_cvt_pk_bf16_f32 v168, v28, v29
    ds_read_b128 v[216:219], v247 offset:45056
    v_mfma_f32_16x16x32_bf16 v[88:91], v[224:227], v[152:155], v[88:91]
    v_mfma_f32_16x16x32_bf16 v[92:95], v[224:227], v[156:159], v[92:95]
    v_lshlrev_b32 v30, 16, v169
    v_and_b32 v31, 0xffff0000, v169
    v_fma_f32 v30, v30, v14, v22
    v_fma_f32 v31, v31, v15, v23
    v_cvt_pk_bf16_f32 v169, v30, v31
    v_lshlrev_b32 v32, 16, v170
    v_and_b32 v33, 0xffff0000, v170
    v_fma_f32 v32, v32, v16, v24
    v_fma_f32 v33, v33, v17, v25
    v_cvt_pk_bf16_f32 v170, v32, v33
    ds_read_b128 v[220:223], v247 offset:46080
    v_mfma_f32_16x16x32_bf16 v[96:99], v[228:231], v[152:155], v[96:99]
    v_mfma_f32_16x16x32_bf16 v[100:103], v[228:231], v[156:159], v[100:103]
    s_mov_b32 s54, 30720
    buffer_load_dwordx4 v[108:111], v8, s[24:27], s54 offen offset:0
    v_lshlrev_b32 v34, 16, v171
    v_and_b32 v35, 0xffff0000, v171
    v_fma_f32 v34, v34, v18, v26
    v_fma_f32 v35, v35, v19, v27
    v_cvt_pk_bf16_f32 v171, v34, v35
    v_lshlrev_b32 v28, 16, v172
    v_and_b32 v29, 0xffff0000, v172
    v_fma_f32 v28, v28, v12, v20
    v_fma_f32 v29, v29, v13, v21
    v_cvt_pk_bf16_f32 v172, v28, v29
    ds_read_b128 v[224:227], v247 offset:47104
    v_mfma_f32_16x16x32_bf16 v[40:43], v[200:203], v[160:163], v[40:43]
    v_mfma_f32_16x16x32_bf16 v[44:47], v[200:203], v[164:167], v[44:47]
    v_lshlrev_b32 v30, 16, v173
    v_and_b32 v31, 0xffff0000, v173
    v_fma_f32 v30, v30, v14, v22
    v_fma_f32 v31, v31, v15, v23
    v_cvt_pk_bf16_f32 v173, v30, v31
    v_lshlrev_b32 v32, 16, v174
    v_and_b32 v33, 0xffff0000, v174
    v_fma_f32 v32, v32, v16, v24
    v_fma_f32 v33, v33, v17, v25
    v_cvt_pk_bf16_f32 v174, v32, v33
    ds_read_b128 v[228:231], v247 offset:48128
    v_mfma_f32_16x16x32_bf16 v[48:51], v[204:207], v[160:163], v[48:51]
    v_mfma_f32_16x16x32_bf16 v[52:55], v[204:207], v[164:167], v[52:55]
    s_mov_b32 s54, 12288
    buffer_load_dwordx4 v[112:115], v8, s[24:27], s54 offen offset:1024
    v_lshlrev_b32 v34, 16, v175
    v_and_b32 v35, 0xffff0000, v175
    v_fma_f32 v34, v34, v18, v26
    v_fma_f32 v35, v35, v19, v27
    v_cvt_pk_bf16_f32 v175, v34, v35
    ds_read_b128 v[12:15], v10 offset:3456
    ds_read_b128 v[16:19], v10 offset:3472
    ds_read_b128 v[20:23], v10 offset:1152
    ds_read_b128 v[24:27], v10 offset:1168
    v_mfma_f32_16x16x32_bf16 v[56:59], v[208:211], v[160:163], v[56:59]
    v_mfma_f32_16x16x32_bf16 v[60:63], v[208:211], v[164:167], v[60:63]
    s_waitcnt lgkmcnt(0)
    v_mfma_f32_16x16x32_bf16 v[64:67], v[212:215], v[160:163], v[64:67]
    v_mfma_f32_16x16x32_bf16 v[68:71], v[212:215], v[164:167], v[68:71]
    s_mov_b32 s54, 30720
    buffer_load_dwordx4 v[116:119], v8, s[24:27], s54 offen offset:1024
    v_lshlrev_b32 v28, 16, v176
    v_and_b32 v29, 0xffff0000, v176
    v_fma_f32 v28, v28, v12, v20
    v_fma_f32 v29, v29, v13, v21
    v_cvt_pk_bf16_f32 v176, v28, v29
    v_lshlrev_b32 v30, 16, v177
    v_and_b32 v31, 0xffff0000, v177
    v_fma_f32 v30, v30, v14, v22
    v_fma_f32 v31, v31, v15, v23
    v_cvt_pk_bf16_f32 v177, v30, v31
    v_mfma_f32_16x16x32_bf16 v[72:75], v[216:219], v[160:163], v[72:75]
    v_mfma_f32_16x16x32_bf16 v[76:79], v[216:219], v[164:167], v[76:79]
    v_lshlrev_b32 v32, 16, v178
    v_and_b32 v33, 0xffff0000, v178
    v_fma_f32 v32, v32, v16, v24
    v_fma_f32 v33, v33, v17, v25
    v_cvt_pk_bf16_f32 v178, v32, v33
    v_lshlrev_b32 v34, 16, v179
    v_and_b32 v35, 0xffff0000, v179
    v_fma_f32 v34, v34, v18, v26
    v_fma_f32 v35, v35, v19, v27
    v_cvt_pk_bf16_f32 v179, v34, v35
    v_mfma_f32_16x16x32_bf16 v[80:83], v[220:223], v[160:163], v[80:83]
    v_mfma_f32_16x16x32_bf16 v[84:87], v[220:223], v[164:167], v[84:87]
    v_lshlrev_b32 v28, 16, v180
    v_and_b32 v29, 0xffff0000, v180
    v_fma_f32 v28, v28, v12, v20
    v_fma_f32 v29, v29, v13, v21
    v_cvt_pk_bf16_f32 v180, v28, v29
    v_lshlrev_b32 v30, 16, v181
    v_and_b32 v31, 0xffff0000, v181
    v_fma_f32 v30, v30, v14, v22
    v_fma_f32 v31, v31, v15, v23
    v_cvt_pk_bf16_f32 v181, v30, v31
    v_mfma_f32_16x16x32_bf16 v[88:91], v[224:227], v[160:163], v[88:91]
    v_mfma_f32_16x16x32_bf16 v[92:95], v[224:227], v[164:167], v[92:95]
    v_lshlrev_b32 v32, 16, v182
    v_and_b32 v33, 0xffff0000, v182
    v_fma_f32 v32, v32, v16, v24
    v_fma_f32 v33, v33, v17, v25
    v_cvt_pk_bf16_f32 v182, v32, v33
    v_lshlrev_b32 v34, 16, v183
    v_and_b32 v35, 0xffff0000, v183
    v_fma_f32 v34, v34, v18, v26
    v_fma_f32 v35, v35, v19, v27
    v_cvt_pk_bf16_f32 v183, v34, v35
    v_mfma_f32_16x16x32_bf16 v[96:99], v[228:231], v[160:163], v[96:99]
    v_mfma_f32_16x16x32_bf16 v[100:103], v[228:231], v[164:167], v[100:103]
    s_barrier
    ds_read_b128 v[200:203], v247 offset:49152
    ds_read_b128 v[204:207], v247 offset:50176
    ds_read_b128 v[208:211], v247 offset:51200
    ds_read_b128 v[212:215], v247 offset:52224
    ds_read_b128 v[216:219], v247 offset:53248
    ds_read_b128 v[220:223], v247 offset:54272
    ds_read_b128 v[224:227], v247 offset:55296
    s_waitcnt lgkmcnt(6)
    v_mfma_f32_16x16x32_bf16 v[40:43], v[200:203], v[168:171], v[40:43]
    v_mfma_f32_16x16x32_bf16 v[44:47], v[200:203], v[172:175], v[44:47]
    ds_read_b128 v[228:231], v247 offset:56320
    s_waitcnt lgkmcnt(6)
    v_mfma_f32_16x16x32_bf16 v[48:51], v[204:207], v[168:171], v[48:51]
    v_mfma_f32_16x16x32_bf16 v[52:55], v[204:207], v[172:175], v[52:55]
    s_add_u32 m0, s50, 98304
    s_nop 0
    buffer_load_dwordx4 v246, s[20:23], s51 offen lds
    ds_read_b128 v[200:203], v247 offset:57344
    s_waitcnt lgkmcnt(6)
    v_mfma_f32_16x16x32_bf16 v[56:59], v[208:211], v[168:171], v[56:59]
    v_mfma_f32_16x16x32_bf16 v[60:63], v[208:211], v[172:175], v[60:63]
    ds_read_b128 v[204:207], v247 offset:58368
    s_waitcnt lgkmcnt(6)
    v_mfma_f32_16x16x32_bf16 v[64:67], v[212:215], v[168:171], v[64:67]
    v_mfma_f32_16x16x32_bf16 v[68:71], v[212:215], v[172:175], v[68:71]
    s_add_u32 m0, s50, 98304
    s_nop 0
    buffer_load_dwordx4 v246, s[20:23], s51 offen offset:1024 lds
    s_add_u32 s51, s51, 16384
    ds_read_b128 v[208:211], v247 offset:59392
    s_waitcnt lgkmcnt(6)
    v_mfma_f32_16x16x32_bf16 v[72:75], v[216:219], v[168:171], v[72:75]
    v_mfma_f32_16x16x32_bf16 v[76:79], v[216:219], v[172:175], v[76:79]
    s_waitcnt vmcnt(8)
    ds_read_b128 v[12:15], v10 offset:3584
    ds_read_b128 v[16:19], v10 offset:3600
    ds_read_b128 v[20:23], v10 offset:1280
    ds_read_b128 v[24:27], v10 offset:1296
    ds_read_b128 v[212:215], v247 offset:60416
    s_waitcnt lgkmcnt(10)
    v_mfma_f32_16x16x32_bf16 v[80:83], v[220:223], v[168:171], v[80:83]
    v_mfma_f32_16x16x32_bf16 v[84:87], v[220:223], v[172:175], v[84:87]
    s_mov_b32 s54, 14336
    buffer_load_dwordx4 v[120:123], v8, s[24:27], s54 offen offset:0
    s_waitcnt lgkmcnt(1)
    v_lshlrev_b32 v28, 16, v184
    v_and_b32 v29, 0xffff0000, v184
    v_fma_f32 v28, v28, v12, v20
    v_fma_f32 v29, v29, v13, v21
    v_cvt_pk_bf16_f32 v184, v28, v29
    ds_read_b128 v[216:219], v247 offset:61440
    v_mfma_f32_16x16x32_bf16 v[88:91], v[224:227], v[168:171], v[88:91]
    v_mfma_f32_16x16x32_bf16 v[92:95], v[224:227], v[172:175], v[92:95]
    v_lshlrev_b32 v30, 16, v185
    v_and_b32 v31, 0xffff0000, v185
    v_fma_f32 v30, v30, v14, v22
    v_fma_f32 v31, v31, v15, v23
    v_cvt_pk_bf16_f32 v185, v30, v31
    v_lshlrev_b32 v32, 16, v186
    v_and_b32 v33, 0xffff0000, v186
    v_fma_f32 v32, v32, v16, v24
    v_fma_f32 v33, v33, v17, v25
    v_cvt_pk_bf16_f32 v186, v32, v33
    ds_read_b128 v[220:223], v247 offset:62464
    v_mfma_f32_16x16x32_bf16 v[96:99], v[228:231], v[168:171], v[96:99]
    v_mfma_f32_16x16x32_bf16 v[100:103], v[228:231], v[172:175], v[100:103]
    s_mov_b32 s54, 32768
    buffer_load_dwordx4 v[124:127], v8, s[24:27], s54 offen offset:0
    v_lshlrev_b32 v34, 16, v187
    v_and_b32 v35, 0xffff0000, v187
    v_fma_f32 v34, v34, v18, v26
    v_fma_f32 v35, v35, v19, v27
    v_cvt_pk_bf16_f32 v187, v34, v35
    v_lshlrev_b32 v28, 16, v188
    v_and_b32 v29, 0xffff0000, v188
    v_fma_f32 v28, v28, v12, v20
    v_fma_f32 v29, v29, v13, v21
    v_cvt_pk_bf16_f32 v188, v28, v29
    ds_read_b128 v[224:227], v247 offset:63488
    v_mfma_f32_16x16x32_bf16 v[40:43], v[200:203], v[176:179], v[40:43]
    v_mfma_f32_16x16x32_bf16 v[44:47], v[200:203], v[180:183], v[44:47]
    v_lshlrev_b32 v30, 16, v189
    v_and_b32 v31, 0xffff0000, v189
    v_fma_f32 v30, v30, v14, v22
    v_fma_f32 v31, v31, v15, v23
    v_cvt_pk_bf16_f32 v189, v30, v31
    v_lshlrev_b32 v32, 16, v190
    v_and_b32 v33, 0xffff0000, v190
    v_fma_f32 v32, v32, v16, v24
    v_fma_f32 v33, v33, v17, v25
    v_cvt_pk_bf16_f32 v190, v32, v33
    ds_read_b128 v[228:231], v247 offset:64512
    v_mfma_f32_16x16x32_bf16 v[48:51], v[204:207], v[176:179], v[48:51]
    v_mfma_f32_16x16x32_bf16 v[52:55], v[204:207], v[180:183], v[52:55]
    s_mov_b32 s54, 14336
    buffer_load_dwordx4 v[128:131], v8, s[24:27], s54 offen offset:1024
    v_lshlrev_b32 v34, 16, v191
    v_and_b32 v35, 0xffff0000, v191
    v_fma_f32 v34, v34, v18, v26
    v_fma_f32 v35, v35, v19, v27
    v_cvt_pk_bf16_f32 v191, v34, v35
    ds_read_b128 v[12:15], v10 offset:3712
    ds_read_b128 v[16:19], v10 offset:3728
    ds_read_b128 v[20:23], v10 offset:1408
    ds_read_b128 v[24:27], v10 offset:1424
    v_mfma_f32_16x16x32_bf16 v[56:59], v[208:211], v[176:179], v[56:59]
    v_mfma_f32_16x16x32_bf16 v[60:63], v[208:211], v[180:183], v[60:63]
    s_waitcnt lgkmcnt(0)
    v_mfma_f32_16x16x32_bf16 v[64:67], v[212:215], v[176:179], v[64:67]
    v_mfma_f32_16x16x32_bf16 v[68:71], v[212:215], v[180:183], v[68:71]
    s_mov_b32 s54, 32768
    buffer_load_dwordx4 v[132:135], v8, s[24:27], s54 offen offset:1024
    v_lshlrev_b32 v28, 16, v192
    v_and_b32 v29, 0xffff0000, v192
    v_fma_f32 v28, v28, v12, v20
    v_fma_f32 v29, v29, v13, v21
    v_cvt_pk_bf16_f32 v192, v28, v29
    v_lshlrev_b32 v30, 16, v193
    v_and_b32 v31, 0xffff0000, v193
    v_fma_f32 v30, v30, v14, v22
    v_fma_f32 v31, v31, v15, v23
    v_cvt_pk_bf16_f32 v193, v30, v31
    v_mfma_f32_16x16x32_bf16 v[72:75], v[216:219], v[176:179], v[72:75]
    v_mfma_f32_16x16x32_bf16 v[76:79], v[216:219], v[180:183], v[76:79]
    v_lshlrev_b32 v32, 16, v194
    v_and_b32 v33, 0xffff0000, v194
    v_fma_f32 v32, v32, v16, v24
    v_fma_f32 v33, v33, v17, v25
    v_cvt_pk_bf16_f32 v194, v32, v33
    v_lshlrev_b32 v34, 16, v195
    v_and_b32 v35, 0xffff0000, v195
    v_fma_f32 v34, v34, v18, v26
    v_fma_f32 v35, v35, v19, v27
    v_cvt_pk_bf16_f32 v195, v34, v35
    v_mfma_f32_16x16x32_bf16 v[80:83], v[220:223], v[176:179], v[80:83]
    v_mfma_f32_16x16x32_bf16 v[84:87], v[220:223], v[180:183], v[84:87]
    v_lshlrev_b32 v28, 16, v196
    v_and_b32 v29, 0xffff0000, v196
    v_fma_f32 v28, v28, v12, v20
    v_fma_f32 v29, v29, v13, v21
    v_cvt_pk_bf16_f32 v196, v28, v29
    v_lshlrev_b32 v30, 16, v197
    v_and_b32 v31, 0xffff0000, v197
    v_fma_f32 v30, v30, v14, v22
    v_fma_f32 v31, v31, v15, v23
    v_cvt_pk_bf16_f32 v197, v30, v31
    v_mfma_f32_16x16x32_bf16 v[88:91], v[224:227], v[176:179], v[88:91]
    v_mfma_f32_16x16x32_bf16 v[92:95], v[224:227], v[180:183], v[92:95]
    v_lshlrev_b32 v32, 16, v198
    v_and_b32 v33, 0xffff0000, v198
    v_fma_f32 v32, v32, v16, v24
    v_fma_f32 v33, v33, v17, v25
    v_cvt_pk_bf16_f32 v198, v32, v33
    v_lshlrev_b32 v34, 16, v199
    v_and_b32 v35, 0xffff0000, v199
    v_fma_f32 v34, v34, v18, v26
    v_fma_f32 v35, v35, v19, v27
    v_cvt_pk_bf16_f32 v199, v34, v35
    v_mfma_f32_16x16x32_bf16 v[96:99], v[228:231], v[176:179], v[96:99]
    v_mfma_f32_16x16x32_bf16 v[100:103], v[228:231], v[180:183], v[100:103]
    s_barrier
    ds_read_b128 v[200:203], v247 offset:0
    ds_read_b128 v[204:207], v247 offset:1024
    ds_read_b128 v[208:211], v247 offset:2048
    ds_read_b128 v[212:215], v247 offset:3072
    ds_read_b128 v[216:219], v247 offset:4096
    ds_read_b128 v[220:223], v247 offset:5120
    ds_read_b128 v[224:227], v247 offset:6144
    s_waitcnt lgkmcnt(6)
    v_mfma_f32_16x16x32_bf16 v[40:43], v[200:203], v[184:187], v[40:43]
    v_mfma_f32_16x16x32_bf16 v[44:47], v[200:203], v[188:191], v[44:47]
    ds_read_b128 v[228:231], v247 offset:7168
    s_waitcnt lgkmcnt(6)
    v_mfma_f32_16x16x32_bf16 v[48:51], v[204:207], v[184:187], v[48:51]
    v_mfma_f32_16x16x32_bf16 v[52:55], v[204:207], v[188:191], v[52:55]
    s_add_u32 m0, s50, 114688
    s_nop 0
    buffer_load_dwordx4 v246, s[20:23], s51 offen lds
    ds_read_b128 v[200:203], v247 offset:8192
    s_waitcnt lgkmcnt(6)
    v_mfma_f32_16x16x32_bf16 v[56:59], v[208:211], v[184:187], v[56:59]
    v_mfma_f32_16x16x32_bf16 v[60:63], v[208:211], v[188:191], v[60:63]
    ds_read_b128 v[204:207], v247 offset:9216
    s_waitcnt lgkmcnt(6)
    v_mfma_f32_16x16x32_bf16 v[64:67], v[212:215], v[184:187], v[64:67]
    v_mfma_f32_16x16x32_bf16 v[68:71], v[212:215], v[188:191], v[68:71]
    s_add_u32 m0, s50, 114688
    s_nop 0
    buffer_load_dwordx4 v246, s[20:23], s51 offen offset:1024 lds
    s_add_u32 s51, s51, 16384
    ds_read_b128 v[208:211], v247 offset:10240
    s_waitcnt lgkmcnt(6)
    v_mfma_f32_16x16x32_bf16 v[72:75], v[216:219], v[184:187], v[72:75]
    v_mfma_f32_16x16x32_bf16 v[76:79], v[216:219], v[188:191], v[76:79]
    s_waitcnt vmcnt(8)
    ds_read_b128 v[12:15], v10 offset:3840
    ds_read_b128 v[16:19], v10 offset:3856
    ds_read_b128 v[20:23], v10 offset:1536
    ds_read_b128 v[24:27], v10 offset:1552
    ds_read_b128 v[212:215], v247 offset:11264
    s_waitcnt lgkmcnt(10)
    v_mfma_f32_16x16x32_bf16 v[80:83], v[220:223], v[184:187], v[80:83]
    v_mfma_f32_16x16x32_bf16 v[84:87], v[220:223], v[188:191], v[84:87]
    s_mov_b32 s54, 16384
    buffer_load_dwordx4 v[136:139], v8, s[24:27], s54 offen offset:0
    s_waitcnt lgkmcnt(1)
    v_lshlrev_b32 v28, 16, v104
    v_and_b32 v29, 0xffff0000, v104
    v_fma_f32 v28, v28, v12, v20
    v_fma_f32 v29, v29, v13, v21
    v_cvt_pk_bf16_f32 v104, v28, v29
    ds_read_b128 v[216:219], v247 offset:12288
    v_mfma_f32_16x16x32_bf16 v[88:91], v[224:227], v[184:187], v[88:91]
    v_mfma_f32_16x16x32_bf16 v[92:95], v[224:227], v[188:191], v[92:95]
    v_lshlrev_b32 v30, 16, v105
    v_and_b32 v31, 0xffff0000, v105
    v_fma_f32 v30, v30, v14, v22
    v_fma_f32 v31, v31, v15, v23
    v_cvt_pk_bf16_f32 v105, v30, v31
    v_lshlrev_b32 v32, 16, v106
    v_and_b32 v33, 0xffff0000, v106
    v_fma_f32 v32, v32, v16, v24
    v_fma_f32 v33, v33, v17, v25
    v_cvt_pk_bf16_f32 v106, v32, v33
    ds_read_b128 v[220:223], v247 offset:13312
    v_mfma_f32_16x16x32_bf16 v[96:99], v[228:231], v[184:187], v[96:99]
    v_mfma_f32_16x16x32_bf16 v[100:103], v[228:231], v[188:191], v[100:103]
    s_mov_b32 s54, 34816
    buffer_load_dwordx4 v[140:143], v8, s[24:27], s54 offen offset:0
    v_lshlrev_b32 v34, 16, v107
    v_and_b32 v35, 0xffff0000, v107
    v_fma_f32 v34, v34, v18, v26
    v_fma_f32 v35, v35, v19, v27
    v_cvt_pk_bf16_f32 v107, v34, v35
    v_lshlrev_b32 v28, 16, v108
    v_and_b32 v29, 0xffff0000, v108
    v_fma_f32 v28, v28, v12, v20
    v_fma_f32 v29, v29, v13, v21
    v_cvt_pk_bf16_f32 v108, v28, v29
    ds_read_b128 v[224:227], v247 offset:14336
    v_mfma_f32_16x16x32_bf16 v[40:43], v[200:203], v[192:195], v[40:43]
    v_mfma_f32_16x16x32_bf16 v[44:47], v[200:203], v[196:199], v[44:47]
    v_lshlrev_b32 v30, 16, v109
    v_and_b32 v31, 0xffff0000, v109
    v_fma_f32 v30, v30, v14, v22
    v_fma_f32 v31, v31, v15, v23
    v_cvt_pk_bf16_f32 v109, v30, v31
    v_lshlrev_b32 v32, 16, v110
    v_and_b32 v33, 0xffff0000, v110
    v_fma_f32 v32, v32, v16, v24
    v_fma_f32 v33, v33, v17, v25
    v_cvt_pk_bf16_f32 v110, v32, v33
    ds_read_b128 v[228:231], v247 offset:15360
    v_mfma_f32_16x16x32_bf16 v[48:51], v[204:207], v[192:195], v[48:51]
    v_mfma_f32_16x16x32_bf16 v[52:55], v[204:207], v[196:199], v[52:55]
    s_mov_b32 s54, 16384
    buffer_load_dwordx4 v[144:147], v8, s[24:27], s54 offen offset:1024
    v_lshlrev_b32 v34, 16, v111
    v_and_b32 v35, 0xffff0000, v111
    v_fma_f32 v34, v34, v18, v26
    v_fma_f32 v35, v35, v19, v27
    v_cvt_pk_bf16_f32 v111, v34, v35
    ds_read_b128 v[12:15], v10 offset:3968
    ds_read_b128 v[16:19], v10 offset:3984
    ds_read_b128 v[20:23], v10 offset:1664
    ds_read_b128 v[24:27], v10 offset:1680
    v_mfma_f32_16x16x32_bf16 v[56:59], v[208:211], v[192:195], v[56:59]
    v_mfma_f32_16x16x32_bf16 v[60:63], v[208:211], v[196:199], v[60:63]
    s_waitcnt lgkmcnt(0)
    v_mfma_f32_16x16x32_bf16 v[64:67], v[212:215], v[192:195], v[64:67]
    v_mfma_f32_16x16x32_bf16 v[68:71], v[212:215], v[196:199], v[68:71]
    s_mov_b32 s54, 34816
    buffer_load_dwordx4 v[148:151], v8, s[24:27], s54 offen offset:1024
    v_lshlrev_b32 v28, 16, v112
    v_and_b32 v29, 0xffff0000, v112
    v_fma_f32 v28, v28, v12, v20
    v_fma_f32 v29, v29, v13, v21
    v_cvt_pk_bf16_f32 v112, v28, v29
    v_lshlrev_b32 v30, 16, v113
    v_and_b32 v31, 0xffff0000, v113
    v_fma_f32 v30, v30, v14, v22
    v_fma_f32 v31, v31, v15, v23
    v_cvt_pk_bf16_f32 v113, v30, v31
    v_mfma_f32_16x16x32_bf16 v[72:75], v[216:219], v[192:195], v[72:75]
    v_mfma_f32_16x16x32_bf16 v[76:79], v[216:219], v[196:199], v[76:79]
    v_lshlrev_b32 v32, 16, v114
    v_and_b32 v33, 0xffff0000, v114
    v_fma_f32 v32, v32, v16, v24
    v_fma_f32 v33, v33, v17, v25
    v_cvt_pk_bf16_f32 v114, v32, v33
    v_lshlrev_b32 v34, 16, v115
    v_and_b32 v35, 0xffff0000, v115
    v_fma_f32 v34, v34, v18, v26
    v_fma_f32 v35, v35, v19, v27
    v_cvt_pk_bf16_f32 v115, v34, v35
    v_mfma_f32_16x16x32_bf16 v[80:83], v[220:223], v[192:195], v[80:83]
    v_mfma_f32_16x16x32_bf16 v[84:87], v[220:223], v[196:199], v[84:87]
    v_lshlrev_b32 v28, 16, v116
    v_and_b32 v29, 0xffff0000, v116
    v_fma_f32 v28, v28, v12, v20
    v_fma_f32 v29, v29, v13, v21
    v_cvt_pk_bf16_f32 v116, v28, v29
    v_lshlrev_b32 v30, 16, v117
    v_and_b32 v31, 0xffff0000, v117
    v_fma_f32 v30, v30, v14, v22
    v_fma_f32 v31, v31, v15, v23
    v_cvt_pk_bf16_f32 v117, v30, v31
    v_mfma_f32_16x16x32_bf16 v[88:91], v[224:227], v[192:195], v[88:91]
    v_mfma_f32_16x16x32_bf16 v[92:95], v[224:227], v[196:199], v[92:95]
    v_lshlrev_b32 v32, 16, v118
    v_and_b32 v33, 0xffff0000, v118
    v_fma_f32 v32, v32, v16, v24
    v_fma_f32 v33, v33, v17, v25
    v_cvt_pk_bf16_f32 v118, v32, v33
    v_lshlrev_b32 v34, 16, v119
    v_and_b32 v35, 0xffff0000, v119
    v_fma_f32 v34, v34, v18, v26
    v_fma_f32 v35, v35, v19, v27
    v_cvt_pk_bf16_f32 v119, v34, v35
    v_mfma_f32_16x16x32_bf16 v[96:99], v[228:231], v[192:195], v[96:99]
    v_mfma_f32_16x16x32_bf16 v[100:103], v[228:231], v[196:199], v[100:103]
    s_barrier
    ds_read_b128 v[200:203], v247 offset:16384
    ds_read_b128 v[204:207], v247 offset:17408
    ds_read_b128 v[208:211], v247 offset:18432
    ds_read_b128 v[212:215], v247 offset:19456
    ds_read_b128 v[216:219], v247 offset:20480
    ds_read_b128 v[220:223], v247 offset:21504
    ds_read_b128 v[224:227], v247 offset:22528
    s_waitcnt lgkmcnt(6)
    v_mfma_f32_16x16x32_bf16 v[40:43], v[200:203], v[104:107], v[40:43]
    v_mfma_f32_16x16x32_bf16 v[44:47], v[200:203], v[108:111], v[44:47]
    ds_read_b128 v[228:231], v247 offset:23552
    s_waitcnt lgkmcnt(6)
    v_mfma_f32_16x16x32_bf16 v[48:51], v[204:207], v[104:107], v[48:51]
    v_mfma_f32_16x16x32_bf16 v[52:55], v[204:207], v[108:111], v[52:55]
    s_cmp_ge_u32 s52, s57
    s_cselect_b32 s58, s59, s52
    s_add_u32 m0, s50, 0
    s_nop 0
    buffer_load_dwordx4 v244, s[12:15], s58 offen lds
    ds_read_b128 v[200:203], v247 offset:24576
    s_waitcnt lgkmcnt(6)
    v_mfma_f32_16x16x32_bf16 v[56:59], v[208:211], v[104:107], v[56:59]
    v_mfma_f32_16x16x32_bf16 v[60:63], v[208:211], v[108:111], v[60:63]
    ds_read_b128 v[204:207], v247 offset:25600
    s_waitcnt lgkmcnt(6)
    v_mfma_f32_16x16x32_bf16 v[64:67], v[212:215], v[104:107], v[64:67]
    v_mfma_f32_16x16x32_bf16 v[68:71], v[212:215], v[108:111], v[68:71]
    s_add_u32 m0, s50, 1024
    s_nop 0
    buffer_load_dwordx4 v245, s[12:15], s58 offen lds
    s_add_u32 s52, s52, 16384
    ds_read_b128 v[208:211], v247 offset:26624
    s_waitcnt lgkmcnt(6)
    v_mfma_f32_16x16x32_bf16 v[72:75], v[216:219], v[104:107], v[72:75]
    v_mfma_f32_16x16x32_bf16 v[76:79], v[216:219], v[108:111], v[76:79]
    s_waitcnt vmcnt(8)
    ds_read_b128 v[12:15], v10 offset:4096
    ds_read_b128 v[16:19], v10 offset:4112
    ds_read_b128 v[20:23], v10 offset:1792
    ds_read_b128 v[24:27], v10 offset:1808
    ds_read_b128 v[212:215], v247 offset:27648
    s_waitcnt lgkmcnt(10)
    v_mfma_f32_16x16x32_bf16 v[80:83], v[220:223], v[104:107], v[80:83]
    v_mfma_f32_16x16x32_bf16 v[84:87], v[220:223], v[108:111], v[84:87]
    s_cmp_ge_u32 s52, s57
    s_cselect_b32 s58, s59, s52
    s_add_u32 m0, s50, 16384
    s_nop 0
    buffer_load_dwordx4 v244, s[12:15], s58 offen lds
    s_waitcnt lgkmcnt(1)
    v_lshlrev_b32 v28, 16, v120
    v_and_b32 v29, 0xffff0000, v120
    v_fma_f32 v28, v28, v12, v20
    v_fma_f32 v29, v29, v13, v21
    v_cvt_pk_bf16_f32 v120, v28, v29
    ds_read_b128 v[216:219], v247 offset:28672
    v_mfma_f32_16x16x32_bf16 v[88:91], v[224:227], v[104:107], v[88:91]
    v_mfma_f32_16x16x32_bf16 v[92:95], v[224:227], v[108:111], v[92:95]
    v_lshlrev_b32 v30, 16, v121
    v_and_b32 v31, 0xffff0000, v121
    v_fma_f32 v30, v30, v14, v22
    v_fma_f32 v31, v31, v15, v23
    v_cvt_pk_bf16_f32 v121, v30, v31
    v_lshlrev_b32 v32, 16, v122
    v_and_b32 v33, 0xffff0000, v122
    v_fma_f32 v32, v32, v16, v24
    v_fma_f32 v33, v33, v17, v25
    v_cvt_pk_bf16_f32 v122, v32, v33
    ds_read_b128 v[220:223], v247 offset:29696
    v_mfma_f32_16x16x32_bf16 v[96:99], v[228:231], v[104:107], v[96:99]
    v_mfma_f32_16x16x32_bf16 v[100:103], v[228:231], v[108:111], v[100:103]
    s_add_u32 m0, s50, 17408
    s_nop 0
    buffer_load_dwordx4 v245, s[12:15], s58 offen lds
    s_add_u32 s52, s52, 16384
    v_lshlrev_b32 v34, 16, v123
    v_and_b32 v35, 0xffff0000, v123
    v_fma_f32 v34, v34, v18, v26
    v_fma_f32 v35, v35, v19, v27
    v_cvt_pk_bf16_f32 v123, v34, v35
    v_lshlrev_b32 v28, 16, v124
    v_and_b32 v29, 0xffff0000, v124
    v_fma_f32 v28, v28, v12, v20
    v_fma_f32 v29, v29, v13, v21
    v_cvt_pk_bf16_f32 v124, v28, v29
    ds_read_b128 v[224:227], v247 offset:30720
    v_mfma_f32_16x16x32_bf16 v[40:43], v[200:203], v[112:115], v[40:43]
    v_mfma_f32_16x16x32_bf16 v[44:47], v[200:203], v[116:119], v[44:47]
    v_lshlrev_b32 v30, 16, v125
    v_and_b32 v31, 0xffff0000, v125
    v_fma_f32 v30, v30, v14, v22
    v_fma_f32 v31, v31, v15, v23
    v_cvt_pk_bf16_f32 v125, v30, v31
    v_lshlrev_b32 v32, 16, v126
    v_and_b32 v33, 0xffff0000, v126
    v_fma_f32 v32, v32, v16, v24
    v_fma_f32 v33, v33, v17, v25
    v_cvt_pk_bf16_f32 v126, v32, v33
    ds_read_b128 v[228:231], v247 offset:31744
    v_mfma_f32_16x16x32_bf16 v[48:51], v[204:207], v[112:115], v[48:51]
    v_mfma_f32_16x16x32_bf16 v[52:55], v[204:207], v[116:119], v[52:55]
    s_cmp_ge_u32 s53, s57
    s_cselect_b32 s55, s59, s53
    s_add_u32 m0, s50, 65536
    s_nop 0
    buffer_load_dwordx4 v246, s[16:19], s55 offen lds
    v_lshlrev_b32 v34, 16, v127
    v_and_b32 v35, 0xffff0000, v127
    v_fma_f32 v34, v34, v18, v26
    v_fma_f32 v35, v35, v19, v27
    v_cvt_pk_bf16_f32 v127, v34, v35
    ds_read_b128 v[12:15], v10 offset:4224
    ds_read_b128 v[16:19], v10 offset:4240
    ds_read_b128 v[20:23], v10 offset:1920
    ds_read_b128 v[24:27], v10 offset:1936
    v_mfma_f32_16x16x32_bf16 v[56:59], v[208:211], v[112:115], v[56:59]
    v_mfma_f32_16x16x32_bf16 v[60:63], v[208:211], v[116:119], v[60:63]
    s_waitcnt lgkmcnt(0)
    v_mfma_f32_16x16x32_bf16 v[64:67], v[212:215], v[112:115], v[64:67]
    v_mfma_f32_16x16x32_bf16 v[68:71], v[212:215], v[116:119], v[68:71]
    s_add_u32 m0, s50, 65536
    s_nop 0
    buffer_load_dwordx4 v246, s[16:19], s55 offen offset:1024 lds
    s_add_u32 s53, s53, 16384
    v_lshlrev_b32 v28, 16, v128
    v_and_b32 v29, 0xffff0000, v128
    v_fma_f32 v28, v28, v12, v20
    v_fma_f32 v29, v29, v13, v21
    v_cvt_pk_bf16_f32 v128, v28, v29
    v_lshlrev_b32 v30, 16, v129
    v_and_b32 v31, 0xffff0000, v129
    v_fma_f32 v30, v30, v14, v22
    v_fma_f32 v31, v31, v15, v23
    v_cvt_pk_bf16_f32 v129, v30, v31
    v_mfma_f32_16x16x32_bf16 v[72:75], v[216:219], v[112:115], v[72:75]
    v_mfma_f32_16x16x32_bf16 v[76:79], v[216:219], v[116:119], v[76:79]
    v_lshlrev_b32 v32, 16, v130
    v_and_b32 v33, 0xffff0000, v130
    v_fma_f32 v32, v32, v16, v24
    v_fma_f32 v33, v33, v17, v25
    v_cvt_pk_bf16_f32 v130, v32, v33
    v_lshlrev_b32 v34, 16, v131
    v_and_b32 v35, 0xffff0000, v131
    v_fma_f32 v34, v34, v18, v26
    v_fma_f32 v35, v35, v19, v27
    v_cvt_pk_bf16_f32 v131, v34, v35
    v_mfma_f32_16x16x32_bf16 v[80:83], v[220:223], v[112:115], v[80:83]
    v_mfma_f32_16x16x32_bf16 v[84:87], v[220:223], v[116:119], v[84:87]
    v_lshlrev_b32 v28, 16, v132
    v_and_b32 v29, 0xffff0000, v132
    v_fma_f32 v28, v28, v12, v20
    v_fma_f32 v29, v29, v13, v21
    v_cvt_pk_bf16_f32 v132, v28, v29
    v_lshlrev_b32 v30, 16, v133
    v_and_b32 v31, 0xffff0000, v133
    v_fma_f32 v30, v30, v14, v22
    v_fma_f32 v31, v31, v15, v23
    v_cvt_pk_bf16_f32 v133, v30, v31
    v_mfma_f32_16x16x32_bf16 v[88:91], v[224:227], v[112:115], v[88:91]
    v_mfma_f32_16x16x32_bf16 v[92:95], v[224:227], v[116:119], v[92:95]
    v_lshlrev_b32 v32, 16, v134
    v_and_b32 v33, 0xffff0000, v134
    v_fma_f32 v32, v32, v16, v24
    v_fma_f32 v33, v33, v17, v25
    v_cvt_pk_bf16_f32 v134, v32, v33
    v_lshlrev_b32 v34, 16, v135
    v_and_b32 v35, 0xffff0000, v135
    v_fma_f32 v34, v34, v18, v26
    v_fma_f32 v35, v35, v19, v27
    v_cvt_pk_bf16_f32 v135, v34, v35
    v_mfma_f32_16x16x32_bf16 v[96:99], v[228:231], v[112:115], v[96:99]
    v_mfma_f32_16x16x32_bf16 v[100:103], v[228:231], v[116:119], v[100:103]
    s_barrier
    ds_read_b128 v[200:203], v247 offset:32768
    ds_read_b128 v[204:207], v247 offset:33792
    ds_read_b128 v[208:211], v247 offset:34816
    ds_read_b128 v[212:215], v247 offset:35840
    ds_read_b128 v[216:219], v247 offset:36864
    ds_read_b128 v[220:223], v247 offset:37888
    ds_read_b128 v[224:227], v247 offset:38912
    s_waitcnt lgkmcnt(6)
    v_mfma_f32_16x16x32_bf16 v[40:43], v[200:203], v[120:123], v[40:43]
    v_mfma_f32_16x16x32_bf16 v[44:47], v[200:203], v[124:127], v[44:47]
    ds_read_b128 v[228:231], v247 offset:39936
    s_waitcnt lgkmcnt(6)
    v_mfma_f32_16x16x32_bf16 v[48:51], v[204:207], v[120:123], v[48:51]
    v_mfma_f32_16x16x32_bf16 v[52:55], v[204:207], v[124:127], v[52:55]
    s_cmp_ge_u32 s52, s57
    s_cselect_b32 s58, s59, s52
    s_add_u32 m0, s50, 32768
    s_nop 0
    buffer_load_dwordx4 v244, s[12:15], s58 offen lds
    ds_read_b128 v[200:203], v247 offset:40960
    s_waitcnt lgkmcnt(6)
    v_mfma_f32_16x16x32_bf16 v[56:59], v[208:211], v[120:123], v[56:59]
    v_mfma_f32_16x16x32_bf16 v[60:63], v[208:211], v[124:127], v[60:63]
    ds_read_b128 v[204:207], v247 offset:41984
    s_waitcnt lgkmcnt(6)
    v_mfma_f32_16x16x32_bf16 v[64:67], v[212:215], v[120:123], v[64:67]
    v_mfma_f32_16x16x32_bf16 v[68:71], v[212:215], v[124:127], v[68:71]
    s_add_u32 m0, s50, 33792
    s_nop 0
    buffer_load_dwordx4 v245, s[12:15], s58 offen lds
    s_add_u32 s52, s52, 16384
    ds_read_b128 v[208:211], v247 offset:43008
    s_waitcnt lgkmcnt(6)
    v_mfma_f32_16x16x32_bf16 v[72:75], v[216:219], v[120:123], v[72:75]
    v_mfma_f32_16x16x32_bf16 v[76:79], v[216:219], v[124:127], v[76:79]
    s_waitcnt vmcnt(8)
    ds_read_b128 v[12:15], v10 offset:4352
    ds_read_b128 v[16:19], v10 offset:4368
    ds_read_b128 v[20:23], v10 offset:2048
    ds_read_b128 v[24:27], v10 offset:2064
    ds_read_b128 v[212:215], v247 offset:44032
    s_waitcnt lgkmcnt(10)
    v_mfma_f32_16x16x32_bf16 v[80:83], v[220:223], v[120:123], v[80:83]
    v_mfma_f32_16x16x32_bf16 v[84:87], v[220:223], v[124:127], v[84:87]
    s_cmp_ge_u32 s53, s57
    s_cselect_b32 s55, s59, s53
    s_add_u32 m0, s50, 81920
    s_nop 0
    buffer_load_dwordx4 v246, s[16:19], s55 offen lds
    s_waitcnt lgkmcnt(1)
    v_lshlrev_b32 v28, 16, v136
    v_and_b32 v29, 0xffff0000, v136
    v_fma_f32 v28, v28, v12, v20
    v_fma_f32 v29, v29, v13, v21
    v_cvt_pk_bf16_f32 v136, v28, v29
    ds_read_b128 v[216:219], v247 offset:45056
    v_mfma_f32_16x16x32_bf16 v[88:91], v[224:227], v[120:123], v[88:91]
    v_mfma_f32_16x16x32_bf16 v[92:95], v[224:227], v[124:127], v[92:95]
    v_lshlrev_b32 v30, 16, v137
    v_and_b32 v31, 0xffff0000, v137
    v_fma_f32 v30, v30, v14, v22
    v_fma_f32 v31, v31, v15, v23
    v_cvt_pk_bf16_f32 v137, v30, v31
    v_lshlrev_b32 v32, 16, v138
    v_and_b32 v33, 0xffff0000, v138
    v_fma_f32 v32, v32, v16, v24
    v_fma_f32 v33, v33, v17, v25
    v_cvt_pk_bf16_f32 v138, v32, v33
    ds_read_b128 v[220:223], v247 offset:46080
    v_mfma_f32_16x16x32_bf16 v[96:99], v[228:231], v[120:123], v[96:99]
    v_mfma_f32_16x16x32_bf16 v[100:103], v[228:231], v[124:127], v[100:103]
    s_add_u32 m0, s50, 81920
    s_nop 0
    buffer_load_dwordx4 v246, s[16:19], s55 offen offset:1024 lds
    s_add_u32 s53, s53, 16384
    v_lshlrev_b32 v34, 16, v139
    v_and_b32 v35, 0xffff0000, v139
    v_fma_f32 v34, v34, v18, v26
    v_fma_f32 v35, v35, v19, v27
    v_cvt_pk_bf16_f32 v139, v34, v35
    v_lshlrev_b32 v28, 16, v140
    v_and_b32 v29, 0xffff0000, v140
    v_fma_f32 v28, v28, v12, v20
    v_fma_f32 v29, v29, v13, v21
    v_cvt_pk_bf16_f32 v140, v28, v29
    ds_read_b128 v[224:227], v247 offset:47104
    v_mfma_f32_16x16x32_bf16 v[40:43], v[200:203], v[128:131], v[40:43]
    v_mfma_f32_16x16x32_bf16 v[44:47], v[200:203], v[132:135], v[44:47]
    v_lshlrev_b32 v30, 16, v141
    v_and_b32 v31, 0xffff0000, v141
    v_fma_f32 v30, v30, v14, v22
    v_fma_f32 v31, v31, v15, v23
    v_cvt_pk_bf16_f32 v141, v30, v31
    v_lshlrev_b32 v32, 16, v142
    v_and_b32 v33, 0xffff0000, v142
    v_fma_f32 v32, v32, v16, v24
    v_fma_f32 v33, v33, v17, v25
    v_cvt_pk_bf16_f32 v142, v32, v33
    ds_read_b128 v[228:231], v247 offset:48128
    v_mfma_f32_16x16x32_bf16 v[48:51], v[204:207], v[128:131], v[48:51]
    v_mfma_f32_16x16x32_bf16 v[52:55], v[204:207], v[132:135], v[52:55]
    v_lshlrev_b32 v34, 16, v143
    v_and_b32 v35, 0xffff0000, v143
    v_fma_f32 v34, v34, v18, v26
    v_fma_f32 v35, v35, v19, v27
    v_cvt_pk_bf16_f32 v143, v34, v35
    ds_read_b128 v[12:15], v10 offset:4480
    ds_read_b128 v[16:19], v10 offset:4496
    ds_read_b128 v[20:23], v10 offset:2176
    ds_read_b128 v[24:27], v10 offset:2192
    v_mfma_f32_16x16x32_bf16 v[56:59], v[208:211], v[128:131], v[56:59]
    v_mfma_f32_16x16x32_bf16 v[60:63], v[208:211], v[132:135], v[60:63]
    s_waitcnt lgkmcnt(0)
    v_mfma_f32_16x16x32_bf16 v[64:67], v[212:215], v[128:131], v[64:67]
    v_mfma_f32_16x16x32_bf16 v[68:71], v[212:215], v[132:135], v[68:71]
    v_lshlrev_b32 v28, 16, v144
    v_and_b32 v29, 0xffff0000, v144
    v_fma_f32 v28, v28, v12, v20
    v_fma_f32 v29, v29, v13, v21
    v_cvt_pk_bf16_f32 v144, v28, v29
    v_lshlrev_b32 v30, 16, v145
    v_and_b32 v31, 0xffff0000, v145
    v_fma_f32 v30, v30, v14, v22
    v_fma_f32 v31, v31, v15, v23
    v_cvt_pk_bf16_f32 v145, v30, v31
    v_mfma_f32_16x16x32_bf16 v[72:75], v[216:219], v[128:131], v[72:75]
    v_mfma_f32_16x16x32_bf16 v[76:79], v[216:219], v[132:135], v[76:79]
    v_lshlrev_b32 v32, 16, v146
    v_and_b32 v33, 0xffff0000, v146
    v_fma_f32 v32, v32, v16, v24
    v_fma_f32 v33, v33, v17, v25
    v_cvt_pk_bf16_f32 v146, v32, v33
    v_lshlrev_b32 v34, 16, v147
    v_and_b32 v35, 0xffff0000, v147
    v_fma_f32 v34, v34, v18, v26
    v_fma_f32 v35, v35, v19, v27
    v_cvt_pk_bf16_f32 v147, v34, v35
    v_mfma_f32_16x16x32_bf16 v[80:83], v[220:223], v[128:131], v[80:83]
    v_mfma_f32_16x16x32_bf16 v[84:87], v[220:223], v[132:135], v[84:87]
    v_lshlrev_b32 v28, 16, v148
    v_and_b32 v29, 0xffff0000, v148
    v_fma_f32 v28, v28, v12, v20
    v_fma_f32 v29, v29, v13, v21
    v_cvt_pk_bf16_f32 v148, v28, v29
    v_lshlrev_b32 v30, 16, v149
    v_and_b32 v31, 0xffff0000, v149
    v_fma_f32 v30, v30, v14, v22
    v_fma_f32 v31, v31, v15, v23
    v_cvt_pk_bf16_f32 v149, v30, v31
    v_mfma_f32_16x16x32_bf16 v[88:91], v[224:227], v[128:131], v[88:91]
    v_mfma_f32_16x16x32_bf16 v[92:95], v[224:227], v[132:135], v[92:95]
    v_lshlrev_b32 v32, 16, v150
    v_and_b32 v33, 0xffff0000, v150
    v_fma_f32 v32, v32, v16, v24
    v_fma_f32 v33, v33, v17, v25
    v_cvt_pk_bf16_f32 v150, v32, v33
    v_lshlrev_b32 v34, 16, v151
    v_and_b32 v35, 0xffff0000, v151
    v_fma_f32 v34, v34, v18, v26
    v_fma_f32 v35, v35, v19, v27
    v_cvt_pk_bf16_f32 v151, v34, v35
    v_mfma_f32_16x16x32_bf16 v[96:99], v[228:231], v[128:131], v[96:99]
    v_mfma_f32_16x16x32_bf16 v[100:103], v[228:231], v[132:135], v[100:103]
    s_barrier
    ds_read_b128 v[200:203], v247 offset:49152
    ds_read_b128 v[204:207], v247 offset:50176
    ds_read_b128 v[208:211], v247 offset:51200
    ds_read_b128 v[212:215], v247 offset:52224
    ds_read_b128 v[216:219], v247 offset:53248
    ds_read_b128 v[220:223], v247 offset:54272
    ds_read_b128 v[224:227], v247 offset:55296
    s_waitcnt lgkmcnt(6)
    v_mfma_f32_16x16x32_bf16 v[40:43], v[200:203], v[136:139], v[40:43]
    v_mfma_f32_16x16x32_bf16 v[44:47], v[200:203], v[140:143], v[44:47]
    ds_read_b128 v[228:231], v247 offset:56320
    s_waitcnt lgkmcnt(6)
    v_mfma_f32_16x16x32_bf16 v[48:51], v[204:207], v[136:139], v[48:51]
    v_mfma_f32_16x16x32_bf16 v[52:55], v[204:207], v[140:143], v[52:55]
    s_cmp_ge_u32 s52, s57
    s_cselect_b32 s58, s59, s52
    s_add_u32 m0, s50, 49152
    s_nop 0
    buffer_load_dwordx4 v244, s[12:15], s58 offen lds
    ds_read_b128 v[200:203], v247 offset:57344
    s_waitcnt lgkmcnt(6)
    v_mfma_f32_16x16x32_bf16 v[56:59], v[208:211], v[136:139], v[56:59]
    v_mfma_f32_16x16x32_bf16 v[60:63], v[208:211], v[140:143], v[60:63]
    ds_read_b128 v[204:207], v247 offset:58368
    s_waitcnt lgkmcnt(6)
    v_mfma_f32_16x16x32_bf16 v[64:67], v[212:215], v[136:139], v[64:67]
    v_mfma_f32_16x16x32_bf16 v[68:71], v[212:215], v[140:143], v[68:71]
    s_add_u32 m0, s50, 50176
    s_nop 0
    buffer_load_dwordx4 v245, s[12:15], s58 offen lds
    s_add_u32 s52, s52, 16384
    ds_read_b128 v[208:211], v247 offset:59392
    s_waitcnt lgkmcnt(6)
    v_mfma_f32_16x16x32_bf16 v[72:75], v[216:219], v[136:139], v[72:75]
    v_mfma_f32_16x16x32_bf16 v[76:79], v[216:219], v[140:143], v[76:79]
    ds_read_b128 v[212:215], v247 offset:60416
    s_waitcnt lgkmcnt(6)
    v_mfma_f32_16x16x32_bf16 v[80:83], v[220:223], v[136:139], v[80:83]
    v_mfma_f32_16x16x32_bf16 v[84:87], v[220:223], v[140:143], v[84:87]
    s_cmp_ge_u32 s53, s57
    s_cselect_b32 s55, s59, s53
    s_add_u32 m0, s50, 98304
    s_nop 0
    buffer_load_dwordx4 v246, s[16:19], s55 offen lds
    ds_read_b128 v[216:219], v247 offset:61440
    s_waitcnt lgkmcnt(6)
    v_mfma_f32_16x16x32_bf16 v[88:91], v[224:227], v[136:139], v[88:91]
    v_mfma_f32_16x16x32_bf16 v[92:95], v[224:227], v[140:143], v[92:95]
    ds_read_b128 v[220:223], v247 offset:62464
    s_waitcnt lgkmcnt(6)
    v_mfma_f32_16x16x32_bf16 v[96:99], v[228:231], v[136:139], v[96:99]
    v_mfma_f32_16x16x32_bf16 v[100:103], v[228:231], v[140:143], v[100:103]
    s_add_u32 m0, s50, 98304
    s_nop 0
    buffer_load_dwordx4 v246, s[16:19], s55 offen offset:1024 lds
    s_add_u32 s53, s53, 16384
    ds_read_b128 v[224:227], v247 offset:63488
    s_waitcnt lgkmcnt(6)
    v_mfma_f32_16x16x32_bf16 v[40:43], v[200:203], v[144:147], v[40:43]
    v_mfma_f32_16x16x32_bf16 v[44:47], v[200:203], v[148:151], v[44:47]
    ds_read_b128 v[228:231], v247 offset:64512
    s_waitcnt lgkmcnt(6)
    v_mfma_f32_16x16x32_bf16 v[48:51], v[204:207], v[144:147], v[48:51]
    v_mfma_f32_16x16x32_bf16 v[52:55], v[204:207], v[148:151], v[52:55]
    s_waitcnt lgkmcnt(5)
    v_mfma_f32_16x16x32_bf16 v[56:59], v[208:211], v[144:147], v[56:59]
    v_mfma_f32_16x16x32_bf16 v[60:63], v[208:211], v[148:151], v[60:63]
    s_waitcnt lgkmcnt(4)
    v_mfma_f32_16x16x32_bf16 v[64:67], v[212:215], v[144:147], v[64:67]
    v_mfma_f32_16x16x32_bf16 v[68:71], v[212:215], v[148:151], v[68:71]
    s_waitcnt lgkmcnt(3)
    v_mfma_f32_16x16x32_bf16 v[72:75], v[216:219], v[144:147], v[72:75]
    v_mfma_f32_16x16x32_bf16 v[76:79], v[216:219], v[148:151], v[76:79]
    s_waitcnt lgkmcnt(2)
    v_mfma_f32_16x16x32_bf16 v[80:83], v[220:223], v[144:147], v[80:83]
    v_mfma_f32_16x16x32_bf16 v[84:87], v[220:223], v[148:151], v[84:87]
    s_waitcnt lgkmcnt(1)
    v_mfma_f32_16x16x32_bf16 v[88:91], v[224:227], v[144:147], v[88:91]
    v_mfma_f32_16x16x32_bf16 v[92:95], v[224:227], v[148:151], v[92:95]
    s_waitcnt lgkmcnt(0)
    v_mfma_f32_16x16x32_bf16 v[96:99], v[228:231], v[144:147], v[96:99]
    v_mfma_f32_16x16x32_bf16 v[100:103], v[228:231], v[148:151], v[100:103]
    v_cmp_gt_u32 vcc, 32, v2
    v_mul_f32 v40, s62, v40
    v_mul_f32 v48, s62, v48
    v_mul_f32 v41, s62, v41
    v_mul_f32 v49, s62, v49
    v_mul_f32 v42, s62, v42
    v_mul_f32 v50, s62, v50
    v_mul_f32 v43, s62, v43
    v_mul_f32 v51, s62, v51
    v_cvt_pk_bf16_f32 v8, v40, v41
    v_cvt_pk_bf16_f32 v9, v42, v43
    v_cvt_pk_bf16_f32 v10, v48, v49
    v_cvt_pk_bf16_f32 v11, v50, v51
    v_mul_f32 v56, s62, v56
    v_mul_f32 v64, s62, v64
    v_mul_f32 v57, s62, v57
    v_mul_f32 v65, s62, v65
    v_mul_f32 v58, s62, v58
    v_mul_f32 v66, s62, v66
    v_mul_f32 v59, s62, v59
    v_mul_f32 v67, s62, v67
    v_cvt_pk_bf16_f32 v12, v56, v57
    v_cvt_pk_bf16_f32 v13, v58, v59
    v_cvt_pk_bf16_f32 v14, v64, v65
    v_cvt_pk_bf16_f32 v15, v66, v67
    v_mul_f32 v72, s62, v72
    v_mul_f32 v80, s62, v80
    v_mul_f32 v73, s62, v73
    v_mul_f32 v81, s62, v81
    v_mul_f32 v74, s62, v74
    v_mul_f32 v82, s62, v82
    v_mul_f32 v75, s62, v75
    v_mul_f32 v83, s62, v83
    v_cvt_pk_bf16_f32 v16, v72, v73
    v_cvt_pk_bf16_f32 v17, v74, v75
    v_cvt_pk_bf16_f32 v18, v80, v81
    v_cvt_pk_bf16_f32 v19, v82, v83
    v_mul_f32 v88, s62, v88
    v_mul_f32 v96, s62, v96
    v_mul_f32 v89, s62, v89
    v_mul_f32 v97, s62, v97
    v_mul_f32 v90, s62, v90
    v_mul_f32 v98, s62, v98
    v_mul_f32 v91, s62, v91
    v_mul_f32 v99, s62, v99
    v_cvt_pk_bf16_f32 v20, v88, v89
    v_cvt_pk_bf16_f32 v21, v90, v91
    v_cvt_pk_bf16_f32 v22, v96, v97
    v_cvt_pk_bf16_f32 v23, v98, v99
    v_mul_f32 v44, s62, v44
    v_mul_f32 v52, s62, v52
    v_mul_f32 v45, s62, v45
    v_mul_f32 v53, s62, v53
    v_mul_f32 v46, s62, v46
    v_mul_f32 v54, s62, v54
    v_mul_f32 v47, s62, v47
    v_mul_f32 v55, s62, v55
    v_cvt_pk_bf16_f32 v24, v44, v45
    v_cvt_pk_bf16_f32 v25, v46, v47
    v_cvt_pk_bf16_f32 v26, v52, v53
    v_cvt_pk_bf16_f32 v27, v54, v55
    v_mul_f32 v60, s62, v60
    v_mul_f32 v68, s62, v68
    v_mul_f32 v61, s62, v61
    v_mul_f32 v69, s62, v69
    v_mul_f32 v62, s62, v62
    v_mul_f32 v70, s62, v70
    v_mul_f32 v63, s62, v63
    v_mul_f32 v71, s62, v71
    v_cvt_pk_bf16_f32 v28, v60, v61
    v_cvt_pk_bf16_f32 v29, v62, v63
    v_cvt_pk_bf16_f32 v30, v68, v69
    v_cvt_pk_bf16_f32 v31, v70, v71
    v_mul_f32 v76, s62, v76
    v_mul_f32 v84, s62, v84
    v_mul_f32 v77, s62, v77
    v_mul_f32 v85, s62, v85
    v_mul_f32 v78, s62, v78
    v_mul_f32 v86, s62, v86
    v_mul_f32 v79, s62, v79
    v_mul_f32 v87, s62, v87
    v_cvt_pk_bf16_f32 v32, v76, v77
    v_cvt_pk_bf16_f32 v33, v78, v79
    v_cvt_pk_bf16_f32 v34, v84, v85
    v_cvt_pk_bf16_f32 v35, v86, v87
    v_mul_f32 v92, s62, v92
    v_mul_f32 v100, s62, v100
    v_mul_f32 v93, s62, v93
    v_mul_f32 v101, s62, v101
    v_mul_f32 v94, s62, v94
    v_mul_f32 v102, s62, v102
    v_mul_f32 v95, s62, v95
    v_mul_f32 v103, s62, v103
    v_cvt_pk_bf16_f32 v36, v92, v93
    v_cvt_pk_bf16_f32 v37, v94, v95
    v_cvt_pk_bf16_f32 v38, v100, v101
    v_cvt_pk_bf16_f32 v39, v102, v103
    v_mov_b32 v40, 0
    v_mov_b32 v41, 0
    v_mov_b32 v42, 0
    v_mov_b32 v43, 0
    v_mov_b32 v44, 0
    v_mov_b32 v45, 0
    v_mov_b32 v46, 0
    v_mov_b32 v47, 0
    v_mov_b32 v48, 0
    v_mov_b32 v49, 0
    v_mov_b32 v50, 0
    v_mov_b32 v51, 0
    v_mov_b32 v52, 0
    v_mov_b32 v53, 0
    v_mov_b32 v54, 0
    v_mov_b32 v55, 0
    v_mov_b32 v56, 0
    v_mov_b32 v57, 0
    v_mov_b32 v58, 0
    v_mov_b32 v59, 0
    v_mov_b32 v60, 0
    v_mov_b32 v61, 0
    v_mov_b32 v62, 0
    v_mov_b32 v63, 0
    v_mov_b32 v64, 0
    v_mov_b32 v65, 0
    v_mov_b32 v66, 0
    v_mov_b32 v67, 0
    v_mov_b32 v68, 0
    v_mov_b32 v69, 0
    v_mov_b32 v70, 0
    v_mov_b32 v71, 0
    v_mov_b32 v72, 0
    v_mov_b32 v73, 0
    v_mov_b32 v74, 0
    v_mov_b32 v75, 0
    v_mov_b32 v76, 0
    v_mov_b32 v77, 0
    v_mov_b32 v78, 0
    v_mov_b32 v79, 0
    v_mov_b32 v80, 0
    v_mov_b32 v81, 0
    v_mov_b32 v82, 0
    v_mov_b32 v83, 0
    v_mov_b32 v84, 0
    v_mov_b32 v85, 0
    v_mov_b32 v86, 0
    v_mov_b32 v87, 0
    v_mov_b32 v88, 0
    v_mov_b32 v89, 0
    v_mov_b32 v90, 0
    v_mov_b32 v91, 0
    v_mov_b32 v92, 0
    v_mov_b32 v93, 0
    v_mov_b32 v94, 0
    v_mov_b32 v95, 0
    v_mov_b32 v96, 0
    v_mov_b32 v97, 0
    v_mov_b32 v98, 0
    v_mov_b32 v99, 0
    v_mov_b32 v100, 0
    v_mov_b32 v101, 0
    v_mov_b32 v102, 0
    v_mov_b32 v103, 0
    v_mov_b32 v184, 0
    v_mov_b32 v185, 0
    v_mov_b32 v186, 0
    v_mov_b32 v187, 0
    v_mov_b32 v188, 0
    v_mov_b32 v189, 0
    v_mov_b32 v190, 0
    v_mov_b32 v191, 0
    v_mov_b32 v192, 0
    v_mov_b32 v193, 0
    v_mov_b32 v194, 0
    v_mov_b32 v195, 0
    v_mov_b32 v196, 0
    v_mov_b32 v197, 0
    v_mov_b32 v198, 0
    v_mov_b32 v199, 0
    v_mov_b32 v236, 0
    v_mov_b32 v237, 0
    v_mov_b32 v238, 0
    v_mov_b32 v239, 0
    v_mov_b32 v3, 0
    v_mov_b32 v240, 0
    v_mov_b32 v241, 0
    v_mov_b32 v242, 0
    v_mov_b32 v243, 0
    v_mov_b32 v5, 0
    s_mov_b32 s61, 0xff61b1e6
    v_mov_b32 v252, 0x3f803f80
    v_mov_b32 v253, 0x3f803f80
    v_mov_b32 v254, 0x3f803f80
    v_mov_b32 v255, 0x3f803f80
    s_waitcnt vmcnt(12)
    s_barrier
    ds_read_b128 v[200:203], v232 offset:0
    ds_read_b128 v[204:207], v233 offset:0
    ds_read_b128 v[208:211], v234 offset:0
    ds_read_b128 v[212:215], v235 offset:0
    ds_read_b128 v[216:219], v232 offset:4096
    ds_read_b128 v[220:223], v233 offset:4096
    ds_read_b128 v[224:227], v234 offset:4096
    s_waitcnt lgkmcnt(6)
    v_mfma_f32_16x16x32_bf16 v[104:107], v[200:203], v[8:11], v[236:239]
    v_mfma_f32_16x16x32_bf16 v[108:111], v[200:203], v[24:27], v[240:243]
    ds_read_b128 v[228:231], v235 offset:4096
    s_waitcnt lgkmcnt(6)
    v_mfma_f32_16x16x32_bf16 v[104:107], v[204:207], v[12:15], v[104:107]
    v_mfma_f32_16x16x32_bf16 v[108:111], v[204:207], v[28:31], v[108:111]
    ds_read_b128 v[200:203], v232 offset:8192
    s_waitcnt lgkmcnt(6)
    v_mfma_f32_16x16x32_bf16 v[104:107], v[208:211], v[16:19], v[104:107]
    v_mfma_f32_16x16x32_bf16 v[108:111], v[208:211], v[32:35], v[108:111]
    ds_read_b128 v[204:207], v233 offset:8192
    s_waitcnt lgkmcnt(6)
    v_mfma_f32_16x16x32_bf16 v[104:107], v[212:215], v[20:23], v[104:107]
    v_mfma_f32_16x16x32_bf16 v[108:111], v[212:215], v[36:39], v[108:111]
    ds_read_b128 v[208:211], v234 offset:8192
    s_waitcnt lgkmcnt(6)
    v_mfma_f32_16x16x32_bf16 v[112:115], v[216:219], v[8:11], v[236:239]
    v_mfma_f32_16x16x32_bf16 v[116:119], v[216:219], v[24:27], v[240:243]
    ds_read_b128 v[212:215], v235 offset:8192
    s_waitcnt lgkmcnt(6)
    v_mfma_f32_16x16x32_bf16 v[112:115], v[220:223], v[12:15], v[112:115]
    v_mfma_f32_16x16x32_bf16 v[116:119], v[220:223], v[28:31], v[116:119]
    ds_read_b128 v[216:219], v232 offset:12288
    s_waitcnt lgkmcnt(6)
    v_mfma_f32_16x16x32_bf16 v[112:115], v[224:227], v[16:19], v[112:115]
    v_mfma_f32_16x16x32_bf16 v[116:119], v[224:227], v[32:35], v[116:119]
    ds_read_b128 v[220:223], v233 offset:12288
    s_waitcnt lgkmcnt(6)
    v_mfma_f32_16x16x32_bf16 v[112:115], v[228:231], v[20:23], v[112:115]
    v_mfma_f32_16x16x32_bf16 v[116:119], v[228:231], v[36:39], v[116:119]
    ds_read_b128 v[224:227], v234 offset:12288
    s_waitcnt lgkmcnt(6)
    v_mfma_f32_16x16x32_bf16 v[120:123], v[200:203], v[8:11], v[236:239]
    v_mfma_f32_16x16x32_bf16 v[124:127], v[200:203], v[24:27], v[240:243]
    ds_read_b128 v[228:231], v235 offset:12288
    s_waitcnt lgkmcnt(6)
    v_mfma_f32_16x16x32_bf16 v[120:123], v[204:207], v[12:15], v[120:123]
    v_mfma_f32_16x16x32_bf16 v[124:127], v[204:207], v[28:31], v[124:127]
    ds_read_b128 v[200:203], v247 offset:49152
    s_waitcnt lgkmcnt(6)
    v_mfma_f32_16x16x32_bf16 v[120:123], v[208:211], v[16:19], v[120:123]
    v_mfma_f32_16x16x32_bf16 v[124:127], v[208:211], v[32:35], v[124:127]
    ds_read_b128 v[204:207], v247 offset:50176
    s_waitcnt lgkmcnt(6)
    v_mfma_f32_16x16x32_bf16 v[120:123], v[212:215], v[20:23], v[120:123]
    v_mfma_f32_16x16x32_bf16 v[124:127], v[212:215], v[36:39], v[124:127]
    ds_read_b128 v[208:211], v247 offset:51200
    s_waitcnt lgkmcnt(6)
    v_mfma_f32_16x16x32_bf16 v[128:131], v[216:219], v[8:11], v[236:239]
    v_mfma_f32_16x16x32_bf16 v[132:135], v[216:219], v[24:27], v[240:243]
    ds_read_b128 v[212:215], v247 offset:52224
    s_waitcnt lgkmcnt(6)
    v_mfma_f32_16x16x32_bf16 v[128:131], v[220:223], v[12:15], v[128:131]
    v_mfma_f32_16x16x32_bf16 v[132:135], v[220:223], v[28:31], v[132:135]
    ds_read_b128 v[216:219], v247 offset:53248
    s_waitcnt lgkmcnt(6)
    v_mfma_f32_16x16x32_bf16 v[128:131], v[224:227], v[16:19], v[128:131]
    v_mfma_f32_16x16x32_bf16 v[132:135], v[224:227], v[32:35], v[132:135]
    ds_read_b128 v[220:223], v247 offset:54272
    s_waitcnt lgkmcnt(6)
    v_mfma_f32_16x16x32_bf16 v[128:131], v[228:231], v[20:23], v[128:131]
    v_mfma_f32_16x16x32_bf16 v[132:135], v[228:231], v[36:39], v[132:135]
    s_mov_b32 s56, 8
attn_kernel_loop2:
    ds_read_b128 v[224:227], v247 offset:55296
    s_waitcnt lgkmcnt(5)
    v_mfma_f32_16x16x32_bf16 v[40:43], v[200:203], v[184:187], v[40:43]
    v_exp_f32 v0, v104
    v_mfma_f32_16x16x32_bf16 v[44:47], v[200:203], v[188:191], v[44:47]
    v_exp_f32 v1, v105
    ds_read_b128 v[228:231], v247 offset:56320
    v_mfma_f32_16x16x32_bf16 v[48:51], v[204:207], v[184:187], v[48:51]
    v_exp_f32 v6, v108
    v_mfma_f32_16x16x32_bf16 v[52:55], v[204:207], v[188:191], v[52:55]
    v_exp_f32 v7, v109
    ds_read_b128 v[200:203], v247 offset:57344
    s_waitcnt lgkmcnt(5)
    v_mfma_f32_16x16x32_bf16 v[56:59], v[208:211], v[184:187], v[56:59]
    v_cvt_pk_bf16_f32 v168, v0, v1
    v_mfma_f32_16x16x32_bf16 v[60:63], v[208:211], v[188:191], v[60:63]
    s_cmp_lt_u32 s72, 4096
    s_cbranch_scc1 attn_kernel_sa3
    s_sub_u32 s86, s72, 4096
    s_cmp_lt_u32 s86, 2304
    s_cbranch_scc1 attn_kernel_s15
    s_cmp_lt_u32 s86, 4896
    s_cbranch_scc1 attn_kernel_s26
    s_sub_u32 s86, s86, 4896
    s_mov_b32 s76, s68
    s_mov_b32 s77, s69
    s_mov_b32 s78, 2654208
    s_movk_i32 s85, 1152
    s_movk_i32 s87, 18
    s_mov_b32 s88, 238609295
    s_mov_b32 s89, 10043392
    s_cmp_lt_u32 s86, 1296
    s_cselect_b32 s89, s89, 0x70000000
    s_branch attn_kernel_sb7
attn_kernel_s15:
    s_mov_b32 s76, s64
    s_mov_b32 s77, s65
    s_mov_b32 s78, 4718592
    s_movk_i32 s85, 1152
    s_movk_i32 s87, 18
    s_mov_b32 s88, 238609295
    s_mov_b32 s89, 16384
    s_branch attn_kernel_sb7
attn_kernel_s26:
    s_sub_u32 s86, s86, 2304
    s_mov_b32 s76, s66
    s_mov_b32 s77, s67
    s_mov_b32 s78, 5308416
    s_movk_i32 s85, 9216
    s_movk_i32 s87, 144
    s_mov_b32 s88, 29826162
    s_mov_b32 s89, 4734976
attn_kernel_sb7:
    s_mul_hi_u32 s90, s86, s88
    s_mul_i32 s91, s90, s87
    s_sub_u32 s91, s86, s91
    s_mul_i32 s74, s90, s85
    s_lshl_b32 s74, s74, 5
    s_lshl_b32 s91, s91, 6
    s_add_u32 s74, s74, s91
    s_lshl_b32 s75, s86, 11
    s_add_u32 s75, s75, s89
    s_mov_b32 s84, 0
    v_lshrrev_b32 v248, 2, v2
    v_mul_lo_u32 v248, v248, s85
    v_and_b32 v249, 3, v2
    v_lshl_add_u32 v248, v249, 4, v248
    s_lshl_b32 s85, s85, 4
    s_branch attn_kernel_sj4
attn_kernel_sa3:
    s_mov_b32 s76, s70
    s_mov_b32 s77, s71
    s_mov_b32 s78, 8388608
    s_lshr_b32 s90, s72, 5
    s_lshl_b32 s74, s90, 16
    s_and_b32 s91, s72, 31
    s_lshl_b32 s91, s91, 7
    s_add_u32 s74, s74, s91
    s_lshl_b32 s75, s72, 11
    s_add_u32 s75, s75, 12730368
    s_mov_b32 s84, 1
    v_lshrrev_b32 v248, 3, v2
    v_lshlrev_b32 v248, 12, v248
    v_and_b32 v249, 7, v2
    v_lshl_add_u32 v248, v249, 4, v248
    s_mov_b32 s85, 32768
attn_kernel_sj4:
    s_sub_u32 s75, s75, s50
    s_mov_b32 m0, s73
    s_nop 0
    buffer_load_dwordx4 v248, s[76:79], s74 offen lds
    s_add_u32 s74, s74, s85
    s_add_u32 m0, s73, 1024
    s_nop 0
    buffer_load_dwordx4 v248, s[76:79], s74 offen lds
    s_add_u32 s72, s72, 2048
    v_cvt_pk_bf16_f32 v172, v6, v7
    ds_read_b128 v[204:207], v247 offset:58368
    v_mfma_f32_16x16x32_bf16 v[64:67], v[212:215], v[184:187], v[64:67]
    v_exp_f32 v0, v106
    v_mfma_f32_16x16x32_bf16 v[68:71], v[212:215], v[188:191], v[68:71]
    v_exp_f32 v1, v107
    ds_read_b128 v[208:211], v247 offset:59392
    s_waitcnt lgkmcnt(5)
    v_mfma_f32_16x16x32_bf16 v[72:75], v[216:219], v[184:187], v[72:75]
    v_mfma_f32_16x16x32_bf16 v[76:79], v[216:219], v[188:191], v[76:79]
    v_exp_f32 v6, v110
    ds_read_b128 v[212:215], v247 offset:60416
    v_mfma_f32_16x16x32_bf16 v[80:83], v[220:223], v[184:187], v[80:83]
    v_exp_f32 v7, v111
    v_mfma_f32_16x16x32_bf16 v[84:87], v[220:223], v[188:191], v[84:87]
    v_cvt_pk_bf16_f32 v169, v0, v1
    ds_read_b128 v[216:219], v247 offset:61440
    s_waitcnt lgkmcnt(5)
    v_mfma_f32_16x16x32_bf16 v[88:91], v[224:227], v[184:187], v[88:91]
    v_cvt_pk_bf16_f32 v173, v6, v7
    v_mfma_f32_16x16x32_bf16 v[92:95], v[224:227], v[188:191], v[92:95]
    v_exp_f32 v0, v112
    ds_read_b128 v[220:223], v247 offset:62464
    v_mfma_f32_16x16x32_bf16 v[96:99], v[228:231], v[184:187], v[96:99]
    v_exp_f32 v1, v113
    v_mfma_f32_16x16x32_bf16 v[100:103], v[228:231], v[188:191], v[100:103]
    v_exp_f32 v6, v116
    ds_read_b128 v[224:227], v247 offset:63488
    ds_read_b128 v[228:231], v247 offset:64512
    s_waitcnt lgkmcnt(6)
    v_mfma_f32_16x16x32_bf16 v[40:43], v[200:203], v[192:195], v[40:43]
    v_exp_f32 v7, v117
    v_mfma_f32_16x16x32_bf16 v[44:47], v[200:203], v[196:199], v[44:47]
    v_mfma_f32_16x16x32_bf16 v[48:51], v[204:207], v[192:195], v[48:51]
    v_cvt_pk_bf16_f32 v170, v0, v1
    v_mfma_f32_16x16x32_bf16 v[52:55], v[204:207], v[196:199], v[52:55]
    s_waitcnt lgkmcnt(0)
    s_waitcnt vmcnt(10)
    s_barrier
    v_cvt_pk_bf16_f32 v174, v6, v7
    ds_read_b128 v[200:203], v232 offset:16384
    v_mfma_f32_16x16x32_bf16 v[56:59], v[208:211], v[192:195], v[56:59]
    v_exp_f32 v0, v114
    v_mfma_f32_16x16x32_bf16 v[60:63], v[208:211], v[196:199], v[60:63]
    v_exp_f32 v1, v115
    ds_read_b128 v[204:207], v233 offset:16384
    v_mfma_f32_16x16x32_bf16 v[64:67], v[212:215], v[192:195], v[64:67]
    v_exp_f32 v6, v118
    v_mfma_f32_16x16x32_bf16 v[68:71], v[212:215], v[196:199], v[68:71]
    v_exp_f32 v7, v119
    ds_read_b128 v[208:211], v234 offset:16384
    v_mfma_f32_16x16x32_bf16 v[72:75], v[216:219], v[192:195], v[72:75]
    v_cvt_pk_bf16_f32 v171, v0, v1
    v_mfma_f32_16x16x32_bf16 v[76:79], v[216:219], v[196:199], v[76:79]
    v_cvt_pk_bf16_f32 v175, v6, v7
    ds_read_b128 v[212:215], v235 offset:16384
    v_mfma_f32_16x16x32_bf16 v[80:83], v[220:223], v[192:195], v[80:83]
    v_mfma_f32_16x16x32_bf16 v[84:87], v[220:223], v[196:199], v[84:87]
    v_exp_f32 v0, v120
    ds_read_b128 v[216:219], v232 offset:20480
    v_mfma_f32_16x16x32_bf16 v[88:91], v[224:227], v[192:195], v[88:91]
    v_exp_f32 v1, v121
    v_mfma_f32_16x16x32_bf16 v[92:95], v[224:227], v[196:199], v[92:95]
    s_cmp_ge_u32 s52, s57
    s_cselect_b32 s58, s59, s52
    s_add_u32 m0, s50, 0
    s_nop 0
    buffer_load_dwordx4 v244, s[12:15], s58 offen lds
    v_exp_f32 v6, v124
    ds_read_b128 v[220:223], v233 offset:20480
    v_mfma_f32_16x16x32_bf16 v[96:99], v[228:231], v[192:195], v[96:99]
    v_exp_f32 v7, v125
    v_mfma_f32_16x16x32_bf16 v[100:103], v[228:231], v[196:199], v[100:103]
    v_cvt_pk_bf16_f32 v176, v0, v1
    ds_read_b128 v[224:227], v234 offset:20480
    s_waitcnt lgkmcnt(5)
    v_mfma_f32_16x16x32_bf16 v[136:139], v[200:203], v[8:11], v[236:239]
    v_cvt_pk_bf16_f32 v180, v6, v7
    v_mfma_f32_16x16x32_bf16 v[140:143], v[200:203], v[24:27], v[240:243]
    v_exp_f32 v0, v122
    ds_read_b128 v[228:231], v235 offset:20480
    v_mfma_f32_16x16x32_bf16 v[136:139], v[204:207], v[12:15], v[136:139]
    v_exp_f32 v1, v123
    v_mfma_f32_16x16x32_bf16 v[140:143], v[204:207], v[28:31], v[140:143]
    s_add_u32 m0, s50, 1024
    s_nop 0
    buffer_load_dwordx4 v245, s[12:15], s58 offen lds
    s_add_u32 s52, s52, 16384
    v_mfma_f32_16x16x32_bf16 v[184:187], v[252:255], v[168:171], 0
    v_mfma_f32_16x16x32_bf16 v[188:191], v[252:255], v[172:175], 0
    ds_read_b128 v[200:203], v232 offset:24576
    s_waitcnt lgkmcnt(5)
    v_mfma_f32_16x16x32_bf16 v[136:139], v[208:211], v[16:19], v[136:139]
    v_exp_f32 v6, v126
    v_mfma_f32_16x16x32_bf16 v[140:143], v[208:211], v[32:35], v[140:143]
    v_exp_f32 v7, v127
    ds_read_b128 v[204:207], v233 offset:24576
    v_mfma_f32_16x16x32_bf16 v[136:139], v[212:215], v[20:23], v[136:139]
    v_cvt_pk_bf16_f32 v177, v0, v1
    v_mfma_f32_16x16x32_bf16 v[140:143], v[212:215], v[36:39], v[140:143]
    v_cvt_pk_bf16_f32 v181, v6, v7
    ds_read_b128 v[208:211], v234 offset:24576
    s_waitcnt lgkmcnt(5)
    v_mfma_f32_16x16x32_bf16 v[144:147], v[216:219], v[8:11], v[236:239]
    v_exp_f32 v0, v128
    v_mfma_f32_16x16x32_bf16 v[148:151], v[216:219], v[24:27], v[240:243]
    s_cmp_ge_u32 s53, s57
    s_cselect_b32 s55, s59, s53
    s_add_u32 m0, s50, 114688
    s_nop 0
    buffer_load_dwordx4 v246, s[16:19], s55 offen lds
    v_exp_f32 v1, v129
    ds_read_b128 v[212:215], v235 offset:24576
    v_mfma_f32_16x16x32_bf16 v[144:147], v[220:223], v[12:15], v[144:147]
    v_exp_f32 v6, v132
    v_mfma_f32_16x16x32_bf16 v[148:151], v[220:223], v[28:31], v[148:151]
    v_exp_f32 v7, v133
    ds_read_b128 v[216:219], v232 offset:28672
    s_waitcnt lgkmcnt(5)
    v_mfma_f32_16x16x32_bf16 v[144:147], v[224:227], v[16:19], v[144:147]
    v_mfma_f32_16x16x32_bf16 v[148:151], v[224:227], v[32:35], v[148:151]
    v_cvt_pk_bf16_f32 v178, v0, v1
    ds_read_b128 v[220:223], v233 offset:28672
    v_mfma_f32_16x16x32_bf16 v[144:147], v[228:231], v[20:23], v[144:147]
    v_cvt_pk_bf16_f32 v182, v6, v7
    v_mfma_f32_16x16x32_bf16 v[148:151], v[228:231], v[36:39], v[148:151]
    s_add_u32 m0, s50, 114688
    s_nop 0
    buffer_load_dwordx4 v246, s[16:19], s55 offen offset:1024 lds
    s_add_u32 s53, s53, 16384
    v_exp_f32 v0, v130
    ds_read_b128 v[224:227], v234 offset:28672
    s_waitcnt lgkmcnt(5)
    v_mfma_f32_16x16x32_bf16 v[152:155], v[200:203], v[8:11], v[236:239]
    v_exp_f32 v1, v131
    v_mfma_f32_16x16x32_bf16 v[156:159], v[200:203], v[24:27], v[240:243]
    v_exp_f32 v6, v134
    ds_read_b128 v[228:231], v235 offset:28672
    v_mfma_f32_16x16x32_bf16 v[152:155], v[204:207], v[12:15], v[152:155]
    v_exp_f32 v7, v135
    v_mfma_f32_16x16x32_bf16 v[156:159], v[204:207], v[28:31], v[156:159]
    v_cvt_pk_bf16_f32 v179, v0, v1
    ds_read_b128 v[200:203], v247 offset:0
    s_waitcnt lgkmcnt(5)
    v_mfma_f32_16x16x32_bf16 v[152:155], v[208:211], v[16:19], v[152:155]
    v_cvt_pk_bf16_f32 v183, v6, v7
    v_mfma_f32_16x16x32_bf16 v[156:159], v[208:211], v[32:35], v[156:159]
    ds_read_b128 v[204:207], v247 offset:1024
    v_mfma_f32_16x16x32_bf16 v[152:155], v[212:215], v[20:23], v[152:155]
    v_mfma_f32_16x16x32_bf16 v[156:159], v[212:215], v[36:39], v[156:159]
    v_mfma_f32_16x16x32_bf16 v[184:187], v[252:255], v[176:179], v[184:187]
    v_mfma_f32_16x16x32_bf16 v[188:191], v[252:255], v[180:183], v[188:191]
    ds_read_b128 v[208:211], v247 offset:2048
    s_waitcnt lgkmcnt(5)
    v_mfma_f32_16x16x32_bf16 v[160:163], v[216:219], v[8:11], v[236:239]
    v_mfma_f32_16x16x32_bf16 v[164:167], v[216:219], v[24:27], v[240:243]
    ds_read_b128 v[212:215], v247 offset:3072
    v_mfma_f32_16x16x32_bf16 v[160:163], v[220:223], v[12:15], v[160:163]
    v_mfma_f32_16x16x32_bf16 v[164:167], v[220:223], v[28:31], v[164:167]
    ds_read_b128 v[216:219], v247 offset:4096
    s_waitcnt lgkmcnt(5)
    v_mfma_f32_16x16x32_bf16 v[160:163], v[224:227], v[16:19], v[160:163]
    v_mfma_f32_16x16x32_bf16 v[164:167], v[224:227], v[32:35], v[164:167]
    ds_read_b128 v[220:223], v247 offset:5120
    v_mfma_f32_16x16x32_bf16 v[160:163], v[228:231], v[20:23], v[160:163]
    v_mfma_f32_16x16x32_bf16 v[164:167], v[228:231], v[36:39], v[164:167]
    v_add_f32 v4, v184, v188
    v_cmp_nge_f32 vcc, s63, v4
    s_cbranch_vccnz attn_kernel_slow8
attn_kernel_ret9:
    v_add_f32 v3, v3, v184
    v_add_f32 v5, v5, v188
    ds_read_b128 v[224:227], v247 offset:6144
    s_waitcnt lgkmcnt(5)
    v_mfma_f32_16x16x32_bf16 v[40:43], v[200:203], v[168:171], v[40:43]
    v_exp_f32 v0, v136
    v_mfma_f32_16x16x32_bf16 v[44:47], v[200:203], v[172:175], v[44:47]
    v_exp_f32 v1, v137
    ds_read_b128 v[228:231], v247 offset:7168
    v_mfma_f32_16x16x32_bf16 v[48:51], v[204:207], v[168:171], v[48:51]
    v_exp_f32 v6, v140
    v_mfma_f32_16x16x32_bf16 v[52:55], v[204:207], v[172:175], v[52:55]
    v_exp_f32 v7, v141
    ds_read_b128 v[200:203], v247 offset:8192
    s_waitcnt lgkmcnt(5)
    v_mfma_f32_16x16x32_bf16 v[56:59], v[208:211], v[168:171], v[56:59]
    v_cvt_pk_bf16_f32 v184, v0, v1
    v_mfma_f32_16x16x32_bf16 v[60:63], v[208:211], v[172:175], v[60:63]
    v_cvt_pk_bf16_f32 v188, v6, v7
    ds_read_b128 v[204:207], v247 offset:9216
    v_mfma_f32_16x16x32_bf16 v[64:67], v[212:215], v[168:171], v[64:67]
    v_exp_f32 v0, v138
    v_mfma_f32_16x16x32_bf16 v[68:71], v[212:215], v[172:175], v[68:71]
    v_exp_f32 v1, v139
    ds_read_b128 v[208:211], v247 offset:10240
    s_waitcnt lgkmcnt(5)
    v_mfma_f32_16x16x32_bf16 v[72:75], v[216:219], v[168:171], v[72:75]
    v_mfma_f32_16x16x32_bf16 v[76:79], v[216:219], v[172:175], v[76:79]
    v_exp_f32 v6, v142
    ds_read_b128 v[212:215], v247 offset:11264
    v_mfma_f32_16x16x32_bf16 v[80:83], v[220:223], v[168:171], v[80:83]
    v_exp_f32 v7, v143
    v_mfma_f32_16x16x32_bf16 v[84:87], v[220:223], v[172:175], v[84:87]
    v_cvt_pk_bf16_f32 v185, v0, v1
    ds_read_b128 v[216:219], v247 offset:12288
    s_waitcnt lgkmcnt(5)
    v_mfma_f32_16x16x32_bf16 v[88:91], v[224:227], v[168:171], v[88:91]
    v_cvt_pk_bf16_f32 v189, v6, v7
    v_mfma_f32_16x16x32_bf16 v[92:95], v[224:227], v[172:175], v[92:95]
    v_exp_f32 v0, v144
    ds_read_b128 v[220:223], v247 offset:13312
    v_mfma_f32_16x16x32_bf16 v[96:99], v[228:231], v[168:171], v[96:99]
    v_exp_f32 v1, v145
    v_mfma_f32_16x16x32_bf16 v[100:103], v[228:231], v[172:175], v[100:103]
    v_exp_f32 v6, v148
    ds_read_b128 v[224:227], v247 offset:14336
    ds_read_b128 v[228:231], v247 offset:15360
    s_waitcnt lgkmcnt(6)
    v_mfma_f32_16x16x32_bf16 v[40:43], v[200:203], v[176:179], v[40:43]
    v_exp_f32 v7, v149
    v_mfma_f32_16x16x32_bf16 v[44:47], v[200:203], v[180:183], v[44:47]
    v_mfma_f32_16x16x32_bf16 v[48:51], v[204:207], v[176:179], v[48:51]
    v_cvt_pk_bf16_f32 v186, v0, v1
    v_mfma_f32_16x16x32_bf16 v[52:55], v[204:207], v[180:183], v[52:55]
    s_waitcnt lgkmcnt(0)
    s_waitcnt vmcnt(10)
    s_barrier
    v_cvt_pk_bf16_f32 v190, v6, v7
    ds_read_b128 v[200:203], v232 offset:32768
    v_mfma_f32_16x16x32_bf16 v[56:59], v[208:211], v[176:179], v[56:59]
    v_exp_f32 v0, v146
    v_mfma_f32_16x16x32_bf16 v[60:63], v[208:211], v[180:183], v[60:63]
    v_exp_f32 v1, v147
    ds_read_b128 v[204:207], v233 offset:32768
    v_mfma_f32_16x16x32_bf16 v[64:67], v[212:215], v[176:179], v[64:67]
    v_exp_f32 v6, v150
    v_mfma_f32_16x16x32_bf16 v[68:71], v[212:215], v[180:183], v[68:71]
    v_exp_f32 v7, v151
    ds_read_b128 v[208:211], v234 offset:32768
    v_mfma_f32_16x16x32_bf16 v[72:75], v[216:219], v[176:179], v[72:75]
    v_cvt_pk_bf16_f32 v187, v0, v1
    v_mfma_f32_16x16x32_bf16 v[76:79], v[216:219], v[180:183], v[76:79]
    v_cvt_pk_bf16_f32 v191, v6, v7
    ds_read_b128 v[212:215], v235 offset:32768
    v_mfma_f32_16x16x32_bf16 v[80:83], v[220:223], v[176:179], v[80:83]
    v_mfma_f32_16x16x32_bf16 v[84:87], v[220:223], v[180:183], v[84:87]
    v_exp_f32 v0, v152
    ds_read_b128 v[216:219], v232 offset:36864
    v_mfma_f32_16x16x32_bf16 v[88:91], v[224:227], v[176:179], v[88:91]
    v_exp_f32 v1, v153
    v_mfma_f32_16x16x32_bf16 v[92:95], v[224:227], v[180:183], v[92:95]
    s_cmp_ge_u32 s52, s57
    s_cselect_b32 s58, s59, s52
    s_add_u32 m0, s50, 16384
    s_nop 0
    buffer_load_dwordx4 v244, s[12:15], s58 offen lds
    v_exp_f32 v6, v156
    ds_read_b128 v[220:223], v233 offset:36864
    v_mfma_f32_16x16x32_bf16 v[96:99], v[228:231], v[176:179], v[96:99]
    v_exp_f32 v7, v157
    v_mfma_f32_16x16x32_bf16 v[100:103], v[228:231], v[180:183], v[100:103]
    v_cvt_pk_bf16_f32 v192, v0, v1
    ds_read_b128 v[224:227], v234 offset:36864
    s_waitcnt lgkmcnt(5)
    v_mfma_f32_16x16x32_bf16 v[104:107], v[200:203], v[8:11], v[236:239]
    v_cvt_pk_bf16_f32 v196, v6, v7
    v_mfma_f32_16x16x32_bf16 v[108:111], v[200:203], v[24:27], v[240:243]
    v_exp_f32 v0, v154
    ds_read_b128 v[228:231], v235 offset:36864
    v_mfma_f32_16x16x32_bf16 v[104:107], v[204:207], v[12:15], v[104:107]
    v_exp_f32 v1, v155
    v_mfma_f32_16x16x32_bf16 v[108:111], v[204:207], v[28:31], v[108:111]
    s_add_u32 m0, s50, 17408
    s_nop 0
    buffer_load_dwordx4 v245, s[12:15], s58 offen lds
    s_add_u32 s52, s52, 16384
    v_mfma_f32_16x16x32_bf16 v[168:171], v[252:255], v[184:187], 0
    v_mfma_f32_16x16x32_bf16 v[172:175], v[252:255], v[188:191], 0
    ds_read_b128 v[200:203], v232 offset:40960
    s_waitcnt lgkmcnt(5)
    v_mfma_f32_16x16x32_bf16 v[104:107], v[208:211], v[16:19], v[104:107]
    v_exp_f32 v6, v158
    v_mfma_f32_16x16x32_bf16 v[108:111], v[208:211], v[32:35], v[108:111]
    v_exp_f32 v7, v159
    ds_read_b128 v[204:207], v233 offset:40960
    v_mfma_f32_16x16x32_bf16 v[104:107], v[212:215], v[20:23], v[104:107]
    v_cvt_pk_bf16_f32 v193, v0, v1
    v_mfma_f32_16x16x32_bf16 v[108:111], v[212:215], v[36:39], v[108:111]
    v_cvt_pk_bf16_f32 v197, v6, v7
    ds_read_b128 v[208:211], v234 offset:40960
    s_waitcnt lgkmcnt(5)
    v_mfma_f32_16x16x32_bf16 v[112:115], v[216:219], v[8:11], v[236:239]
    v_exp_f32 v0, v160
    v_mfma_f32_16x16x32_bf16 v[116:119], v[216:219], v[24:27], v[240:243]
    s_cmp_ge_u32 s53, s57
    s_cselect_b32 s55, s59, s53
    s_add_u32 m0, s50, 65536
    s_nop 0
    buffer_load_dwordx4 v246, s[16:19], s55 offen lds
    v_exp_f32 v1, v161
    ds_read_b128 v[212:215], v235 offset:40960
    v_mfma_f32_16x16x32_bf16 v[112:115], v[220:223], v[12:15], v[112:115]
    v_exp_f32 v6, v164
    v_mfma_f32_16x16x32_bf16 v[116:119], v[220:223], v[28:31], v[116:119]
    v_exp_f32 v7, v165
    ds_read_b128 v[216:219], v232 offset:45056
    s_waitcnt lgkmcnt(5)
    v_mfma_f32_16x16x32_bf16 v[112:115], v[224:227], v[16:19], v[112:115]
    v_mfma_f32_16x16x32_bf16 v[116:119], v[224:227], v[32:35], v[116:119]
    v_cvt_pk_bf16_f32 v194, v0, v1
    ds_read_b128 v[220:223], v233 offset:45056
    v_mfma_f32_16x16x32_bf16 v[112:115], v[228:231], v[20:23], v[112:115]
    v_cvt_pk_bf16_f32 v198, v6, v7
    v_mfma_f32_16x16x32_bf16 v[116:119], v[228:231], v[36:39], v[116:119]
    s_add_u32 m0, s50, 65536
    s_nop 0
    buffer_load_dwordx4 v246, s[16:19], s55 offen offset:1024 lds
    s_add_u32 s53, s53, 16384
    v_exp_f32 v0, v162
    ds_read_b128 v[224:227], v234 offset:45056
    s_waitcnt lgkmcnt(5)
    v_mfma_f32_16x16x32_bf16 v[120:123], v[200:203], v[8:11], v[236:239]
    v_exp_f32 v1, v163
    v_mfma_f32_16x16x32_bf16 v[124:127], v[200:203], v[24:27], v[240:243]
    v_exp_f32 v6, v166
    ds_read_b128 v[228:231], v235 offset:45056
    v_mfma_f32_16x16x32_bf16 v[120:123], v[204:207], v[12:15], v[120:123]
    v_exp_f32 v7, v167
    v_mfma_f32_16x16x32_bf16 v[124:127], v[204:207], v[28:31], v[124:127]
    v_cvt_pk_bf16_f32 v195, v0, v1
    ds_read_b128 v[200:203], v247 offset:16384
    s_waitcnt lgkmcnt(5)
    v_mfma_f32_16x16x32_bf16 v[120:123], v[208:211], v[16:19], v[120:123]
    v_cvt_pk_bf16_f32 v199, v6, v7
    v_mfma_f32_16x16x32_bf16 v[124:127], v[208:211], v[32:35], v[124:127]
    ds_read_b128 v[204:207], v247 offset:17408
    v_mfma_f32_16x16x32_bf16 v[120:123], v[212:215], v[20:23], v[120:123]
    v_mfma_f32_16x16x32_bf16 v[124:127], v[212:215], v[36:39], v[124:127]
    v_mfma_f32_16x16x32_bf16 v[168:171], v[252:255], v[192:195], v[168:171]
    v_mfma_f32_16x16x32_bf16 v[172:175], v[252:255], v[196:199], v[172:175]
    ds_read_b128 v[208:211], v247 offset:18432
    s_waitcnt lgkmcnt(5)
    v_mfma_f32_16x16x32_bf16 v[128:131], v[216:219], v[8:11], v[236:239]
    v_mfma_f32_16x16x32_bf16 v[132:135], v[216:219], v[24:27], v[240:243]
    ds_read_b128 v[212:215], v247 offset:19456
    v_mfma_f32_16x16x32_bf16 v[128:131], v[220:223], v[12:15], v[128:131]
    v_mfma_f32_16x16x32_bf16 v[132:135], v[220:223], v[28:31], v[132:135]
    ds_read_b128 v[216:219], v247 offset:20480
    s_waitcnt lgkmcnt(5)
    v_mfma_f32_16x16x32_bf16 v[128:131], v[224:227], v[16:19], v[128:131]
    v_mfma_f32_16x16x32_bf16 v[132:135], v[224:227], v[32:35], v[132:135]
    ds_read_b128 v[220:223], v247 offset:21504
    v_mfma_f32_16x16x32_bf16 v[128:131], v[228:231], v[20:23], v[128:131]
    v_mfma_f32_16x16x32_bf16 v[132:135], v[228:231], v[36:39], v[132:135]
    v_add_f32 v4, v168, v172
    v_cmp_nge_f32 vcc, s63, v4
    s_cbranch_vccnz attn_kernel_slow10
attn_kernel_ret11:
    v_add_f32 v3, v3, v168
    v_add_f32 v5, v5, v172
    ds_read_b128 v[224:227], v247 offset:22528
    s_waitcnt lgkmcnt(5)
    v_mfma_f32_16x16x32_bf16 v[40:43], v[200:203], v[184:187], v[40:43]
    v_exp_f32 v0, v104
    v_mfma_f32_16x16x32_bf16 v[44:47], v[200:203], v[188:191], v[44:47]
    v_exp_f32 v1, v105
    ds_read_b128 v[228:231], v247 offset:23552
    v_mfma_f32_16x16x32_bf16 v[48:51], v[204:207], v[184:187], v[48:51]
    v_exp_f32 v6, v108
    v_mfma_f32_16x16x32_bf16 v[52:55], v[204:207], v[188:191], v[52:55]
    v_exp_f32 v7, v109
    ds_read_b128 v[200:203], v247 offset:24576
    s_waitcnt lgkmcnt(5)
    v_mfma_f32_16x16x32_bf16 v[56:59], v[208:211], v[184:187], v[56:59]
    v_cvt_pk_bf16_f32 v168, v0, v1
    v_mfma_f32_16x16x32_bf16 v[60:63], v[208:211], v[188:191], v[60:63]
    v_cvt_pk_bf16_f32 v172, v6, v7
    ds_read_b128 v[204:207], v247 offset:25600
    v_mfma_f32_16x16x32_bf16 v[64:67], v[212:215], v[184:187], v[64:67]
    v_exp_f32 v0, v106
    v_mfma_f32_16x16x32_bf16 v[68:71], v[212:215], v[188:191], v[68:71]
    v_exp_f32 v1, v107
    ds_read_b128 v[208:211], v247 offset:26624
    s_waitcnt lgkmcnt(5)
    v_mfma_f32_16x16x32_bf16 v[72:75], v[216:219], v[184:187], v[72:75]
    v_mfma_f32_16x16x32_bf16 v[76:79], v[216:219], v[188:191], v[76:79]
    v_exp_f32 v6, v110
    ds_read_b128 v[212:215], v247 offset:27648
    v_mfma_f32_16x16x32_bf16 v[80:83], v[220:223], v[184:187], v[80:83]
    v_exp_f32 v7, v111
    v_mfma_f32_16x16x32_bf16 v[84:87], v[220:223], v[188:191], v[84:87]
    v_cvt_pk_bf16_f32 v169, v0, v1
    ds_read_b128 v[216:219], v247 offset:28672
    s_waitcnt lgkmcnt(5)
    v_mfma_f32_16x16x32_bf16 v[88:91], v[224:227], v[184:187], v[88:91]
    v_cvt_pk_bf16_f32 v173, v6, v7
    v_mfma_f32_16x16x32_bf16 v[92:95], v[224:227], v[188:191], v[92:95]
    v_exp_f32 v0, v112
    ds_read_b128 v[220:223], v247 offset:29696
    v_mfma_f32_16x16x32_bf16 v[96:99], v[228:231], v[184:187], v[96:99]
    v_exp_f32 v1, v113
    v_mfma_f32_16x16x32_bf16 v[100:103], v[228:231], v[188:191], v[100:103]
    v_exp_f32 v6, v116
    ds_read_b128 v[224:227], v247 offset:30720
    ds_read_b128 v[228:231], v247 offset:31744
    s_waitcnt lgkmcnt(6)
    v_mfma_f32_16x16x32_bf16 v[40:43], v[200:203], v[192:195], v[40:43]
    v_exp_f32 v7, v117
    v_mfma_f32_16x16x32_bf16 v[44:47], v[200:203], v[196:199], v[44:47]
    v_mfma_f32_16x16x32_bf16 v[48:51], v[204:207], v[192:195], v[48:51]
    v_cvt_pk_bf16_f32 v170, v0, v1
    v_mfma_f32_16x16x32_bf16 v[52:55], v[204:207], v[196:199], v[52:55]
    s_waitcnt lgkmcnt(0)
    s_waitcnt vmcnt(10)
    s_barrier
    v_cvt_pk_bf16_f32 v174, v6, v7
    ds_read_b128 v[200:203], v232 offset:49152
    v_mfma_f32_16x16x32_bf16 v[56:59], v[208:211], v[192:195], v[56:59]
    v_exp_f32 v0, v114
    v_mfma_f32_16x16x32_bf16 v[60:63], v[208:211], v[196:199], v[60:63]
    v_exp_f32 v1, v115
    ds_read_b128 v[204:207], v233 offset:49152
    v_mfma_f32_16x16x32_bf16 v[64:67], v[212:215], v[192:195], v[64:67]
    v_exp_f32 v6, v118
    v_mfma_f32_16x16x32_bf16 v[68:71], v[212:215], v[196:199], v[68:71]
    v_exp_f32 v7, v119
    ds_read_b128 v[208:211], v234 offset:49152
    v_mfma_f32_16x16x32_bf16 v[72:75], v[216:219], v[192:195], v[72:75]
    v_cvt_pk_bf16_f32 v171, v0, v1
    v_mfma_f32_16x16x32_bf16 v[76:79], v[216:219], v[196:199], v[76:79]
    v_cvt_pk_bf16_f32 v175, v6, v7
    ds_read_b128 v[212:215], v235 offset:49152
    v_mfma_f32_16x16x32_bf16 v[80:83], v[220:223], v[192:195], v[80:83]
    v_mfma_f32_16x16x32_bf16 v[84:87], v[220:223], v[196:199], v[84:87]
    v_exp_f32 v0, v120
    ds_read_b128 v[216:219], v232 offset:53248
    v_mfma_f32_16x16x32_bf16 v[88:91], v[224:227], v[192:195], v[88:91]
    v_exp_f32 v1, v121
    v_mfma_f32_16x16x32_bf16 v[92:95], v[224:227], v[196:199], v[92:95]
    s_cmp_ge_u32 s52, s57
    s_cselect_b32 s58, s59, s52
    s_add_u32 m0, s50, 32768
    s_nop 0
    buffer_load_dwordx4 v244, s[12:15], s58 offen lds
    v_exp_f32 v6, v124
    ds_read_b128 v[220:223], v233 offset:53248
    v_mfma_f32_16x16x32_bf16 v[96:99], v[228:231], v[192:195], v[96:99]
    v_exp_f32 v7, v125
    v_mfma_f32_16x16x32_bf16 v[100:103], v[228:231], v[196:199], v[100:103]
    v_cvt_pk_bf16_f32 v176, v0, v1
    ds_read_b128 v[224:227], v234 offset:53248
    s_waitcnt lgkmcnt(5)
    v_mfma_f32_16x16x32_bf16 v[136:139], v[200:203], v[8:11], v[236:239]
    v_cvt_pk_bf16_f32 v180, v6, v7
    v_mfma_f32_16x16x32_bf16 v[140:143], v[200:203], v[24:27], v[240:243]
    v_exp_f32 v0, v122
    ds_read_b128 v[228:231], v235 offset:53248
    v_mfma_f32_16x16x32_bf16 v[136:139], v[204:207], v[12:15], v[136:139]
    v_exp_f32 v1, v123
    v_mfma_f32_16x16x32_bf16 v[140:143], v[204:207], v[28:31], v[140:143]
    s_add_u32 m0, s50, 33792
    s_nop 0
    buffer_load_dwordx4 v245, s[12:15], s58 offen lds
    s_add_u32 s52, s52, 16384
    v_mfma_f32_16x16x32_bf16 v[184:187], v[252:255], v[168:171], 0
    v_mfma_f32_16x16x32_bf16 v[188:191], v[252:255], v[172:175], 0
    ds_read_b128 v[200:203], v232 offset:57344
    s_waitcnt lgkmcnt(5)
    v_mfma_f32_16x16x32_bf16 v[136:139], v[208:211], v[16:19], v[136:139]
    v_exp_f32 v6, v126
    v_mfma_f32_16x16x32_bf16 v[140:143], v[208:211], v[32:35], v[140:143]
    v_exp_f32 v7, v127
    ds_read_b128 v[204:207], v233 offset:57344
    v_mfma_f32_16x16x32_bf16 v[136:139], v[212:215], v[20:23], v[136:139]
    v_cvt_pk_bf16_f32 v177, v0, v1
    v_mfma_f32_16x16x32_bf16 v[140:143], v[212:215], v[36:39], v[140:143]
    v_cvt_pk_bf16_f32 v181, v6, v7
    ds_read_b128 v[208:211], v234 offset:57344
    s_waitcnt lgkmcnt(5)
    v_mfma_f32_16x16x32_bf16 v[144:147], v[216:219], v[8:11], v[236:239]
    v_exp_f32 v0, v128
    v_mfma_f32_16x16x32_bf16 v[148:151], v[216:219], v[24:27], v[240:243]
    s_cmp_ge_u32 s53, s57
    s_cselect_b32 s55, s59, s53
    s_add_u32 m0, s50, 81920
    s_nop 0
    buffer_load_dwordx4 v246, s[16:19], s55 offen lds
    v_exp_f32 v1, v129
    ds_read_b128 v[212:215], v235 offset:57344
    v_mfma_f32_16x16x32_bf16 v[144:147], v[220:223], v[12:15], v[144:147]
    v_exp_f32 v6, v132
    v_mfma_f32_16x16x32_bf16 v[148:151], v[220:223], v[28:31], v[148:151]
    v_exp_f32 v7, v133
    ds_read_b128 v[216:219], v232 offset:61440
    s_waitcnt lgkmcnt(5)
    v_mfma_f32_16x16x32_bf16 v[144:147], v[224:227], v[16:19], v[144:147]
    v_mfma_f32_16x16x32_bf16 v[148:151], v[224:227], v[32:35], v[148:151]
    v_cvt_pk_bf16_f32 v178, v0, v1
    ds_read_b128 v[220:223], v233 offset:61440
    v_mfma_f32_16x16x32_bf16 v[144:147], v[228:231], v[20:23], v[144:147]
    v_cvt_pk_bf16_f32 v182, v6, v7
    v_mfma_f32_16x16x32_bf16 v[148:151], v[228:231], v[36:39], v[148:151]
    s_add_u32 m0, s50, 81920
    s_nop 0
    buffer_load_dwordx4 v246, s[16:19], s55 offen offset:1024 lds
    s_add_u32 s53, s53, 16384
    v_exp_f32 v0, v130
    ds_read_b128 v[224:227], v234 offset:61440
    s_waitcnt lgkmcnt(5)
    v_mfma_f32_16x16x32_bf16 v[152:155], v[200:203], v[8:11], v[236:239]
    v_exp_f32 v1, v131
    v_mfma_f32_16x16x32_bf16 v[156:159], v[200:203], v[24:27], v[240:243]
    v_exp_f32 v6, v134
    ds_read_b128 v[228:231], v235 offset:61440
    v_mfma_f32_16x16x32_bf16 v[152:155], v[204:207], v[12:15], v[152:155]
    v_exp_f32 v7, v135
    v_mfma_f32_16x16x32_bf16 v[156:159], v[204:207], v[28:31], v[156:159]
    v_cvt_pk_bf16_f32 v179, v0, v1
    ds_read_b128 v[200:203], v247 offset:32768
    s_waitcnt lgkmcnt(5)
    v_mfma_f32_16x16x32_bf16 v[152:155], v[208:211], v[16:19], v[152:155]
    v_cvt_pk_bf16_f32 v183, v6, v7
    v_mfma_f32_16x16x32_bf16 v[156:159], v[208:211], v[32:35], v[156:159]
    ds_read_b128 v[204:207], v247 offset:33792
    v_mfma_f32_16x16x32_bf16 v[152:155], v[212:215], v[20:23], v[152:155]
    v_mfma_f32_16x16x32_bf16 v[156:159], v[212:215], v[36:39], v[156:159]
    v_mfma_f32_16x16x32_bf16 v[184:187], v[252:255], v[176:179], v[184:187]
    v_mfma_f32_16x16x32_bf16 v[188:191], v[252:255], v[180:183], v[188:191]
    ds_read_b128 v[208:211], v247 offset:34816
    s_waitcnt lgkmcnt(5)
    v_mfma_f32_16x16x32_bf16 v[160:163], v[216:219], v[8:11], v[236:239]
    v_mfma_f32_16x16x32_bf16 v[164:167], v[216:219], v[24:27], v[240:243]
    ds_read_b128 v[212:215], v247 offset:35840
    v_mfma_f32_16x16x32_bf16 v[160:163], v[220:223], v[12:15], v[160:163]
    v_mfma_f32_16x16x32_bf16 v[164:167], v[220:223], v[28:31], v[164:167]
    ds_read_b128 v[216:219], v247 offset:36864
    s_waitcnt lgkmcnt(5)
    v_mfma_f32_16x16x32_bf16 v[160:163], v[224:227], v[16:19], v[160:163]
    v_mfma_f32_16x16x32_bf16 v[164:167], v[224:227], v[32:35], v[164:167]
    ds_read_b128 v[220:223], v247 offset:37888
    v_mfma_f32_16x16x32_bf16 v[160:163], v[228:231], v[20:23], v[160:163]
    v_mfma_f32_16x16x32_bf16 v[164:167], v[228:231], v[36:39], v[164:167]
    v_add_f32 v4, v184, v188
    v_cmp_nge_f32 vcc, s63, v4
    s_cbranch_vccnz attn_kernel_slow12
attn_kernel_ret13:
    v_add_f32 v3, v3, v184
    v_add_f32 v5, v5, v188
    ds_read_b128 v[224:227], v247 offset:38912
    s_waitcnt lgkmcnt(5)
    v_mfma_f32_16x16x32_bf16 v[40:43], v[200:203], v[168:171], v[40:43]
    v_exp_f32 v0, v136
    v_mfma_f32_16x16x32_bf16 v[44:47], v[200:203], v[172:175], v[44:47]
    v_exp_f32 v1, v137
    ds_read_b128 v[228:231], v247 offset:39936
    v_mfma_f32_16x16x32_bf16 v[48:51], v[204:207], v[168:171], v[48:51]
    v_exp_f32 v6, v140
    v_mfma_f32_16x16x32_bf16 v[52:55], v[204:207], v[172:175], v[52:55]
    v_exp_f32 v7, v141
    ds_read_b128 v[200:203], v247 offset:40960
    s_waitcnt lgkmcnt(5)
    v_mfma_f32_16x16x32_bf16 v[56:59], v[208:211], v[168:171], v[56:59]
    v_cvt_pk_bf16_f32 v184, v0, v1
    v_mfma_f32_16x16x32_bf16 v[60:63], v[208:211], v[172:175], v[60:63]
    v_cvt_pk_bf16_f32 v188, v6, v7
    ds_read_b128 v[204:207], v247 offset:41984
    v_mfma_f32_16x16x32_bf16 v[64:67], v[212:215], v[168:171], v[64:67]
    v_exp_f32 v0, v138
    v_mfma_f32_16x16x32_bf16 v[68:71], v[212:215], v[172:175], v[68:71]
    v_exp_f32 v1, v139
    ds_read_b128 v[208:211], v247 offset:43008
    s_waitcnt lgkmcnt(5)
    v_mfma_f32_16x16x32_bf16 v[72:75], v[216:219], v[168:171], v[72:75]
    v_mfma_f32_16x16x32_bf16 v[76:79], v[216:219], v[172:175], v[76:79]
    v_exp_f32 v6, v142
    ds_read_b128 v[212:215], v247 offset:44032
    v_mfma_f32_16x16x32_bf16 v[80:83], v[220:223], v[168:171], v[80:83]
    v_exp_f32 v7, v143
    v_mfma_f32_16x16x32_bf16 v[84:87], v[220:223], v[172:175], v[84:87]
    v_cvt_pk_bf16_f32 v185, v0, v1
    ds_read_b128 v[216:219], v247 offset:45056
    s_waitcnt lgkmcnt(5)
    v_mfma_f32_16x16x32_bf16 v[88:91], v[224:227], v[168:171], v[88:91]
    v_cvt_pk_bf16_f32 v189, v6, v7
    v_mfma_f32_16x16x32_bf16 v[92:95], v[224:227], v[172:175], v[92:95]
    v_exp_f32 v0, v144
    ds_read_b128 v[220:223], v247 offset:46080
    v_mfma_f32_16x16x32_bf16 v[96:99], v[228:231], v[168:171], v[96:99]
    v_exp_f32 v1, v145
    v_mfma_f32_16x16x32_bf16 v[100:103], v[228:231], v[172:175], v[100:103]
    v_exp_f32 v6, v148
    ds_read_b128 v[224:227], v247 offset:47104
    ds_read_b128 v[228:231], v247 offset:48128
    s_waitcnt lgkmcnt(6)
    v_mfma_f32_16x16x32_bf16 v[40:43], v[200:203], v[176:179], v[40:43]
    v_exp_f32 v7, v149
    v_mfma_f32_16x16x32_bf16 v[44:47], v[200:203], v[180:183], v[44:47]
    v_mfma_f32_16x16x32_bf16 v[48:51], v[204:207], v[176:179], v[48:51]
    v_cvt_pk_bf16_f32 v186, v0, v1
    v_mfma_f32_16x16x32_bf16 v[52:55], v[204:207], v[180:183], v[52:55]
    s_waitcnt lgkmcnt(0)
    s_waitcnt vmcnt(8)
    s_barrier
    v_cvt_pk_bf16_f32 v190, v6, v7
    ds_read_b128 v[200:203], v232 offset:0
    v_mfma_f32_16x16x32_bf16 v[56:59], v[208:211], v[176:179], v[56:59]
    v_exp_f32 v0, v146
    v_mfma_f32_16x16x32_bf16 v[60:63], v[208:211], v[180:183], v[60:63]
    v_exp_f32 v1, v147
    ds_read_b128 v[204:207], v233 offset:0
    v_mfma_f32_16x16x32_bf16 v[64:67], v[212:215], v[176:179], v[64:67]
    v_exp_f32 v6, v150
    v_mfma_f32_16x16x32_bf16 v[68:71], v[212:215], v[180:183], v[68:71]
    v_exp_f32 v7, v151
    ds_read_b128 v[208:211], v234 offset:0
    v_mfma_f32_16x16x32_bf16 v[72:75], v[216:219], v[176:179], v[72:75]
    v_cvt_pk_bf16_f32 v187, v0, v1
    v_mfma_f32_16x16x32_bf16 v[76:79], v[216:219], v[180:183], v[76:79]
    s_cmp_eq_u32 s84, 1
    s_cbranch_scc1 attn_kernel_ra14
    v_lshrrev_b32 v4, 2, v2
    v_lshlrev_b32 v4, 6, v4
    v_and_b32 v248, 3, v2
    v_lshl_add_u32 v4, v248, 3, v4
    v_add_u32 v4, s73, v4
    ds_read_b64_tr_b16 v[248:249], v4 offset:0
    ds_read_b64_tr_b16 v[250:251], v4 offset:1024
    s_branch attn_kernel_rj15
attn_kernel_ra14:
    v_and_b32 v4, 15, v2
    v_lshlrev_b32 v4, 7, v4
    v_lshrrev_b32 v248, 4, v2
    v_lshl_add_u32 v4, v248, 3, v4
    v_add_u32 v4, s73, v4
    ds_read_b64 v[248:249], v4 offset:0
    ds_read_b64 v[250:251], v4 offset:32
attn_kernel_rj15:
    v_cvt_pk_bf16_f32 v191, v6, v7
    ds_read_b128 v[212:215], v235 offset:0
    v_mfma_f32_16x16x32_bf16 v[80:83], v[220:223], v[176:179], v[80:83]
    v_mfma_f32_16x16x32_bf16 v[84:87], v[220:223], v[180:183], v[84:87]
    v_exp_f32 v0, v152
    ds_read_b128 v[216:219], v232 offset:4096
    v_mfma_f32_16x16x32_bf16 v[88:91], v[224:227], v[176:179], v[88:91]
    v_exp_f32 v1, v153
    v_mfma_f32_16x16x32_bf16 v[92:95], v[224:227], v[180:183], v[92:95]
    s_cmp_ge_u32 s52, s57
    s_cselect_b32 s58, s59, s52
    s_add_u32 m0, s50, 49152
    s_nop 0
    buffer_load_dwordx4 v244, s[12:15], s58 offen lds
    v_exp_f32 v6, v156
    ds_read_b128 v[220:223], v233 offset:4096
    v_mfma_f32_16x16x32_bf16 v[96:99], v[228:231], v[176:179], v[96:99]
    v_exp_f32 v7, v157
    v_mfma_f32_16x16x32_bf16 v[100:103], v[228:231], v[180:183], v[100:103]
    v_cvt_pk_bf16_f32 v192, v0, v1
    ds_read_b128 v[224:227], v234 offset:4096
    s_waitcnt lgkmcnt(7)
    v_mfma_f32_16x16x32_bf16 v[104:107], v[200:203], v[8:11], v[236:239]
    v_cvt_pk_bf16_f32 v196, v6, v7
    v_mfma_f32_16x16x32_bf16 v[108:111], v[200:203], v[24:27], v[240:243]
    s_waitcnt lgkmcnt(4)
    buffer_store_dwordx4 v[248:251], v246, s[80:83], s75 offen offset:0 sc0 sc1
    v_exp_f32 v0, v154
    ds_read_b128 v[228:231], v235 offset:4096
    v_mfma_f32_16x16x32_bf16 v[104:107], v[204:207], v[12:15], v[104:107]
    v_exp_f32 v1, v155
    v_mfma_f32_16x16x32_bf16 v[108:111], v[204:207], v[28:31], v[108:111]
    s_add_u32 m0, s50, 50176
    s_nop 0
    buffer_load_dwordx4 v245, s[12:15], s58 offen lds
    s_add_u32 s52, s52, 16384
    v_mfma_f32_16x16x32_bf16 v[168:171], v[252:255], v[184:187], 0
    v_mfma_f32_16x16x32_bf16 v[172:175], v[252:255], v[188:191], 0
    ds_read_b128 v[200:203], v232 offset:8192
    v_mfma_f32_16x16x32_bf16 v[104:107], v[208:211], v[16:19], v[104:107]
    v_exp_f32 v6, v158
    v_mfma_f32_16x16x32_bf16 v[108:111], v[208:211], v[32:35], v[108:111]
    v_exp_f32 v7, v159
    ds_read_b128 v[204:207], v233 offset:8192
    s_waitcnt lgkmcnt(5)
    v_mfma_f32_16x16x32_bf16 v[104:107], v[212:215], v[20:23], v[104:107]
    v_cvt_pk_bf16_f32 v193, v0, v1
    v_mfma_f32_16x16x32_bf16 v[108:111], v[212:215], v[36:39], v[108:111]
    s_cmp_eq_u32 s84, 1
    s_cbranch_scc1 attn_kernel_ra16
    v_lshrrev_b32 v4, 2, v2
    v_lshlrev_b32 v4, 6, v4
    v_and_b32 v248, 3, v2
    v_lshl_add_u32 v4, v248, 3, v4
    v_add_u32 v4, s73, v4
    ds_read_b64_tr_b16 v[248:249], v4 offset:32
    ds_read_b64_tr_b16 v[250:251], v4 offset:1056
    s_branch attn_kernel_rj17
attn_kernel_ra16:
    v_and_b32 v4, 15, v2
    v_lshlrev_b32 v4, 7, v4
    v_lshrrev_b32 v248, 4, v2
    v_lshl_add_u32 v4, v248, 3, v4
    v_add_u32 v4, s73, v4
    ds_read_b64 v[248:249], v4 offset:64
    ds_read_b64 v[250:251], v4 offset:96
attn_kernel_rj17:
    v_cvt_pk_bf16_f32 v197, v6, v7
    ds_read_b128 v[208:211], v234 offset:8192
    v_mfma_f32_16x16x32_bf16 v[112:115], v[216:219], v[8:11], v[236:239]
    v_exp_f32 v0, v160
    v_mfma_f32_16x16x32_bf16 v[116:119], v[216:219], v[24:27], v[240:243]
    s_cmp_ge_u32 s53, s57
    s_cselect_b32 s55, s59, s53
    s_add_u32 m0, s50, 98304
    s_nop 0
    buffer_load_dwordx4 v246, s[16:19], s55 offen lds
    v_exp_f32 v1, v161
    ds_read_b128 v[212:215], v235 offset:8192
    s_waitcnt lgkmcnt(7)
    v_mfma_f32_16x16x32_bf16 v[112:115], v[220:223], v[12:15], v[112:115]
    v_exp_f32 v6, v164
    v_mfma_f32_16x16x32_bf16 v[116:119], v[220:223], v[28:31], v[116:119]
    v_exp_f32 v7, v165
    ds_read_b128 v[216:219], v232 offset:12288
    v_mfma_f32_16x16x32_bf16 v[112:115], v[224:227], v[16:19], v[112:115]
    v_mfma_f32_16x16x32_bf16 v[116:119], v[224:227], v[32:35], v[116:119]
    v_cvt_pk_bf16_f32 v194, v0, v1
    ds_read_b128 v[220:223], v233 offset:12288
    s_waitcnt lgkmcnt(7)
    v_mfma_f32_16x16x32_bf16 v[112:115], v[228:231], v[20:23], v[112:115]
    v_cvt_pk_bf16_f32 v198, v6, v7
    v_mfma_f32_16x16x32_bf16 v[116:119], v[228:231], v[36:39], v[116:119]
    s_add_u32 m0, s50, 98304
    s_nop 0
    buffer_load_dwordx4 v246, s[16:19], s55 offen offset:1024 lds
    s_add_u32 s53, s53, 16384
    s_waitcnt lgkmcnt(4)
    buffer_store_dwordx4 v[248:251], v246, s[80:83], s75 offen offset:1024 sc0 sc1
    v_exp_f32 v0, v162
    ds_read_b128 v[224:227], v234 offset:12288
    v_mfma_f32_16x16x32_bf16 v[120:123], v[200:203], v[8:11], v[236:239]
    v_exp_f32 v1, v163
    v_mfma_f32_16x16x32_bf16 v[124:127], v[200:203], v[24:27], v[240:243]
    v_exp_f32 v6, v166
    ds_read_b128 v[228:231], v235 offset:12288
    v_mfma_f32_16x16x32_bf16 v[120:123], v[204:207], v[12:15], v[120:123]
    v_exp_f32 v7, v167
    v_mfma_f32_16x16x32_bf16 v[124:127], v[204:207], v[28:31], v[124:127]
    v_cvt_pk_bf16_f32 v195, v0, v1
    ds_read_b128 v[200:203], v247 offset:49152
    s_waitcnt lgkmcnt(5)
    v_mfma_f32_16x16x32_bf16 v[120:123], v[208:211], v[16:19], v[120:123]
    v_cvt_pk_bf16_f32 v199, v6, v7
    v_mfma_f32_16x16x32_bf16 v[124:127], v[208:211], v[32:35], v[124:127]
    ds_read_b128 v[204:207], v247 offset:50176
    v_mfma_f32_16x16x32_bf16 v[120:123], v[212:215], v[20:23], v[120:123]
    v_mfma_f32_16x16x32_bf16 v[124:127], v[212:215], v[36:39], v[124:127]
    v_mfma_f32_16x16x32_bf16 v[168:171], v[252:255], v[192:195], v[168:171]
    v_mfma_f32_16x16x32_bf16 v[172:175], v[252:255], v[196:199], v[172:175]
    ds_read_b128 v[208:211], v247 offset:51200
    s_waitcnt lgkmcnt(5)
    v_mfma_f32_16x16x32_bf16 v[128:131], v[216:219], v[8:11], v[236:239]
    v_mfma_f32_16x16x32_bf16 v[132:135], v[216:219], v[24:27], v[240:243]
    ds_read_b128 v[212:215], v247 offset:52224
    v_mfma_f32_16x16x32_bf16 v[128:131], v[220:223], v[12:15], v[128:131]
    v_mfma_f32_16x16x32_bf16 v[132:135], v[220:223], v[28:31], v[132:135]
    ds_read_b128 v[216:219], v247 offset:53248
    s_waitcnt lgkmcnt(5)
    v_mfma_f32_16x16x32_bf16 v[128:131], v[224:227], v[16:19], v[128:131]
    v_mfma_f32_16x16x32_bf16 v[132:135], v[224:227], v[32:35], v[132:135]
    ds_read_b128 v[220:223], v247 offset:54272
    v_mfma_f32_16x16x32_bf16 v[128:131], v[228:231], v[20:23], v[128:131]
    v_mfma_f32_16x16x32_bf16 v[132:135], v[228:231], v[36:39], v[132:135]
    v_add_f32 v4, v168, v172
    v_cmp_nge_f32 vcc, s63, v4
    s_cbranch_vccnz attn_kernel_slow18
attn_kernel_ret19:
    v_add_f32 v3, v3, v168
    v_add_f32 v5, v5, v172
    s_sub_u32 s56, s56, 1
    s_cmp_lg_u32 s56, 0
    s_cbranch_scc1 attn_kernel_loop2
    ds_read_b128 v[224:227], v247 offset:55296
    s_waitcnt lgkmcnt(6)
    v_mfma_f32_16x16x32_bf16 v[40:43], v[200:203], v[184:187], v[40:43]
    v_mfma_f32_16x16x32_bf16 v[44:47], v[200:203], v[188:191], v[44:47]
    ds_read_b128 v[228:231], v247 offset:56320
    s_waitcnt lgkmcnt(6)
    v_mfma_f32_16x16x32_bf16 v[48:51], v[204:207], v[184:187], v[48:51]
    v_mfma_f32_16x16x32_bf16 v[52:55], v[204:207], v[188:191], v[52:55]
    ds_read_b128 v[200:203], v247 offset:57344
    s_waitcnt lgkmcnt(6)
    v_mfma_f32_16x16x32_bf16 v[56:59], v[208:211], v[184:187], v[56:59]
    v_mfma_f32_16x16x32_bf16 v[60:63], v[208:211], v[188:191], v[60:63]
    ds_read_b128 v[204:207], v247 offset:58368
    s_waitcnt lgkmcnt(6)
    v_mfma_f32_16x16x32_bf16 v[64:67], v[212:215], v[184:187], v[64:67]
    v_mfma_f32_16x16x32_bf16 v[68:71], v[212:215], v[188:191], v[68:71]
    ds_read_b128 v[208:211], v247 offset:59392
    s_waitcnt lgkmcnt(6)
    v_mfma_f32_16x16x32_bf16 v[72:75], v[216:219], v[184:187], v[72:75]
    v_mfma_f32_16x16x32_bf16 v[76:79], v[216:219], v[188:191], v[76:79]
    ds_read_b128 v[212:215], v247 offset:60416
    s_waitcnt lgkmcnt(6)
    v_mfma_f32_16x16x32_bf16 v[80:83], v[220:223], v[184:187], v[80:83]
    v_mfma_f32_16x16x32_bf16 v[84:87], v[220:223], v[188:191], v[84:87]
    ds_read_b128 v[216:219], v247 offset:61440
    s_waitcnt lgkmcnt(6)
    v_mfma_f32_16x16x32_bf16 v[88:91], v[224:227], v[184:187], v[88:91]
    v_mfma_f32_16x16x32_bf16 v[92:95], v[224:227], v[188:191], v[92:95]
    ds_read_b128 v[220:223], v247 offset:62464
    s_waitcnt lgkmcnt(6)
    v_mfma_f32_16x16x32_bf16 v[96:99], v[228:231], v[184:187], v[96:99]
    v_mfma_f32_16x16x32_bf16 v[100:103], v[228:231], v[188:191], v[100:103]
    ds_read_b128 v[224:227], v247 offset:63488
    s_waitcnt lgkmcnt(6)
    v_mfma_f32_16x16x32_bf16 v[40:43], v[200:203], v[192:195], v[40:43]
    v_mfma_f32_16x16x32_bf16 v[44:47], v[200:203], v[196:199], v[44:47]
    ds_read_b128 v[228:231], v247 offset:64512
    s_waitcnt lgkmcnt(6)
    v_mfma_f32_16x16x32_bf16 v[48:51], v[204:207], v[192:195], v[48:51]
    v_mfma_f32_16x16x32_bf16 v[52:55], v[204:207], v[196:199], v[52:55]
    s_waitcnt lgkmcnt(5)
    v_mfma_f32_16x16x32_bf16 v[56:59], v[208:211], v[192:195], v[56:59]
    v_mfma_f32_16x16x32_bf16 v[60:63], v[208:211], v[196:199], v[60:63]
    s_waitcnt lgkmcnt(4)
    v_mfma_f32_16x16x32_bf16 v[64:67], v[212:215], v[192:195], v[64:67]
    v_mfma_f32_16x16x32_bf16 v[68:71], v[212:215], v[196:199], v[68:71]
    s_waitcnt lgkmcnt(3)
    v_mfma_f32_16x16x32_bf16 v[72:75], v[216:219], v[192:195], v[72:75]
    v_mfma_f32_16x16x32_bf16 v[76:79], v[216:219], v[196:199], v[76:79]
    s_waitcnt lgkmcnt(2)
    v_mfma_f32_16x16x32_bf16 v[80:83], v[220:223], v[192:195], v[80:83]
    v_mfma_f32_16x16x32_bf16 v[84:87], v[220:223], v[196:199], v[84:87]
    s_waitcnt lgkmcnt(1)
    v_mfma_f32_16x16x32_bf16 v[88:91], v[224:227], v[192:195], v[88:91]
    v_mfma_f32_16x16x32_bf16 v[92:95], v[224:227], v[196:199], v[92:95]
    s_waitcnt lgkmcnt(0)
    v_mfma_f32_16x16x32_bf16 v[96:99], v[228:231], v[192:195], v[96:99]
    v_mfma_f32_16x16x32_bf16 v[100:103], v[228:231], v[196:199], v[100:103]
    v_rcp_f32 v1, v3
    s_nop 0
    v_fma_f32 v4, -v3, v1, 1.0
    v_fma_f32 v3, v4, v1, v1
    v_rcp_f32 v1, v5
    s_nop 0
    v_fma_f32 v4, -v5, v1, 1.0
    v_fma_f32 v5, v4, v1, v1
    v_lshlrev_b32 v6, 4, v2
    s_lshl_b32 s51, s46, 13
    s_lshl_b32 s54, s43, 12
    s_add_u32 s51, s51, s54
    v_mul_f32 v40, v40, v3
    v_mul_f32 v41, v41, v3
    v_mul_f32 v42, v42, v3
    v_mul_f32 v43, v43, v3
    v_cvt_pk_bf16_f32 v104, v40, v41
    v_cvt_pk_bf16_f32 v105, v42, v43
    v_mul_f32 v48, v48, v3
    v_mul_f32 v49, v49, v3
    v_mul_f32 v50, v50, v3
    v_mul_f32 v51, v51, v3
    v_cvt_pk_bf16_f32 v106, v48, v49
    v_cvt_pk_bf16_f32 v107, v50, v51
    buffer_store_dwordx4 v[104:107], v6, s[28:31], s51 offen offset:0 sc0 sc1
    v_mul_f32 v56, v56, v3
    v_mul_f32 v57, v57, v3
    v_mul_f32 v58, v58, v3
    v_mul_f32 v59, v59, v3
    v_cvt_pk_bf16_f32 v108, v56, v57
    v_cvt_pk_bf16_f32 v109, v58, v59
    v_mul_f32 v64, v64, v3
    v_mul_f32 v65, v65, v3
    v_mul_f32 v66, v66, v3
    v_mul_f32 v67, v67, v3
    v_cvt_pk_bf16_f32 v110, v64, v65
    v_cvt_pk_bf16_f32 v111, v66, v67
    buffer_store_dwordx4 v[108:111], v6, s[28:31], s51 offen offset:1024 sc0 sc1
    v_mul_f32 v72, v72, v3
    v_mul_f32 v73, v73, v3
    v_mul_f32 v74, v74, v3
    v_mul_f32 v75, v75, v3
    v_cvt_pk_bf16_f32 v112, v72, v73
    v_cvt_pk_bf16_f32 v113, v74, v75
    v_mul_f32 v80, v80, v3
    v_mul_f32 v81, v81, v3
    v_mul_f32 v82, v82, v3
    v_mul_f32 v83, v83, v3
    v_cvt_pk_bf16_f32 v114, v80, v81
    v_cvt_pk_bf16_f32 v115, v82, v83
    buffer_store_dwordx4 v[112:115], v6, s[28:31], s51 offen offset:2048 sc0 sc1
    v_mul_f32 v88, v88, v3
    v_mul_f32 v89, v89, v3
    v_mul_f32 v90, v90, v3
    v_mul_f32 v91, v91, v3
    v_cvt_pk_bf16_f32 v116, v88, v89
    v_cvt_pk_bf16_f32 v117, v90, v91
    v_mul_f32 v96, v96, v3
    v_mul_f32 v97, v97, v3
    v_mul_f32 v98, v98, v3
    v_mul_f32 v99, v99, v3
    v_cvt_pk_bf16_f32 v118, v96, v97
    v_cvt_pk_bf16_f32 v119, v98, v99
    buffer_store_dwordx4 v[116:119], v6, s[28:31], s51 offen offset:3072 sc0 sc1
    s_add_u32 s51, s51, 131072
    v_mul_f32 v44, v44, v5
    v_mul_f32 v45, v45, v5
    v_mul_f32 v46, v46, v5
    v_mul_f32 v47, v47, v5
    v_cvt_pk_bf16_f32 v120, v44, v45
    v_cvt_pk_bf16_f32 v121, v46, v47
    v_mul_f32 v52, v52, v5
    v_mul_f32 v53, v53, v5
    v_mul_f32 v54, v54, v5
    v_mul_f32 v55, v55, v5
    v_cvt_pk_bf16_f32 v122, v52, v53
    v_cvt_pk_bf16_f32 v123, v54, v55
    buffer_store_dwordx4 v[120:123], v6, s[28:31], s51 offen offset:0 sc0 sc1
    v_mul_f32 v60, v60, v5
    v_mul_f32 v61, v61, v5
    v_mul_f32 v62, v62, v5
    v_mul_f32 v63, v63, v5
    v_cvt_pk_bf16_f32 v124, v60, v61
    v_cvt_pk_bf16_f32 v125, v62, v63
    v_mul_f32 v68, v68, v5
    v_mul_f32 v69, v69, v5
    v_mul_f32 v70, v70, v5
    v_mul_f32 v71, v71, v5
    v_cvt_pk_bf16_f32 v126, v68, v69
    v_cvt_pk_bf16_f32 v127, v70, v71
    buffer_store_dwordx4 v[124:127], v6, s[28:31], s51 offen offset:1024 sc0 sc1
    v_mul_f32 v76, v76, v5
    v_mul_f32 v77, v77, v5
    v_mul_f32 v78, v78, v5
    v_mul_f32 v79, v79, v5
    v_cvt_pk_bf16_f32 v128, v76, v77
    v_cvt_pk_bf16_f32 v129, v78, v79
    v_mul_f32 v84, v84, v5
    v_mul_f32 v85, v85, v5
    v_mul_f32 v86, v86, v5
    v_mul_f32 v87, v87, v5
    v_cvt_pk_bf16_f32 v130, v84, v85
    v_cvt_pk_bf16_f32 v131, v86, v87
    buffer_store_dwordx4 v[128:131], v6, s[28:31], s51 offen offset:2048 sc0 sc1
    v_mul_f32 v92, v92, v5
    v_mul_f32 v93, v93, v5
    v_mul_f32 v94, v94, v5
    v_mul_f32 v95, v95, v5
    v_cvt_pk_bf16_f32 v132, v92, v93
    v_cvt_pk_bf16_f32 v133, v94, v95
    v_mul_f32 v100, v100, v5
    v_mul_f32 v101, v101, v5
    v_mul_f32 v102, v102, v5
    v_mul_f32 v103, v103, v5
    v_cvt_pk_bf16_f32 v134, v100, v101
    v_cvt_pk_bf16_f32 v135, v102, v103
    buffer_store_dwordx4 v[132:135], v6, s[28:31], s51 offen offset:3072 sc0 sc1
    s_add_u32 s51, s51, 131072
    s_waitcnt vmcnt(0)
attn_kernel_done1:
    s_endpgm
attn_kernel_slow8:
    s_nop 15
    v_max3_f32 v1, v104, v105, v106
    v_max3_f32 v1, v1, v107, v112
    v_max3_f32 v1, v1, v113, v114
    v_max3_f32 v1, v1, v115, v120
    v_max3_f32 v1, v1, v121, v122
    v_max3_f32 v1, v1, v123, v128
    v_max3_f32 v1, v1, v129, v130
    v_max_f32 v1, v1, v131
    ds_swizzle_b32 v0, v1 offset:0x401F
    s_waitcnt lgkmcnt(0)
    v_max_f32 v1, v1, v0
    v_mov_b32 v0, v1
    s_nop 1
    v_permlane32_swap_b32 v0, v1
    v_max_f32 v1, v1, v0
    v_max_f32 v1, s61, v1
    v_add_f32 v1, 0x42000000, v1
    v_sub_f32 v236, v236, v1
    v_sub_f32 v237, v237, v1
    v_sub_f32 v238, v238, v1
    v_sub_f32 v239, v239, v1
    v_sub_f32 v136, v136, v1
    v_sub_f32 v137, v137, v1
    v_sub_f32 v138, v138, v1
    v_sub_f32 v139, v139, v1
    v_sub_f32 v144, v144, v1
    v_sub_f32 v145, v145, v1
    v_sub_f32 v146, v146, v1
    v_sub_f32 v147, v147, v1
    v_sub_f32 v152, v152, v1
    v_sub_f32 v153, v153, v1
    v_sub_f32 v154, v154, v1
    v_sub_f32 v155, v155, v1
    v_sub_f32 v160, v160, v1
    v_sub_f32 v161, v161, v1
    v_sub_f32 v162, v162, v1
    v_sub_f32 v163, v163, v1
    v_max_f32 v0, 0, v1
    v_exp_f32 v0, -v0
    s_nop 0
    v_mul_f32 v3, v3, v0
    v_mul_f32 v40, v40, v0
    v_mul_f32 v41, v41, v0
    v_mul_f32 v42, v42, v0
    v_mul_f32 v43, v43, v0
    v_mul_f32 v48, v48, v0
    v_mul_f32 v49, v49, v0
    v_mul_f32 v50, v50, v0
    v_mul_f32 v51, v51, v0
    v_mul_f32 v56, v56, v0
    v_mul_f32 v57, v57, v0
    v_mul_f32 v58, v58, v0
    v_mul_f32 v59, v59, v0
    v_mul_f32 v64, v64, v0
    v_mul_f32 v65, v65, v0
    v_mul_f32 v66, v66, v0
    v_mul_f32 v67, v67, v0
    v_mul_f32 v72, v72, v0
    v_mul_f32 v73, v73, v0
    v_mul_f32 v74, v74, v0
    v_mul_f32 v75, v75, v0
    v_mul_f32 v80, v80, v0
    v_mul_f32 v81, v81, v0
    v_mul_f32 v82, v82, v0
    v_mul_f32 v83, v83, v0
    v_mul_f32 v88, v88, v0
    v_mul_f32 v89, v89, v0
    v_mul_f32 v90, v90, v0
    v_mul_f32 v91, v91, v0
    v_mul_f32 v96, v96, v0
    v_mul_f32 v97, v97, v0
    v_mul_f32 v98, v98, v0
    v_mul_f32 v99, v99, v0
    v_mov_b32 v184, 0
    v_sub_f32 v4, v104, v1
    v_sub_f32 v6, v105, v1
    v_exp_f32 v4, v4
    v_exp_f32 v6, v6
    v_add_f32 v184, v184, v4
    v_add_f32 v184, v184, v6
    v_cvt_pk_bf16_f32 v168, v4, v6
    v_sub_f32 v4, v106, v1
    v_sub_f32 v6, v107, v1
    v_exp_f32 v4, v4
    v_exp_f32 v6, v6
    v_add_f32 v184, v184, v4
    v_add_f32 v184, v184, v6
    v_cvt_pk_bf16_f32 v169, v4, v6
    v_sub_f32 v4, v112, v1
    v_sub_f32 v6, v113, v1
    v_exp_f32 v4, v4
    v_exp_f32 v6, v6
    v_add_f32 v184, v184, v4
    v_add_f32 v184, v184, v6
    v_cvt_pk_bf16_f32 v170, v4, v6
    v_sub_f32 v4, v114, v1
    v_sub_f32 v6, v115, v1
    v_exp_f32 v4, v4
    v_exp_f32 v6, v6
    v_add_f32 v184, v184, v4
    v_add_f32 v184, v184, v6
    v_cvt_pk_bf16_f32 v171, v4, v6
    v_sub_f32 v4, v120, v1
    v_sub_f32 v6, v121, v1
    v_exp_f32 v4, v4
    v_exp_f32 v6, v6
    v_add_f32 v184, v184, v4
    v_add_f32 v184, v184, v6
    v_cvt_pk_bf16_f32 v176, v4, v6
    v_sub_f32 v4, v122, v1
    v_sub_f32 v6, v123, v1
    v_exp_f32 v4, v4
    v_exp_f32 v6, v6
    v_add_f32 v184, v184, v4
    v_add_f32 v184, v184, v6
    v_cvt_pk_bf16_f32 v177, v4, v6
    v_sub_f32 v4, v128, v1
    v_sub_f32 v6, v129, v1
    v_exp_f32 v4, v4
    v_exp_f32 v6, v6
    v_add_f32 v184, v184, v4
    v_add_f32 v184, v184, v6
    v_cvt_pk_bf16_f32 v178, v4, v6
    v_sub_f32 v4, v130, v1
    v_sub_f32 v6, v131, v1
    v_exp_f32 v4, v4
    v_exp_f32 v6, v6
    v_add_f32 v184, v184, v4
    v_add_f32 v184, v184, v6
    v_cvt_pk_bf16_f32 v179, v4, v6
    ds_swizzle_b32 v0, v184 offset:0x401F
    s_waitcnt lgkmcnt(0)
    v_add_f32 v184, v184, v0
    v_mov_b32 v0, v184
    s_nop 1
    v_permlane32_swap_b32 v0, v184
    v_add_f32 v184, v184, v0
    v_max3_f32 v1, v108, v109, v110
    v_max3_f32 v1, v1, v111, v116
    v_max3_f32 v1, v1, v117, v118
    v_max3_f32 v1, v1, v119, v124
    v_max3_f32 v1, v1, v125, v126
    v_max3_f32 v1, v1, v127, v132
    v_max3_f32 v1, v1, v133, v134
    v_max_f32 v1, v1, v135
    ds_swizzle_b32 v0, v1 offset:0x401F
    s_waitcnt lgkmcnt(0)
    v_max_f32 v1, v1, v0
    v_mov_b32 v0, v1
    s_nop 1
    v_permlane32_swap_b32 v0, v1
    v_max_f32 v1, v1, v0
    v_max_f32 v1, s61, v1
    v_add_f32 v1, 0x42000000, v1
    v_sub_f32 v240, v240, v1
    v_sub_f32 v241, v241, v1
    v_sub_f32 v242, v242, v1
    v_sub_f32 v243, v243, v1
    v_sub_f32 v140, v140, v1
    v_sub_f32 v141, v141, v1
    v_sub_f32 v142, v142, v1
    v_sub_f32 v143, v143, v1
    v_sub_f32 v148, v148, v1
    v_sub_f32 v149, v149, v1
    v_sub_f32 v150, v150, v1
    v_sub_f32 v151, v151, v1
    v_sub_f32 v156, v156, v1
    v_sub_f32 v157, v157, v1
    v_sub_f32 v158, v158, v1
    v_sub_f32 v159, v159, v1
    v_sub_f32 v164, v164, v1
    v_sub_f32 v165, v165, v1
    v_sub_f32 v166, v166, v1
    v_sub_f32 v167, v167, v1
    v_max_f32 v0, 0, v1
    v_exp_f32 v0, -v0
    s_nop 0
    v_mul_f32 v5, v5, v0
    v_mul_f32 v44, v44, v0
    v_mul_f32 v45, v45, v0
    v_mul_f32 v46, v46, v0
    v_mul_f32 v47, v47, v0
    v_mul_f32 v52, v52, v0
    v_mul_f32 v53, v53, v0
    v_mul_f32 v54, v54, v0
    v_mul_f32 v55, v55, v0
    v_mul_f32 v60, v60, v0
    v_mul_f32 v61, v61, v0
    v_mul_f32 v62, v62, v0
    v_mul_f32 v63, v63, v0
    v_mul_f32 v68, v68, v0
    v_mul_f32 v69, v69, v0
    v_mul_f32 v70, v70, v0
    v_mul_f32 v71, v71, v0
    v_mul_f32 v76, v76, v0
    v_mul_f32 v77, v77, v0
    v_mul_f32 v78, v78, v0
    v_mul_f32 v79, v79, v0
    v_mul_f32 v84, v84, v0
    v_mul_f32 v85, v85, v0
    v_mul_f32 v86, v86, v0
    v_mul_f32 v87, v87, v0
    v_mul_f32 v92, v92, v0
    v_mul_f32 v93, v93, v0
    v_mul_f32 v94, v94, v0
    v_mul_f32 v95, v95, v0
    v_mul_f32 v100, v100, v0
    v_mul_f32 v101, v101, v0
    v_mul_f32 v102, v102, v0
    v_mul_f32 v103, v103, v0
    v_mov_b32 v188, 0
    v_sub_f32 v4, v108, v1
    v_sub_f32 v6, v109, v1
    v_exp_f32 v4, v4
    v_exp_f32 v6, v6
    v_add_f32 v188, v188, v4
    v_add_f32 v188, v188, v6
    v_cvt_pk_bf16_f32 v172, v4, v6
    v_sub_f32 v4, v110, v1
    v_sub_f32 v6, v111, v1
    v_exp_f32 v4, v4
    v_exp_f32 v6, v6
    v_add_f32 v188, v188, v4
    v_add_f32 v188, v188, v6
    v_cvt_pk_bf16_f32 v173, v4, v6
    v_sub_f32 v4, v116, v1
    v_sub_f32 v6, v117, v1
    v_exp_f32 v4, v4
    v_exp_f32 v6, v6
    v_add_f32 v188, v188, v4
    v_add_f32 v188, v188, v6
    v_cvt_pk_bf16_f32 v174, v4, v6
    v_sub_f32 v4, v118, v1
    v_sub_f32 v6, v119, v1
    v_exp_f32 v4, v4
    v_exp_f32 v6, v6
    v_add_f32 v188, v188, v4
    v_add_f32 v188, v188, v6
    v_cvt_pk_bf16_f32 v175, v4, v6
    v_sub_f32 v4, v124, v1
    v_sub_f32 v6, v125, v1
    v_exp_f32 v4, v4
    v_exp_f32 v6, v6
    v_add_f32 v188, v188, v4
    v_add_f32 v188, v188, v6
    v_cvt_pk_bf16_f32 v180, v4, v6
    v_sub_f32 v4, v126, v1
    v_sub_f32 v6, v127, v1
    v_exp_f32 v4, v4
    v_exp_f32 v6, v6
    v_add_f32 v188, v188, v4
    v_add_f32 v188, v188, v6
    v_cvt_pk_bf16_f32 v181, v4, v6
    v_sub_f32 v4, v132, v1
    v_sub_f32 v6, v133, v1
    v_exp_f32 v4, v4
    v_exp_f32 v6, v6
    v_add_f32 v188, v188, v4
    v_add_f32 v188, v188, v6
    v_cvt_pk_bf16_f32 v182, v4, v6
    v_sub_f32 v4, v134, v1
    v_sub_f32 v6, v135, v1
    v_exp_f32 v4, v4
    v_exp_f32 v6, v6
    v_add_f32 v188, v188, v4
    v_add_f32 v188, v188, v6
    v_cvt_pk_bf16_f32 v183, v4, v6
    ds_swizzle_b32 v0, v188 offset:0x401F
    s_waitcnt lgkmcnt(0)
    v_add_f32 v188, v188, v0
    v_mov_b32 v0, v188
    s_nop 1
    v_permlane32_swap_b32 v0, v188
    v_add_f32 v188, v188, v0
    s_mov_b32 s61, 0xc2000000
    s_mov_b32 s63, 0x67800000
    s_nop 3
    s_branch attn_kernel_ret9
attn_kernel_slow10:
    s_nop 15
    v_max3_f32 v1, v136, v137, v138
    v_max3_f32 v1, v1, v139, v144
    v_max3_f32 v1, v1, v145, v146
    v_max3_f32 v1, v1, v147, v152
    v_max3_f32 v1, v1, v153, v154
    v_max3_f32 v1, v1, v155, v160
    v_max3_f32 v1, v1, v161, v162
    v_max_f32 v1, v1, v163
    ds_swizzle_b32 v0, v1 offset:0x401F
    s_waitcnt lgkmcnt(0)
    v_max_f32 v1, v1, v0
    v_mov_b32 v0, v1
    s_nop 1
    v_permlane32_swap_b32 v0, v1
    v_max_f32 v1, v1, v0
    v_max_f32 v1, s61, v1
    v_add_f32 v1, 0x42000000, v1
    v_sub_f32 v236, v236, v1
    v_sub_f32 v237, v237, v1
    v_sub_f32 v238, v238, v1
    v_sub_f32 v239, v239, v1
    v_sub_f32 v104, v104, v1
    v_sub_f32 v105, v105, v1
    v_sub_f32 v106, v106, v1
    v_sub_f32 v107, v107, v1
    v_sub_f32 v112, v112, v1
    v_sub_f32 v113, v113, v1
    v_sub_f32 v114, v114, v1
    v_sub_f32 v115, v115, v1
    v_sub_f32 v120, v120, v1
    v_sub_f32 v121, v121, v1
    v_sub_f32 v122, v122, v1
    v_sub_f32 v123, v123, v1
    v_sub_f32 v128, v128, v1
    v_sub_f32 v129, v129, v1
    v_sub_f32 v130, v130, v1
    v_sub_f32 v131, v131, v1
    v_max_f32 v0, 0, v1
    v_exp_f32 v0, -v0
    s_nop 0
    v_mul_f32 v3, v3, v0
    v_mul_f32 v40, v40, v0
    v_mul_f32 v41, v41, v0
    v_mul_f32 v42, v42, v0
    v_mul_f32 v43, v43, v0
    v_mul_f32 v48, v48, v0
    v_mul_f32 v49, v49, v0
    v_mul_f32 v50, v50, v0
    v_mul_f32 v51, v51, v0
    v_mul_f32 v56, v56, v0
    v_mul_f32 v57, v57, v0
    v_mul_f32 v58, v58, v0
    v_mul_f32 v59, v59, v0
    v_mul_f32 v64, v64, v0
    v_mul_f32 v65, v65, v0
    v_mul_f32 v66, v66, v0
    v_mul_f32 v67, v67, v0
    v_mul_f32 v72, v72, v0
    v_mul_f32 v73, v73, v0
    v_mul_f32 v74, v74, v0
    v_mul_f32 v75, v75, v0
    v_mul_f32 v80, v80, v0
    v_mul_f32 v81, v81, v0
    v_mul_f32 v82, v82, v0
    v_mul_f32 v83, v83, v0
    v_mul_f32 v88, v88, v0
    v_mul_f32 v89, v89, v0
    v_mul_f32 v90, v90, v0
    v_mul_f32 v91, v91, v0
    v_mul_f32 v96, v96, v0
    v_mul_f32 v97, v97, v0
    v_mul_f32 v98, v98, v0
    v_mul_f32 v99, v99, v0
    v_mov_b32 v168, 0
    v_sub_f32 v4, v136, v1
    v_sub_f32 v6, v137, v1
    v_exp_f32 v4, v4
    v_exp_f32 v6, v6
    v_add_f32 v168, v168, v4
    v_add_f32 v168, v168, v6
    v_cvt_pk_bf16_f32 v184, v4, v6
    v_sub_f32 v4, v138, v1
    v_sub_f32 v6, v139, v1
    v_exp_f32 v4, v4
    v_exp_f32 v6, v6
    v_add_f32 v168, v168, v4
    v_add_f32 v168, v168, v6
    v_cvt_pk_bf16_f32 v185, v4, v6
    v_sub_f32 v4, v144, v1
    v_sub_f32 v6, v145, v1
    v_exp_f32 v4, v4
    v_exp_f32 v6, v6
    v_add_f32 v168, v168, v4
    v_add_f32 v168, v168, v6
    v_cvt_pk_bf16_f32 v186, v4, v6
    v_sub_f32 v4, v146, v1
    v_sub_f32 v6, v147, v1
    v_exp_f32 v4, v4
    v_exp_f32 v6, v6
    v_add_f32 v168, v168, v4
    v_add_f32 v168, v168, v6
    v_cvt_pk_bf16_f32 v187, v4, v6
    v_sub_f32 v4, v152, v1
    v_sub_f32 v6, v153, v1
    v_exp_f32 v4, v4
    v_exp_f32 v6, v6
    v_add_f32 v168, v168, v4
    v_add_f32 v168, v168, v6
    v_cvt_pk_bf16_f32 v192, v4, v6
    v_sub_f32 v4, v154, v1
    v_sub_f32 v6, v155, v1
    v_exp_f32 v4, v4
    v_exp_f32 v6, v6
    v_add_f32 v168, v168, v4
    v_add_f32 v168, v168, v6
    v_cvt_pk_bf16_f32 v193, v4, v6
    v_sub_f32 v4, v160, v1
    v_sub_f32 v6, v161, v1
    v_exp_f32 v4, v4
    v_exp_f32 v6, v6
    v_add_f32 v168, v168, v4
    v_add_f32 v168, v168, v6
    v_cvt_pk_bf16_f32 v194, v4, v6
    v_sub_f32 v4, v162, v1
    v_sub_f32 v6, v163, v1
    v_exp_f32 v4, v4
    v_exp_f32 v6, v6
    v_add_f32 v168, v168, v4
    v_add_f32 v168, v168, v6
    v_cvt_pk_bf16_f32 v195, v4, v6
    ds_swizzle_b32 v0, v168 offset:0x401F
    s_waitcnt lgkmcnt(0)
    v_add_f32 v168, v168, v0
    v_mov_b32 v0, v168
    s_nop 1
    v_permlane32_swap_b32 v0, v168
    v_add_f32 v168, v168, v0
    v_max3_f32 v1, v140, v141, v142
    v_max3_f32 v1, v1, v143, v148
    v_max3_f32 v1, v1, v149, v150
    v_max3_f32 v1, v1, v151, v156
    v_max3_f32 v1, v1, v157, v158
    v_max3_f32 v1, v1, v159, v164
    v_max3_f32 v1, v1, v165, v166
    v_max_f32 v1, v1, v167
    ds_swizzle_b32 v0, v1 offset:0x401F
    s_waitcnt lgkmcnt(0)
    v_max_f32 v1, v1, v0
    v_mov_b32 v0, v1
    s_nop 1
    v_permlane32_swap_b32 v0, v1
    v_max_f32 v1, v1, v0
    v_max_f32 v1, s61, v1
    v_add_f32 v1, 0x42000000, v1
    v_sub_f32 v240, v240, v1
    v_sub_f32 v241, v241, v1
    v_sub_f32 v242, v242, v1
    v_sub_f32 v243, v243, v1
    v_sub_f32 v108, v108, v1
    v_sub_f32 v109, v109, v1
    v_sub_f32 v110, v110, v1
    v_sub_f32 v111, v111, v1
    v_sub_f32 v116, v116, v1
    v_sub_f32 v117, v117, v1
    v_sub_f32 v118, v118, v1
    v_sub_f32 v119, v119, v1
    v_sub_f32 v124, v124, v1
    v_sub_f32 v125, v125, v1
    v_sub_f32 v126, v126, v1
    v_sub_f32 v127, v127, v1
    v_sub_f32 v132, v132, v1
    v_sub_f32 v133, v133, v1
    v_sub_f32 v134, v134, v1
    v_sub_f32 v135, v135, v1
    v_max_f32 v0, 0, v1
    v_exp_f32 v0, -v0
    s_nop 0
    v_mul_f32 v5, v5, v0
    v_mul_f32 v44, v44, v0
    v_mul_f32 v45, v45, v0
    v_mul_f32 v46, v46, v0
    v_mul_f32 v47, v47, v0
    v_mul_f32 v52, v52, v0
    v_mul_f32 v53, v53, v0
    v_mul_f32 v54, v54, v0
    v_mul_f32 v55, v55, v0
    v_mul_f32 v60, v60, v0
    v_mul_f32 v61, v61, v0
    v_mul_f32 v62, v62, v0
    v_mul_f32 v63, v63, v0
    v_mul_f32 v68, v68, v0
    v_mul_f32 v69, v69, v0
    v_mul_f32 v70, v70, v0
    v_mul_f32 v71, v71, v0
    v_mul_f32 v76, v76, v0
    v_mul_f32 v77, v77, v0
    v_mul_f32 v78, v78, v0
    v_mul_f32 v79, v79, v0
    v_mul_f32 v84, v84, v0
    v_mul_f32 v85, v85, v0
    v_mul_f32 v86, v86, v0
    v_mul_f32 v87, v87, v0
    v_mul_f32 v92, v92, v0
    v_mul_f32 v93, v93, v0
    v_mul_f32 v94, v94, v0
    v_mul_f32 v95, v95, v0
    v_mul_f32 v100, v100, v0
    v_mul_f32 v101, v101, v0
    v_mul_f32 v102, v102, v0
    v_mul_f32 v103, v103, v0
    v_mov_b32 v172, 0
    v_sub_f32 v4, v140, v1
    v_sub_f32 v6, v141, v1
    v_exp_f32 v4, v4
    v_exp_f32 v6, v6
    v_add_f32 v172, v172, v4
    v_add_f32 v172, v172, v6
    v_cvt_pk_bf16_f32 v188, v4, v6
    v_sub_f32 v4, v142, v1
    v_sub_f32 v6, v143, v1
    v_exp_f32 v4, v4
    v_exp_f32 v6, v6
    v_add_f32 v172, v172, v4
    v_add_f32 v172, v172, v6
    v_cvt_pk_bf16_f32 v189, v4, v6
    v_sub_f32 v4, v148, v1
    v_sub_f32 v6, v149, v1
    v_exp_f32 v4, v4
    v_exp_f32 v6, v6
    v_add_f32 v172, v172, v4
    v_add_f32 v172, v172, v6
    v_cvt_pk_bf16_f32 v190, v4, v6
    v_sub_f32 v4, v150, v1
    v_sub_f32 v6, v151, v1
    v_exp_f32 v4, v4
    v_exp_f32 v6, v6
    v_add_f32 v172, v172, v4
    v_add_f32 v172, v172, v6
    v_cvt_pk_bf16_f32 v191, v4, v6
    v_sub_f32 v4, v156, v1
    v_sub_f32 v6, v157, v1
    v_exp_f32 v4, v4
    v_exp_f32 v6, v6
    v_add_f32 v172, v172, v4
    v_add_f32 v172, v172, v6
    v_cvt_pk_bf16_f32 v196, v4, v6
    v_sub_f32 v4, v158, v1
    v_sub_f32 v6, v159, v1
    v_exp_f32 v4, v4
    v_exp_f32 v6, v6
    v_add_f32 v172, v172, v4
    v_add_f32 v172, v172, v6
    v_cvt_pk_bf16_f32 v197, v4, v6
    v_sub_f32 v4, v164, v1
    v_sub_f32 v6, v165, v1
    v_exp_f32 v4, v4
    v_exp_f32 v6, v6
    v_add_f32 v172, v172, v4
    v_add_f32 v172, v172, v6
    v_cvt_pk_bf16_f32 v198, v4, v6
    v_sub_f32 v4, v166, v1
    v_sub_f32 v6, v167, v1
    v_exp_f32 v4, v4
    v_exp_f32 v6, v6
    v_add_f32 v172, v172, v4
    v_add_f32 v172, v172, v6
    v_cvt_pk_bf16_f32 v199, v4, v6
    ds_swizzle_b32 v0, v172 offset:0x401F
    s_waitcnt lgkmcnt(0)
    v_add_f32 v172, v172, v0
    v_mov_b32 v0, v172
    s_nop 1
    v_permlane32_swap_b32 v0, v172
    v_add_f32 v172, v172, v0
    s_mov_b32 s61, 0xc2000000
    s_mov_b32 s63, 0x67800000
    s_nop 3
    s_branch attn_kernel_ret11
attn_kernel_slow12:
    s_nop 15
    v_max3_f32 v1, v104, v105, v106
    v_max3_f32 v1, v1, v107, v112
    v_max3_f32 v1, v1, v113, v114
    v_max3_f32 v1, v1, v115, v120
    v_max3_f32 v1, v1, v121, v122
    v_max3_f32 v1, v1, v123, v128
    v_max3_f32 v1, v1, v129, v130
    v_max_f32 v1, v1, v131
    ds_swizzle_b32 v0, v1 offset:0x401F
    s_waitcnt lgkmcnt(0)
    v_max_f32 v1, v1, v0
    v_mov_b32 v0, v1
    s_nop 1
    v_permlane32_swap_b32 v0, v1
    v_max_f32 v1, v1, v0
    v_max_f32 v1, s61, v1
    v_add_f32 v1, 0x42000000, v1
    v_sub_f32 v236, v236, v1
    v_sub_f32 v237, v237, v1
    v_sub_f32 v238, v238, v1
    v_sub_f32 v239, v239, v1
    v_sub_f32 v136, v136, v1
    v_sub_f32 v137, v137, v1
    v_sub_f32 v138, v138, v1
    v_sub_f32 v139, v139, v1
    v_sub_f32 v144, v144, v1
    v_sub_f32 v145, v145, v1
    v_sub_f32 v146, v146, v1
    v_sub_f32 v147, v147, v1
    v_sub_f32 v152, v152, v1
    v_sub_f32 v153, v153, v1
    v_sub_f32 v154, v154, v1
    v_sub_f32 v155, v155, v1
    v_sub_f32 v160, v160, v1
    v_sub_f32 v161, v161, v1
    v_sub_f32 v162, v162, v1
    v_sub_f32 v163, v163, v1
    v_max_f32 v0, 0, v1
    v_exp_f32 v0, -v0
    s_nop 0
    v_mul_f32 v3, v3, v0
    v_mul_f32 v40, v40, v0
    v_mul_f32 v41, v41, v0
    v_mul_f32 v42, v42, v0
    v_mul_f32 v43, v43, v0
    v_mul_f32 v48, v48, v0
    v_mul_f32 v49, v49, v0
    v_mul_f32 v50, v50, v0
    v_mul_f32 v51, v51, v0
    v_mul_f32 v56, v56, v0
    v_mul_f32 v57, v57, v0
    v_mul_f32 v58, v58, v0
    v_mul_f32 v59, v59, v0
    v_mul_f32 v64, v64, v0
    v_mul_f32 v65, v65, v0
    v_mul_f32 v66, v66, v0
    v_mul_f32 v67, v67, v0
    v_mul_f32 v72, v72, v0
    v_mul_f32 v73, v73, v0
    v_mul_f32 v74, v74, v0
    v_mul_f32 v75, v75, v0
    v_mul_f32 v80, v80, v0
    v_mul_f32 v81, v81, v0
    v_mul_f32 v82, v82, v0
    v_mul_f32 v83, v83, v0
    v_mul_f32 v88, v88, v0
    v_mul_f32 v89, v89, v0
    v_mul_f32 v90, v90, v0
    v_mul_f32 v91, v91, v0
    v_mul_f32 v96, v96, v0
    v_mul_f32 v97, v97, v0
    v_mul_f32 v98, v98, v0
    v_mul_f32 v99, v99, v0
    v_mov_b32 v184, 0
    v_sub_f32 v4, v104, v1
    v_sub_f32 v6, v105, v1
    v_exp_f32 v4, v4
    v_exp_f32 v6, v6
    v_add_f32 v184, v184, v4
    v_add_f32 v184, v184, v6
    v_cvt_pk_bf16_f32 v168, v4, v6
    v_sub_f32 v4, v106, v1
    v_sub_f32 v6, v107, v1
    v_exp_f32 v4, v4
    v_exp_f32 v6, v6
    v_add_f32 v184, v184, v4
    v_add_f32 v184, v184, v6
    v_cvt_pk_bf16_f32 v169, v4, v6
    v_sub_f32 v4, v112, v1
    v_sub_f32 v6, v113, v1
    v_exp_f32 v4, v4
    v_exp_f32 v6, v6
    v_add_f32 v184, v184, v4
    v_add_f32 v184, v184, v6
    v_cvt_pk_bf16_f32 v170, v4, v6
    v_sub_f32 v4, v114, v1
    v_sub_f32 v6, v115, v1
    v_exp_f32 v4, v4
    v_exp_f32 v6, v6
    v_add_f32 v184, v184, v4
    v_add_f32 v184, v184, v6
    v_cvt_pk_bf16_f32 v171, v4, v6
    v_sub_f32 v4, v120, v1
    v_sub_f32 v6, v121, v1
    v_exp_f32 v4, v4
    v_exp_f32 v6, v6
    v_add_f32 v184, v184, v4
    v_add_f32 v184, v184, v6
    v_cvt_pk_bf16_f32 v176, v4, v6
    v_sub_f32 v4, v122, v1
    v_sub_f32 v6, v123, v1
    v_exp_f32 v4, v4
    v_exp_f32 v6, v6
    v_add_f32 v184, v184, v4
    v_add_f32 v184, v184, v6
    v_cvt_pk_bf16_f32 v177, v4, v6
    v_sub_f32 v4, v128, v1
    v_sub_f32 v6, v129, v1
    v_exp_f32 v4, v4
    v_exp_f32 v6, v6
    v_add_f32 v184, v184, v4
    v_add_f32 v184, v184, v6
    v_cvt_pk_bf16_f32 v178, v4, v6
    v_sub_f32 v4, v130, v1
    v_sub_f32 v6, v131, v1
    v_exp_f32 v4, v4
    v_exp_f32 v6, v6
    v_add_f32 v184, v184, v4
    v_add_f32 v184, v184, v6
    v_cvt_pk_bf16_f32 v179, v4, v6
    ds_swizzle_b32 v0, v184 offset:0x401F
    s_waitcnt lgkmcnt(0)
    v_add_f32 v184, v184, v0
    v_mov_b32 v0, v184
    s_nop 1
    v_permlane32_swap_b32 v0, v184
    v_add_f32 v184, v184, v0
    v_max3_f32 v1, v108, v109, v110
    v_max3_f32 v1, v1, v111, v116
    v_max3_f32 v1, v1, v117, v118
    v_max3_f32 v1, v1, v119, v124
    v_max3_f32 v1, v1, v125, v126
    v_max3_f32 v1, v1, v127, v132
    v_max3_f32 v1, v1, v133, v134
    v_max_f32 v1, v1, v135
    ds_swizzle_b32 v0, v1 offset:0x401F
    s_waitcnt lgkmcnt(0)
    v_max_f32 v1, v1, v0
    v_mov_b32 v0, v1
    s_nop 1
    v_permlane32_swap_b32 v0, v1
    v_max_f32 v1, v1, v0
    v_max_f32 v1, s61, v1
    v_add_f32 v1, 0x42000000, v1
    v_sub_f32 v240, v240, v1
    v_sub_f32 v241, v241, v1
    v_sub_f32 v242, v242, v1
    v_sub_f32 v243, v243, v1
    v_sub_f32 v140, v140, v1
    v_sub_f32 v141, v141, v1
    v_sub_f32 v142, v142, v1
    v_sub_f32 v143, v143, v1
    v_sub_f32 v148, v148, v1
    v_sub_f32 v149, v149, v1
    v_sub_f32 v150, v150, v1
    v_sub_f32 v151, v151, v1
    v_sub_f32 v156, v156, v1
    v_sub_f32 v157, v157, v1
    v_sub_f32 v158, v158, v1
    v_sub_f32 v159, v159, v1
    v_sub_f32 v164, v164, v1
    v_sub_f32 v165, v165, v1
    v_sub_f32 v166, v166, v1
    v_sub_f32 v167, v167, v1
    v_max_f32 v0, 0, v1
    v_exp_f32 v0, -v0
    s_nop 0
    v_mul_f32 v5, v5, v0
    v_mul_f32 v44, v44, v0
    v_mul_f32 v45, v45, v0
    v_mul_f32 v46, v46, v0
    v_mul_f32 v47, v47, v0
    v_mul_f32 v52, v52, v0
    v_mul_f32 v53, v53, v0
    v_mul_f32 v54, v54, v0
    v_mul_f32 v55, v55, v0
    v_mul_f32 v60, v60, v0
    v_mul_f32 v61, v61, v0
    v_mul_f32 v62, v62, v0
    v_mul_f32 v63, v63, v0
    v_mul_f32 v68, v68, v0
    v_mul_f32 v69, v69, v0
    v_mul_f32 v70, v70, v0
    v_mul_f32 v71, v71, v0
    v_mul_f32 v76, v76, v0
    v_mul_f32 v77, v77, v0
    v_mul_f32 v78, v78, v0
    v_mul_f32 v79, v79, v0
    v_mul_f32 v84, v84, v0
    v_mul_f32 v85, v85, v0
    v_mul_f32 v86, v86, v0
    v_mul_f32 v87, v87, v0
    v_mul_f32 v92, v92, v0
    v_mul_f32 v93, v93, v0
    v_mul_f32 v94, v94, v0
    v_mul_f32 v95, v95, v0
    v_mul_f32 v100, v100, v0
    v_mul_f32 v101, v101, v0
    v_mul_f32 v102, v102, v0
    v_mul_f32 v103, v103, v0
    v_mov_b32 v188, 0
    v_sub_f32 v4, v108, v1
    v_sub_f32 v6, v109, v1
    v_exp_f32 v4, v4
    v_exp_f32 v6, v6
    v_add_f32 v188, v188, v4
    v_add_f32 v188, v188, v6
    v_cvt_pk_bf16_f32 v172, v4, v6
    v_sub_f32 v4, v110, v1
    v_sub_f32 v6, v111, v1
    v_exp_f32 v4, v4
    v_exp_f32 v6, v6
    v_add_f32 v188, v188, v4
    v_add_f32 v188, v188, v6
    v_cvt_pk_bf16_f32 v173, v4, v6
    v_sub_f32 v4, v116, v1
    v_sub_f32 v6, v117, v1
    v_exp_f32 v4, v4
    v_exp_f32 v6, v6
    v_add_f32 v188, v188, v4
    v_add_f32 v188, v188, v6
    v_cvt_pk_bf16_f32 v174, v4, v6
    v_sub_f32 v4, v118, v1
    v_sub_f32 v6, v119, v1
    v_exp_f32 v4, v4
    v_exp_f32 v6, v6
    v_add_f32 v188, v188, v4
    v_add_f32 v188, v188, v6
    v_cvt_pk_bf16_f32 v175, v4, v6
    v_sub_f32 v4, v124, v1
    v_sub_f32 v6, v125, v1
    v_exp_f32 v4, v4
    v_exp_f32 v6, v6
    v_add_f32 v188, v188, v4
    v_add_f32 v188, v188, v6
    v_cvt_pk_bf16_f32 v180, v4, v6
    v_sub_f32 v4, v126, v1
    v_sub_f32 v6, v127, v1
    v_exp_f32 v4, v4
    v_exp_f32 v6, v6
    v_add_f32 v188, v188, v4
    v_add_f32 v188, v188, v6
    v_cvt_pk_bf16_f32 v181, v4, v6
    v_sub_f32 v4, v132, v1
    v_sub_f32 v6, v133, v1
    v_exp_f32 v4, v4
    v_exp_f32 v6, v6
    v_add_f32 v188, v188, v4
    v_add_f32 v188, v188, v6
    v_cvt_pk_bf16_f32 v182, v4, v6
    v_sub_f32 v4, v134, v1
    v_sub_f32 v6, v135, v1
    v_exp_f32 v4, v4
    v_exp_f32 v6, v6
    v_add_f32 v188, v188, v4
    v_add_f32 v188, v188, v6
    v_cvt_pk_bf16_f32 v183, v4, v6
    ds_swizzle_b32 v0, v188 offset:0x401F
    s_waitcnt lgkmcnt(0)
    v_add_f32 v188, v188, v0
    v_mov_b32 v0, v188
    s_nop 1
    v_permlane32_swap_b32 v0, v188
    v_add_f32 v188, v188, v0
    s_mov_b32 s61, 0xc2000000
    s_mov_b32 s63, 0x67800000
    s_nop 3
    s_branch attn_kernel_ret13
attn_kernel_slow18:
    s_nop 15
    v_max3_f32 v1, v136, v137, v138
    v_max3_f32 v1, v1, v139, v144
    v_max3_f32 v1, v1, v145, v146
    v_max3_f32 v1, v1, v147, v152
    v_max3_f32 v1, v1, v153, v154
    v_max3_f32 v1, v1, v155, v160
    v_max3_f32 v1, v1, v161, v162
    v_max_f32 v1, v1, v163
    ds_swizzle_b32 v0, v1 offset:0x401F
    s_waitcnt lgkmcnt(0)
    v_max_f32 v1, v1, v0
    v_mov_b32 v0, v1
    s_nop 1
    v_permlane32_swap_b32 v0, v1
    v_max_f32 v1, v1, v0
    v_max_f32 v1, s61, v1
    v_add_f32 v1, 0x42000000, v1
    v_sub_f32 v236, v236, v1
    v_sub_f32 v237, v237, v1
    v_sub_f32 v238, v238, v1
    v_sub_f32 v239, v239, v1
    v_sub_f32 v104, v104, v1
    v_sub_f32 v105, v105, v1
    v_sub_f32 v106, v106, v1
    v_sub_f32 v107, v107, v1
    v_sub_f32 v112, v112, v1
    v_sub_f32 v113, v113, v1
    v_sub_f32 v114, v114, v1
    v_sub_f32 v115, v115, v1
    v_sub_f32 v120, v120, v1
    v_sub_f32 v121, v121, v1
    v_sub_f32 v122, v122, v1
    v_sub_f32 v123, v123, v1
    v_sub_f32 v128, v128, v1
    v_sub_f32 v129, v129, v1
    v_sub_f32 v130, v130, v1
    v_sub_f32 v131, v131, v1
    v_max_f32 v0, 0, v1
    v_exp_f32 v0, -v0
    s_nop 0
    v_mul_f32 v3, v3, v0
    v_mul_f32 v40, v40, v0
    v_mul_f32 v41, v41, v0
    v_mul_f32 v42, v42, v0
    v_mul_f32 v43, v43, v0
    v_mul_f32 v48, v48, v0
    v_mul_f32 v49, v49, v0
    v_mul_f32 v50, v50, v0
    v_mul_f32 v51, v51, v0
    v_mul_f32 v56, v56, v0
    v_mul_f32 v57, v57, v0
    v_mul_f32 v58, v58, v0
    v_mul_f32 v59, v59, v0
    v_mul_f32 v64, v64, v0
    v_mul_f32 v65, v65, v0
    v_mul_f32 v66, v66, v0
    v_mul_f32 v67, v67, v0
    v_mul_f32 v72, v72, v0
    v_mul_f32 v73, v73, v0
    v_mul_f32 v74, v74, v0
    v_mul_f32 v75, v75, v0
    v_mul_f32 v80, v80, v0
    v_mul_f32 v81, v81, v0
    v_mul_f32 v82, v82, v0
    v_mul_f32 v83, v83, v0
    v_mul_f32 v88, v88, v0
    v_mul_f32 v89, v89, v0
    v_mul_f32 v90, v90, v0
    v_mul_f32 v91, v91, v0
    v_mul_f32 v96, v96, v0
    v_mul_f32 v97, v97, v0
    v_mul_f32 v98, v98, v0
    v_mul_f32 v99, v99, v0
    v_mov_b32 v168, 0
    v_sub_f32 v4, v136, v1
    v_sub_f32 v6, v137, v1
    v_exp_f32 v4, v4
    v_exp_f32 v6, v6
    v_add_f32 v168, v168, v4
    v_add_f32 v168, v168, v6
    v_cvt_pk_bf16_f32 v184, v4, v6
    v_sub_f32 v4, v138, v1
    v_sub_f32 v6, v139, v1
    v_exp_f32 v4, v4
    v_exp_f32 v6, v6
    v_add_f32 v168, v168, v4
    v_add_f32 v168, v168, v6
    v_cvt_pk_bf16_f32 v185, v4, v6
    v_sub_f32 v4, v144, v1
    v_sub_f32 v6, v145, v1
    v_exp_f32 v4, v4
    v_exp_f32 v6, v6
    v_add_f32 v168, v168, v4
    v_add_f32 v168, v168, v6
    v_cvt_pk_bf16_f32 v186, v4, v6
    v_sub_f32 v4, v146, v1
    v_sub_f32 v6, v147, v1
    v_exp_f32 v4, v4
    v_exp_f32 v6, v6
    v_add_f32 v168, v168, v4
    v_add_f32 v168, v168, v6
    v_cvt_pk_bf16_f32 v187, v4, v6
    v_sub_f32 v4, v152, v1
    v_sub_f32 v6, v153, v1
    v_exp_f32 v4, v4
    v_exp_f32 v6, v6
    v_add_f32 v168, v168, v4
    v_add_f32 v168, v168, v6
    v_cvt_pk_bf16_f32 v192, v4, v6
    v_sub_f32 v4, v154, v1
    v_sub_f32 v6, v155, v1
    v_exp_f32 v4, v4
    v_exp_f32 v6, v6
    v_add_f32 v168, v168, v4
    v_add_f32 v168, v168, v6
    v_cvt_pk_bf16_f32 v193, v4, v6
    v_sub_f32 v4, v160, v1
    v_sub_f32 v6, v161, v1
    v_exp_f32 v4, v4
    v_exp_f32 v6, v6
    v_add_f32 v168, v168, v4
    v_add_f32 v168, v168, v6
    v_cvt_pk_bf16_f32 v194, v4, v6
    v_sub_f32 v4, v162, v1
    v_sub_f32 v6, v163, v1
    v_exp_f32 v4, v4
    v_exp_f32 v6, v6
    v_add_f32 v168, v168, v4
    v_add_f32 v168, v168, v6
    v_cvt_pk_bf16_f32 v195, v4, v6
    ds_swizzle_b32 v0, v168 offset:0x401F
    s_waitcnt lgkmcnt(0)
    v_add_f32 v168, v168, v0
    v_mov_b32 v0, v168
    s_nop 1
    v_permlane32_swap_b32 v0, v168
    v_add_f32 v168, v168, v0
    v_max3_f32 v1, v140, v141, v142
    v_max3_f32 v1, v1, v143, v148
    v_max3_f32 v1, v1, v149, v150
    v_max3_f32 v1, v1, v151, v156
    v_max3_f32 v1, v1, v157, v158
    v_max3_f32 v1, v1, v159, v164
    v_max3_f32 v1, v1, v165, v166
    v_max_f32 v1, v1, v167
    ds_swizzle_b32 v0, v1 offset:0x401F
    s_waitcnt lgkmcnt(0)
    v_max_f32 v1, v1, v0
    v_mov_b32 v0, v1
    s_nop 1
    v_permlane32_swap_b32 v0, v1
    v_max_f32 v1, v1, v0
    v_max_f32 v1, s61, v1
    v_add_f32 v1, 0x42000000, v1
    v_sub_f32 v240, v240, v1
    v_sub_f32 v241, v241, v1
    v_sub_f32 v242, v242, v1
    v_sub_f32 v243, v243, v1
    v_sub_f32 v108, v108, v1
    v_sub_f32 v109, v109, v1
    v_sub_f32 v110, v110, v1
    v_sub_f32 v111, v111, v1
    v_sub_f32 v116, v116, v1
    v_sub_f32 v117, v117, v1
    v_sub_f32 v118, v118, v1
    v_sub_f32 v119, v119, v1
    v_sub_f32 v124, v124, v1
    v_sub_f32 v125, v125, v1
    v_sub_f32 v126, v126, v1
    v_sub_f32 v127, v127, v1
    v_sub_f32 v132, v132, v1
    v_sub_f32 v133, v133, v1
    v_sub_f32 v134, v134, v1
    v_sub_f32 v135, v135, v1
    v_max_f32 v0, 0, v1
    v_exp_f32 v0, -v0
    s_nop 0
    v_mul_f32 v5, v5, v0
    v_mul_f32 v44, v44, v0
    v_mul_f32 v45, v45, v0
    v_mul_f32 v46, v46, v0
    v_mul_f32 v47, v47, v0
    v_mul_f32 v52, v52, v0
    v_mul_f32 v53, v53, v0
    v_mul_f32 v54, v54, v0
    v_mul_f32 v55, v55, v0
    v_mul_f32 v60, v60, v0
    v_mul_f32 v61, v61, v0
    v_mul_f32 v62, v62, v0
    v_mul_f32 v63, v63, v0
    v_mul_f32 v68, v68, v0
    v_mul_f32 v69, v69, v0
    v_mul_f32 v70, v70, v0
    v_mul_f32 v71, v71, v0
    v_mul_f32 v76, v76, v0
    v_mul_f32 v77, v77, v0
    v_mul_f32 v78, v78, v0
    v_mul_f32 v79, v79, v0
    v_mul_f32 v84, v84, v0
    v_mul_f32 v85, v85, v0
    v_mul_f32 v86, v86, v0
    v_mul_f32 v87, v87, v0
    v_mul_f32 v92, v92, v0
    v_mul_f32 v93, v93, v0
    v_mul_f32 v94, v94, v0
    v_mul_f32 v95, v95, v0
    v_mul_f32 v100, v100, v0
    v_mul_f32 v101, v101, v0
    v_mul_f32 v102, v102, v0
    v_mul_f32 v103, v103, v0
    v_mov_b32 v172, 0
    v_sub_f32 v4, v140, v1
    v_sub_f32 v6, v141, v1
    v_exp_f32 v4, v4
    v_exp_f32 v6, v6
    v_add_f32 v172, v172, v4
    v_add_f32 v172, v172, v6
    v_cvt_pk_bf16_f32 v188, v4, v6
    v_sub_f32 v4, v142, v1
    v_sub_f32 v6, v143, v1
    v_exp_f32 v4, v4
    v_exp_f32 v6, v6
    v_add_f32 v172, v172, v4
    v_add_f32 v172, v172, v6
    v_cvt_pk_bf16_f32 v189, v4, v6
    v_sub_f32 v4, v148, v1
    v_sub_f32 v6, v149, v1
    v_exp_f32 v4, v4
    v_exp_f32 v6, v6
    v_add_f32 v172, v172, v4
    v_add_f32 v172, v172, v6
    v_cvt_pk_bf16_f32 v190, v4, v6
    v_sub_f32 v4, v150, v1
    v_sub_f32 v6, v151, v1
    v_exp_f32 v4, v4
    v_exp_f32 v6, v6
    v_add_f32 v172, v172, v4
    v_add_f32 v172, v172, v6
    v_cvt_pk_bf16_f32 v191, v4, v6
    v_sub_f32 v4, v156, v1
    v_sub_f32 v6, v157, v1
    v_exp_f32 v4, v4
    v_exp_f32 v6, v6
    v_add_f32 v172, v172, v4
    v_add_f32 v172, v172, v6
    v_cvt_pk_bf16_f32 v196, v4, v6
    v_sub_f32 v4, v158, v1
    v_sub_f32 v6, v159, v1
    v_exp_f32 v4, v4
    v_exp_f32 v6, v6
    v_add_f32 v172, v172, v4
    v_add_f32 v172, v172, v6
    v_cvt_pk_bf16_f32 v197, v4, v6
    v_sub_f32 v4, v164, v1
    v_sub_f32 v6, v165, v1
    v_exp_f32 v4, v4
    v_exp_f32 v6, v6
    v_add_f32 v172, v172, v4
    v_add_f32 v172, v172, v6
    v_cvt_pk_bf16_f32 v198, v4, v6
    v_sub_f32 v4, v166, v1
    v_sub_f32 v6, v167, v1
    v_exp_f32 v4, v4
    v_exp_f32 v6, v6
    v_add_f32 v172, v172, v4
    v_add_f32 v172, v172, v6
    v_cvt_pk_bf16_f32 v199, v4, v6
    ds_swizzle_b32 v0, v172 offset:0x401F
    s_waitcnt lgkmcnt(0)
    v_add_f32 v172, v172, v0
    v_mov_b32 v0, v172
    s_nop 1
    v_permlane32_swap_b32 v0, v172
    v_add_f32 v172, v172, v0
    s_mov_b32 s61, 0xc2000000
    s_mov_b32 s63, 0x67800000
    s_nop 3
    s_branch attn_kernel_ret19
.globl g2_kernel
.type g2_kernel,@function
.p2align 8
g2_kernel:
    s_cmp_ge_u32 s2, 256
    s_cbranch_scc1 g2_kernel_done1
    s_load_dwordx2 s[4:5], s[0:1], 112
    s_and_b32 s40, s2, 7
    s_lshr_b32 s41, s2, 3
    s_and_b32 s44, s40, 3
    s_lshr_b32 s42, s40, 2
    s_lshl_b32 s42, s42, 3
    s_and_b32 s43, s41, 7
    s_add_u32 s42, s42, s43
    s_lshr_b32 s43, s41, 3
    v_lshrrev_b32 v1, 6, v0
    v_and_b32 v2, 63, v0
    v_readfirstlane_b32 s45, v1
    v_lshlrev_b32 v8, 4, v2
    s_lshr_b32 s60, s45, 2
    s_and_b32 s61, s45, 3
    s_lshl_b32 s46, s61, 5
    s_mov_b32 s47, 0
    s_lshl_b32 s48, s42, 7
    s_add_u32 s48, s48, s46
    s_mul_i32 s49, s43, 144
    s_lshr_b32 s50, s48, 4
    s_mul_i32 s50, s50, 131072
    v_add_u32 v9, s50, v8
    v_add_u32 v10, 131072, v9
    s_mul_i32 s51, s44, 32768
    s_lshl_b32 s53, s60, 10
    s_add_u32 s51, s51, s53
    s_mul_i32 s52, s44, 32
    s_add_u32 s52, s52, s60
    s_mul_i32 s52, s52, 36864
    s_mul_i32 s53, s43, 9216
    s_add_u32 s52, s52, s53
    s_mul_i32 s53, s61, 2304
    s_add_u32 s52, s52, s53
    s_mul_i32 s55, s60, 9216
    s_add_u32 s55, s55, s53
    s_mul_i32 s53, s60, 9216
    s_mul_i32 s54, s47, 9216
    s_add_u32 s53, s53, s54
    v_add_u32 v11, s53, v8
    v_add_u32 v12, 65536, v11
    s_mov_b32 s62, -1
    s_mov_b32 s63, 0xffff
    s_waitcnt lgkmcnt(0)
    s_add_u32 s12, s4, 0x250000
    s_addc_u32 s13, s5, 0
    s_mov_b32 s14, 0x1000000
    s_mov_b32 s15, 0x00020000
    s_add_u32 s16, s4, 0x7b50000
    s_addc_u32 s17, s5, 0
    s_mov_b32 s18, 0x480000
    s_mov_b32 s19, 0x00020000
    buffer_load_dwordx4 v[40:43], v9, s[12:15], s51 offen
    buffer_load_dwordx4 v[44:47], v10, s[12:15], s51 offen
    s_add_u32 s51, s51, 2048
    s_add_u32 m0, s55, 0
    s_mov_b64 exec, s[62:63]
    buffer_load_dwordx4 v8, s[16:19], s52 offen offset:0 lds
    s_mov_b64 exec, -1
    s_mov_b64 exec, s[62:63]
    buffer_load_dwordx4 v8, s[16:19], s52 offen offset:768 lds
    s_mov_b64 exec, -1
    s_mov_b64 exec, s[62:63]
    buffer_load_dwordx4 v8, s[16:19], s52 offen offset:1536 lds
    s_mov_b64 exec, -1
    s_add_u32 s52, s52, 73728
    buffer_load_dwordx4 v[48:51], v9, s[12:15], s51 offen
    buffer_load_dwordx4 v[52:55], v10, s[12:15], s51 offen
    s_add_u32 s51, s51, 2048
    s_add_u32 m0, s55, 18432
    s_mov_b64 exec, s[62:63]
    buffer_load_dwordx4 v8, s[16:19], s52 offen offset:0 lds
    s_mov_b64 exec, -1
    s_mov_b64 exec, s[62:63]
    buffer_load_dwordx4 v8, s[16:19], s52 offen offset:768 lds
    s_mov_b64 exec, -1
    s_mov_b64 exec, s[62:63]
    buffer_load_dwordx4 v8, s[16:19], s52 offen offset:1536 lds
    s_mov_b64 exec, -1
    s_add_u32 s52, s52, 73728
    buffer_load_dwordx4 v[56:59], v9, s[12:15], s51 offen
    buffer_load_dwordx4 v[60:63], v10, s[12:15], s51 offen
    s_add_u32 s51, s51, 2048
    s_add_u32 m0, s55, 36864
    s_mov_b64 exec, s[62:63]
    buffer_load_dwordx4 v8, s[16:19], s52 offen offset:0 lds
    s_mov_b64 exec, -1
    s_mov_b64 exec, s[62:63]
    buffer_load_dwordx4 v8, s[16:19], s52 offen offset:768 lds
    s_mov_b64 exec, -1
    s_mov_b64 exec, s[62:63]
    buffer_load_dwordx4 v8, s[16:19], s52 offen offset:1536 lds
    s_mov_b64 exec, -1
    s_add_u32 s52, s52, 73728
    v_accvgpr_write_b32 a0, 0
    v_accvgpr_write_b32 a1, 0
    v_accvgpr_write_b32 a2, 0
    v_accvgpr_write_b32 a3, 0
    v_accvgpr_write_b32 a4, 0
    v_accvgpr_write_b32 a5, 0
    v_accvgpr_write_b32 a6, 0
    v_accvgpr_write_b32 a7, 0
    v_accvgpr_write_b32 a8, 0
    v_accvgpr_write_b32 a9, 0
    v_accvgpr_write_b32 a10, 0
    v_accvgpr_write_b32 a11, 0
    v_accvgpr_write_b32 a12, 0
    v_accvgpr_write_b32 a13, 0
    v_accvgpr_write_b32 a14, 0
    v_accvgpr_write_b32 a15, 0
    v_accvgpr_write_b32 a16, 0
    v_accvgpr_write_b32 a17, 0
    v_accvgpr_write_b32 a18, 0
    v_accvgpr_write_b32 a19, 0
    v_accvgpr_write_b32 a20, 0
    v_accvgpr_write_b32 a21, 0
    v_accvgpr_write_b32 a22, 0
    v_accvgpr_write_b32 a23, 0
    v_accvgpr_write_b32 a24, 0
    v_accvgpr_write_b32 a25, 0
    v_accvgpr_write_b32 a26, 0
    v_accvgpr_write_b32 a27, 0
    v_accvgpr_write_b32 a28, 0
    v_accvgpr_write_b32 a29, 0
    v_accvgpr_write_b32 a30, 0
    v_accvgpr_write_b32 a31, 0
    v_accvgpr_write_b32 a32, 0
    v_accvgpr_write_b32 a33, 0
    v_accvgpr_write_b32 a34, 0
    v_accvgpr_write_b32 a35, 0
    v_accvgpr_write_b32 a36, 0
    v_accvgpr_write_b32 a37, 0
    v_accvgpr_write_b32 a38, 0
    v_accvgpr_write_b32 a39, 0
    v_accvgpr_write_b32 a40, 0
    v_accvgpr_write_b32 a41, 0
    v_accvgpr_write_b32 a42, 0
    v_accvgpr_write_b32 a43, 0
    v_accvgpr_write_b32 a44, 0
    v_accvgpr_write_b32 a45, 0
    v_accvgpr_write_b32 a46, 0
    v_accvgpr_write_b32 a47, 0
    v_accvgpr_write_b32 a48, 0
    v_accvgpr_write_b32 a49, 0
    v_accvgpr_write_b32 a50, 0
    v_accvgpr_write_b32 a51, 0
    v_accvgpr_write_b32 a52, 0
    v_accvgpr_write_b32 a53, 0
    v_accvgpr_write_b32 a54, 0
    v_accvgpr_write_b32 a55, 0
    v_accvgpr_write_b32 a56, 0
    v_accvgpr_write_b32 a57, 0
    v_accvgpr_write_b32 a58, 0
    v_accvgpr_write_b32 a59, 0
    v_accvgpr_write_b32 a60, 0
    v_accvgpr_write_b32 a61, 0
    v_accvgpr_write_b32 a62, 0
    v_accvgpr_write_b32 a63, 0
    v_accvgpr_write_b32 a64, 0
    v_accvgpr_write_b32 a65, 0
    v_accvgpr_write_b32 a66, 0
    v_accvgpr_write_b32 a67, 0
    v_accvgpr_write_b32 a68, 0
    v_accvgpr_write_b32 a69, 0
    v_accvgpr_write_b32 a70, 0
    v_accvgpr_write_b32 a71, 0
    s_waitcnt vmcnt(10)
    s_barrier
    ds_read_b128 v[16:19], v11 offset:0
    ds_read_b128 v[20:23], v11 offset:1024
    ds_read_b128 v[24:27], v11 offset:2048
    ds_read_b128 v[28:31], v11 offset:3072
    ds_read_b128 v[32:35], v11 offset:4096
    s_mov_b32 s56, 3
g2_kernel_loop2:
    ds_read_b128 v[36:39], v11 offset:5120
    s_waitcnt lgkmcnt(5)
    v_mfma_f32_16x16x32_bf16 a[0:3], v[16:19], v[40:43], a[0:3]
    v_mfma_f32_16x16x32_bf16 a[36:39], v[16:19], v[44:47], a[36:39]
    ds_read_b128 v[16:19], v11 offset:6144
    s_waitcnt lgkmcnt(5)
    v_mfma_f32_16x16x32_bf16 a[4:7], v[20:23], v[40:43], a[4:7]
    v_mfma_f32_16x16x32_bf16 a[40:43], v[20:23], v[44:47], a[40:43]
    ds_read_b128 v[20:23], v11 offset:7168
    s_waitcnt lgkmcnt(5)
    v_mfma_f32_16x16x32_bf16 a[8:11], v[24:27], v[40:43], a[8:11]
    v_mfma_f32_16x16x32_bf16 a[44:47], v[24:27], v[44:47], a[44:47]
    s_waitcnt vmcnt(5)
    s_barrier
    ds_read_b128 v[24:27], v11 offset:8192
    s_waitcnt lgkmcnt(5)
    v_mfma_f32_16x16x32_bf16 a[12:15], v[28:31], v[40:43], a[12:15]
    v_mfma_f32_16x16x32_bf16 a[48:51], v[28:31], v[44:47], a[48:51]
    buffer_load_dwordx4 v[64:67], v9, s[12:15], s51 offen
    ds_read_b128 v[28:31], v11 offset:18432
    s_waitcnt lgkmcnt(5)
    v_mfma_f32_16x16x32_bf16 a[16:19], v[32:35], v[40:43], a[16:19]
    v_mfma_f32_16x16x32_bf16 a[52:55], v[32:35], v[44:47], a[52:55]
    buffer_load_dwordx4 v[68:71], v10, s[12:15], s51 offen
    s_add_u32 s51, s51, 2048
    ds_read_b128 v[32:35], v11 offset:19456
    s_waitcnt lgkmcnt(5)
    v_mfma_f32_16x16x32_bf16 a[20:23], v[36:39], v[40:43], a[20:23]
    v_mfma_f32_16x16x32_bf16 a[56:59], v[36:39], v[44:47], a[56:59]
    s_add_u32 m0, s55, 55296
    s_mov_b64 exec, s[62:63]
    buffer_load_dwordx4 v8, s[16:19], s52 offen offset:0 lds
    s_mov_b64 exec, -1
    ds_read_b128 v[36:39], v11 offset:20480
    s_waitcnt lgkmcnt(5)
    v_mfma_f32_16x16x32_bf16 a[24:27], v[16:19], v[40:43], a[24:27]
    v_mfma_f32_16x16x32_bf16 a[60:63], v[16:19], v[44:47], a[60:63]
    s_mov_b64 exec, s[62:63]
    buffer_load_dwordx4 v8, s[16:19], s52 offen offset:768 lds
    s_mov_b64 exec, -1
    ds_read_b128 v[16:19], v11 offset:21504
    s_waitcnt lgkmcnt(5)
    v_mfma_f32_16x16x32_bf16 a[28:31], v[20:23], v[40:43], a[28:31]
    v_mfma_f32_16x16x32_bf16 a[64:67], v[20:23], v[44:47], a[64:67]
    s_mov_b64 exec, s[62:63]
    buffer_load_dwordx4 v8, s[16:19], s52 offen offset:1536 lds
    s_mov_b64 exec, -1
    s_add_u32 s52, s52, 73728
    ds_read_b128 v[20:23], v11 offset:22528
    s_waitcnt lgkmcnt(5)
    v_mfma_f32_16x16x32_bf16 a[32:35], v[24:27], v[40:43], a[32:35]
    v_mfma_f32_16x16x32_bf16 a[68:71], v[24:27], v[44:47], a[68:71]
    ds_read_b128 v[24:27], v11 offset:23552
    s_waitcnt lgkmcnt(5)
    v_mfma_f32_16x16x32_bf16 a[0:3], v[28:31], v[48:51], a[0:3]
    v_mfma_f32_16x16x32_bf16 a[36:39], v[28:31], v[52:55], a[36:39]
    ds_read_b128 v[28:31], v11 offset:24576
    s_waitcnt lgkmcnt(5)
    v_mfma_f32_16x16x32_bf16 a[4:7], v[32:35], v[48:51], a[4:7]
    v_mfma_f32_16x16x32_bf16 a[40:43], v[32:35], v[52:55], a[40:43]
    ds_read_b128 v[32:35], v11 offset:25600
    s_waitcnt lgkmcnt(5)
    v_mfma_f32_16x16x32_bf16 a[8:11], v[36:39], v[48:51], a[8:11]
    v_mfma_f32_16x16x32_bf16 a[44:47], v[36:39], v[52:55], a[44:47]
    s_waitcnt vmcnt(5)
    s_barrier
    ds_read_b128 v[36:39], v11 offset:26624
    s_waitcnt lgkmcnt(5)
    v_mfma_f32_16x16x32_bf16 a[12:15], v[16:19], v[48:51], a[12:15]
    v_mfma_f32_16x16x32_bf16 a[48:51], v[16:19], v[52:55], a[48:51]
    buffer_load_dwordx4 v[40:43], v9, s[12:15], s51 offen
    ds_read_b128 v[16:19], v11 offset:36864
    s_waitcnt lgkmcnt(5)
    v_mfma_f32_16x16x32_bf16 a[16:19], v[20:23], v[48:51], a[16:19]
    v_mfma_f32_16x16x32_bf16 a[52:55], v[20:23], v[52:55], a[52:55]
    buffer_load_dwordx4 v[44:47], v10, s[12:15], s51 offen
    s_add_u32 s51, s51, 2048
    ds_read_b128 v[20:23], v11 offset:37888
    s_waitcnt lgkmcnt(5)
    v_mfma_f32_16x16x32_bf16 a[20:23], v[24:27], v[48:51], a[20:23]
    v_mfma_f32_16x16x32_bf16 a[56:59], v[24:27], v[52:55], a[56:59]
    s_add_u32 m0, s55, 0
    s_mov_b64 exec, s[62:63]
    buffer_load_dwordx4 v8, s[16:19], s52 offen offset:0 lds
    s_mov_b64 exec, -1
    ds_read_b128 v[24:27], v11 offset:38912
    s_waitcnt lgkmcnt(5)
    v_mfma_f32_16x16x32_bf16 a[24:27], v[28:31], v[48:51], a[24:27]
    v_mfma_f32_16x16x32_bf16 a[60:63], v[28:31], v[52:55], a[60:63]
    s_mov_b64 exec, s[62:63]
    buffer_load_dwordx4 v8, s[16:19], s52 offen offset:768 lds
    s_mov_b64 exec, -1
    ds_read_b128 v[28:31], v11 offset:39936
    s_waitcnt lgkmcnt(5)
    v_mfma_f32_16x16x32_bf16 a[28:31], v[32:35], v[48:51], a[28:31]
    v_mfma_f32_16x16x32_bf16 a[64:67], v[32:35], v[52:55], a[64:67]
    s_mov_b64 exec, s[62:63]
    buffer_load_dwordx4 v8, s[16:19], s52 offen offset:1536 lds
    s_mov_b64 exec, -1
    s_add_u32 s52, s52, 73728
    ds_read_b128 v[32:35], v11 offset:40960
    s_waitcnt lgkmcnt(5)
    v_mfma_f32_16x16x32_bf16 a[32:35], v[36:39], v[48:51], a[32:35]
    v_mfma_f32_16x16x32_bf16 a[68:71], v[36:39], v[52:55], a[68:71]
    ds_read_b128 v[36:39], v11 offset:41984
    s_waitcnt lgkmcnt(5)
    v_mfma_f32_16x16x32_bf16 a[0:3], v[16:19], v[56:59], a[0:3]
    v_mfma_f32_16x16x32_bf16 a[36:39], v[16:19], v[60:63], a[36:39]
    ds_read_b128 v[16:19], v11 offset:43008
    s_waitcnt lgkmcnt(5)
    v_mfma_f32_16x16x32_bf16 a[4:7], v[20:23], v[56:59], a[4:7]
    v_mfma_f32_16x16x32_bf16 a[40:43], v[20:23], v[60:63], a[40:43]
    ds_read_b128 v[20:23], v11 offset:44032
    s_waitcnt lgkmcnt(5)
    v_mfma_f32_16x16x32_bf16 a[8:11], v[24:27], v[56:59], a[8:11]
    v_mfma_f32_16x16x32_bf16 a[44:47], v[24:27], v[60:63], a[44:47]
    s_waitcnt vmcnt(5)
    s_barrier
    ds_read_b128 v[24:27], v11 offset:45056
    s_waitcnt lgkmcnt(5)
    v_mfma_f32_16x16x32_bf16 a[12:15], v[28:31], v[56:59], a[12:15]
    v_mfma_f32_16x16x32_bf16 a[48:51], v[28:31], v[60:63], a[48:51]
    buffer_load_dwordx4 v[48:51], v9, s[12:15], s51 offen
    ds_read_b128 v[28:31], v11 offset:55296
    s_waitcnt lgkmcnt(5)
    v_mfma_f32_16x16x32_bf16 a[16:19], v[32:35], v[56:59], a[16:19]
    v_mfma_f32_16x16x32_bf16 a[52:55], v[32:35], v[60:63], a[52:55]
    buffer_load_dwordx4 v[52:55], v10, s[12:15], s51 offen
    s_add_u32 s51, s51, 2048
    ds_read_b128 v[32:35], v11 offset:56320
    s_waitcnt lgkmcnt(5)
    v_mfma_f32_16x16x32_bf16 a[20:23], v[36:39], v[56:59], a[20:23]
    v_mfma_f32_16x16x32_bf16 a[56:59], v[36:39], v[60:63], a[56:59]
    s_add_u32 m0, s55, 18432
    s_mov_b64 exec, s[62:63]
    buffer_load_dwordx4 v8, s[16:19], s52 offen offset:0 lds
    s_mov_b64 exec, -1
    ds_read_b128 v[36:39], v11 offset:57344
    s_waitcnt lgkmcnt(5)
    v_mfma_f32_16x16x32_bf16 a[24:27], v[16:19], v[56:59], a[24:27]
    v_mfma_f32_16x16x32_bf16 a[60:63], v[16:19], v[60:63], a[60:63]
    s_mov_b64 exec, s[62:63]
    buffer_load_dwordx4 v8, s[16:19], s52 offen offset:768 lds
    s_mov_b64 exec, -1
    ds_read_b128 v[16:19], v11 offset:58368
    s_waitcnt lgkmcnt(5)
    v_mfma_f32_16x16x32_bf16 a[28:31], v[20:23], v[56:59], a[28:31]
    v_mfma_f32_16x16x32_bf16 a[64:67], v[20:23], v[60:63], a[64:67]
    s_mov_b64 exec, s[62:63]
    buffer_load_dwordx4 v8, s[16:19], s52 offen offset:1536 lds
    s_mov_b64 exec, -1
    s_add_u32 s52, s52, 73728
    ds_read_b128 v[20:23], v11 offset:59392
    s_waitcnt lgkmcnt(5)
    v_mfma_f32_16x16x32_bf16 a[32:35], v[24:27], v[56:59], a[32:35]
    v_mfma_f32_16x16x32_bf16 a[68:71], v[24:27], v[60:63], a[68:71]
    ds_read_b128 v[24:27], v11 offset:60416
    s_waitcnt lgkmcnt(5)
    v_mfma_f32_16x16x32_bf16 a[0:3], v[28:31], v[64:67], a[0:3]
    v_mfma_f32_16x16x32_bf16 a[36:39], v[28:31], v[68:71], a[36:39]
    ds_read_b128 v[28:31], v11 offset:61440
    s_waitcnt lgkmcnt(5)
    v_mfma_f32_16x16x32_bf16 a[4:7], v[32:35], v[64:67], a[4:7]
    v_mfma_f32_16x16x32_bf16 a[40:43], v[32:35], v[68:71], a[40:43]
    ds_read_b128 v[32:35], v11 offset:62464
    s_waitcnt lgkmcnt(5)
    v_mfma_f32_16x16x32_bf16 a[8:11], v[36:39], v[64:67], a[8:11]
    v_mfma_f32_16x16x32_bf16 a[44:47], v[36:39], v[68:71], a[44:47]
    s_waitcnt vmcnt(5)
    s_barrier
    ds_read_b128 v[36:39], v11 offset:63488
    s_waitcnt lgkmcnt(5)
    v_mfma_f32_16x16x32_bf16 a[12:15], v[16:19], v[64:67], a[12:15]
    v_mfma_f32_16x16x32_bf16 a[48:51], v[16:19], v[68:71], a[48:51]
    buffer_load_dwordx4 v[56:59], v9, s[12:15], s51 offen
    ds_read_b128 v[16:19], v11 offset:0
    s_waitcnt lgkmcnt(5)
    v_mfma_f32_16x16x32_bf16 a[16:19], v[20:23], v[64:67], a[16:19]
    v_mfma_f32_16x16x32_bf16 a[52:55], v[20:23], v[68:71], a[52:55]
    buffer_load_dwordx4 v[60:63], v10, s[12:15], s51 offen
    s_add_u32 s51, s51, 2048
    ds_read_b128 v[20:23], v11 offset:1024
    s_waitcnt lgkmcnt(5)
    v_mfma_f32_16x16x32_bf16 a[20:23], v[24:27], v[64:67], a[20:23]
    v_mfma_f32_16x16x32_bf16 a[56:59], v[24:27], v[68:71], a[56:59]
    s_add_u32 m0, s55, 36864
    s_mov_b64 exec, s[62:63]
    buffer_load_dwordx4 v8, s[16:19], s52 offen offset:0 lds
    s_mov_b64 exec, -1
    ds_read_b128 v[24:27], v11 offset:2048
    s_waitcnt lgkmcnt(5)
    v_mfma_f32_16x16x32_bf16 a[24:27], v[28:31], v[64:67], a[24:27]
    v_mfma_f32_16x16x32_bf16 a[60:63], v[28:31], v[68:71], a[60:63]
    s_mov_b64 exec, s[62:63]
    buffer_load_dwordx4 v8, s[16:19], s52 offen offset:768 lds
    s_mov_b64 exec, -1
    ds_read_b128 v[28:31], v11 offset:3072
    s_waitcnt lgkmcnt(5)
    v_mfma_f32_16x16x32_bf16 a[28:31], v[32:35], v[64:67], a[28:31]
    v_mfma_f32_16x16x32_bf16 a[64:67], v[32:35], v[68:71], a[64:67]
    s_mov_b64 exec, s[62:63]
    buffer_load_dwordx4 v8, s[16:19], s52 offen offset:1536 lds
    s_mov_b64 exec, -1
    s_add_u32 s52, s52, 73728
    ds_read_b128 v[32:35], v11 offset:4096
    s_waitcnt lgkmcnt(5)
    v_mfma_f32_16x16x32_bf16 a[32:35], v[36:39], v[64:67], a[32:35]
    v_mfma_f32_16x16x32_bf16 a[68:71], v[36:39], v[68:71], a[68:71]
    s_sub_u32 s56, s56, 1
    s_cmp_lg_u32 s56, 0
    s_cbranch_scc1 g2_kernel_loop2
    s_mul_i32 s64, s60, 16
    s_add_u32 s48, s48, s64
    v_and_b32 v3, 15, v2
    v_lshrrev_b32 v5, 4, v2
    v_add_u32 v3, s48, v3
    s_mul_i32 s53, s47, 144
    s_add_u32 s53, s53, s49
    v_lshl_add_u32 v5, v5, 2, s53
    ds_read_b128 v[36:39], v11 offset:5120
    s_waitcnt lgkmcnt(5)
    v_mfma_f32_16x16x32_bf16 a[0:3], v[16:19], v[40:43], a[0:3]
    v_mfma_f32_16x16x32_bf16 a[36:39], v[16:19], v[44:47], a[36:39]
    ds_read_b128 v[16:19], v11 offset:6144
    s_waitcnt lgkmcnt(5)
    v_mfma_f32_16x16x32_bf16 a[4:7], v[20:23], v[40:43], a[4:7]
    v_mfma_f32_16x16x32_bf16 a[40:43], v[20:23], v[44:47], a[40:43]
    ds_read_b128 v[20:23], v11 offset:7168
    s_waitcnt lgkmcnt(5)
    v_mfma_f32_16x16x32_bf16 a[8:11], v[24:27], v[40:43], a[8:11]
    v_mfma_f32_16x16x32_bf16 a[44:47], v[24:27], v[44:47], a[44:47]
    s_waitcnt vmcnt(5)
    s_barrier
    ds_read_b128 v[24:27], v11 offset:8192
    s_waitcnt lgkmcnt(5)
    v_mfma_f32_16x16x32_bf16 a[12:15], v[28:31], v[40:43], a[12:15]
    v_mfma_f32_16x16x32_bf16 a[48:51], v[28:31], v[44:47], a[48:51]
    buffer_load_dwordx4 v[64:67], v9, s[12:15], s51 offen
    ds_read_b128 v[28:31], v11 offset:18432
    s_waitcnt lgkmcnt(5)
    v_mfma_f32_16x16x32_bf16 a[16:19], v[32:35], v[40:43], a[16:19]
    v_mfma_f32_16x16x32_bf16 a[52:55], v[32:35], v[44:47], a[52:55]
    buffer_load_dwordx4 v[68:71], v10, s[12:15], s51 offen
    s_add_u32 s51, s51, 2048
    ds_read_b128 v[32:35], v11 offset:19456
    s_waitcnt lgkmcnt(5)
    v_mfma_f32_16x16x32_bf16 a[20:23], v[36:39], v[40:43], a[20:23]
    v_mfma_f32_16x16x32_bf16 a[56:59], v[36:39], v[44:47], a[56:59]
    s_add_u32 m0, s55, 55296
    s_mov_b64 exec, s[62:63]
    buffer_load_dwordx4 v8, s[16:19], s52 offen offset:0 lds
    s_mov_b64 exec, -1
    ds_read_b128 v[36:39], v11 offset:20480
    s_waitcnt lgkmcnt(5)
    v_mfma_f32_16x16x32_bf16 a[24:27], v[16:19], v[40:43], a[24:27]
    v_mfma_f32_16x16x32_bf16 a[60:63], v[16:19], v[44:47], a[60:63]
    s_mov_b64 exec, s[62:63]
    buffer_load_dwordx4 v8, s[16:19], s52 offen offset:768 lds
    s_mov_b64 exec, -1
    ds_read_b128 v[16:19], v11 offset:21504
    s_waitcnt lgkmcnt(5)
    v_mfma_f32_16x16x32_bf16 a[28:31], v[20:23], v[40:43], a[28:31]
    v_mfma_f32_16x16x32_bf16 a[64:67], v[20:23], v[44:47], a[64:67]
    s_mov_b64 exec, s[62:63]
    buffer_load_dwordx4 v8, s[16:19], s52 offen offset:1536 lds
    s_mov_b64 exec, -1
    s_add_u32 s52, s52, 73728
    ds_read_b128 v[20:23], v11 offset:22528
    s_waitcnt lgkmcnt(5)
    v_mfma_f32_16x16x32_bf16 a[32:35], v[24:27], v[40:43], a[32:35]
    v_mfma_f32_16x16x32_bf16 a[68:71], v[24:27], v[44:47], a[68:71]
    ds_read_b128 v[24:27], v11 offset:23552
    s_waitcnt lgkmcnt(5)
    v_mfma_f32_16x16x32_bf16 a[0:3], v[28:31], v[48:51], a[0:3]
    v_mfma_f32_16x16x32_bf16 a[36:39], v[28:31], v[52:55], a[36:39]
    ds_read_b128 v[28:31], v11 offset:24576
    s_waitcnt lgkmcnt(5)
    v_mfma_f32_16x16x32_bf16 a[4:7], v[32:35], v[48:51], a[4:7]
    v_mfma_f32_16x16x32_bf16 a[40:43], v[32:35], v[52:55], a[40:43]
    ds_read_b128 v[32:35], v11 offset:25600
    s_waitcnt lgkmcnt(5)
    v_mfma_f32_16x16x32_bf16 a[8:11], v[36:39], v[48:51], a[8:11]
    v_mfma_f32_16x16x32_bf16 a[44:47], v[36:39], v[52:55], a[44:47]
    s_waitcnt vmcnt(5)
    s_barrier
    ds_read_b128 v[36:39], v11 offset:26624
    s_waitcnt lgkmcnt(5)
    v_mfma_f32_16x16x32_bf16 a[12:15], v[16:19], v[48:51], a[12:15]
    v_mfma_f32_16x16x32_bf16 a[48:51], v[16:19], v[52:55], a[48:51]
    ds_read_b128 v[16:19], v11 offset:36864
    s_waitcnt lgkmcnt(5)
    v_mfma_f32_16x16x32_bf16 a[16:19], v[20:23], v[48:51], a[16:19]
    v_mfma_f32_16x16x32_bf16 a[52:55], v[20:23], v[52:55], a[52:55]
    ds_read_b128 v[20:23], v11 offset:37888
    s_waitcnt lgkmcnt(5)
    v_mfma_f32_16x16x32_bf16 a[20:23], v[24:27], v[48:51], a[20:23]
    v_mfma_f32_16x16x32_bf16 a[56:59], v[24:27], v[52:55], a[56:59]
    ds_read_b128 v[24:27], v11 offset:38912
    s_waitcnt lgkmcnt(5)
    v_mfma_f32_16x16x32_bf16 a[24:27], v[28:31], v[48:51], a[24:27]
    v_mfma_f32_16x16x32_bf16 a[60:63], v[28:31], v[52:55], a[60:63]
    ds_read_b128 v[28:31], v11 offset:39936
    s_waitcnt lgkmcnt(5)
    v_mfma_f32_16x16x32_bf16 a[28:31], v[32:35], v[48:51], a[28:31]
    v_mfma_f32_16x16x32_bf16 a[64:67], v[32:35], v[52:55], a[64:67]
    ds_read_b128 v[32:35], v11 offset:40960
    s_waitcnt lgkmcnt(5)
    v_mfma_f32_16x16x32_bf16 a[32:35], v[36:39], v[48:51], a[32:35]
    v_mfma_f32_16x16x32_bf16 a[68:71], v[36:39], v[52:55], a[68:71]
    ds_read_b128 v[36:39], v11 offset:41984
    s_waitcnt lgkmcnt(5)
    v_mfma_f32_16x16x32_bf16 a[0:3], v[16:19], v[56:59], a[0:3]
    v_mfma_f32_16x16x32_bf16 a[36:39], v[16:19], v[60:63], a[36:39]
    ds_read_b128 v[16:19], v11 offset:43008
    s_waitcnt lgkmcnt(5)
    v_mfma_f32_16x16x32_bf16 a[4:7], v[20:23], v[56:59], a[4:7]
    v_mfma_f32_16x16x32_bf16 a[40:43], v[20:23], v[60:63], a[40:43]
    ds_read_b128 v[20:23], v11 offset:44032
    s_waitcnt lgkmcnt(5)
    v_mfma_f32_16x16x32_bf16 a[8:11], v[24:27], v[56:59], a[8:11]
    v_mfma_f32_16x16x32_bf16 a[44:47], v[24:27], v[60:63], a[44:47]
    s_waitcnt vmcnt(0)
    s_barrier
    ds_read_b128 v[24:27], v11 offset:45056
    s_waitcnt lgkmcnt(5)
    v_mfma_f32_16x16x32_bf16 a[12:15], v[28:31], v[56:59], a[12:15]
    v_mfma_f32_16x16x32_bf16 a[48:51], v[28:31], v[60:63], a[48:51]
    ds_read_b128 v[28:31], v11 offset:55296
    s_waitcnt lgkmcnt(5)
    v_mfma_f32_16x16x32_bf16 a[16:19], v[32:35], v[56:59], a[16:19]
    v_mfma_f32_16x16x32_bf16 a[52:55], v[32:35], v[60:63], a[52:55]
    ds_read_b128 v[32:35], v11 offset:56320
    s_waitcnt lgkmcnt(5)
    v_mfma_f32_16x16x32_bf16 a[20:23], v[36:39], v[56:59], a[20:23]
    v_mfma_f32_16x16x32_bf16 a[56:59], v[36:39], v[60:63], a[56:59]
    ds_read_b128 v[36:39], v11 offset:57344
    s_waitcnt lgkmcnt(5)
    v_mfma_f32_16x16x32_bf16 a[24:27], v[16:19], v[56:59], a[24:27]
    v_mfma_f32_16x16x32_bf16 a[60:63], v[16:19], v[60:63], a[60:63]
    ds_read_b128 v[16:19], v11 offset:58368
    s_waitcnt lgkmcnt(5)
    v_mfma_f32_16x16x32_bf16 a[28:31], v[20:23], v[56:59], a[28:31]
    v_mfma_f32_16x16x32_bf16 a[64:67], v[20:23], v[60:63], a[64:67]
    ds_read_b128 v[20:23], v11 offset:59392
    s_waitcnt lgkmcnt(5)
    v_mfma_f32_16x16x32_bf16 a[32:35], v[24:27], v[56:59], a[32:35]
    v_mfma_f32_16x16x32_bf16 a[68:71], v[24:27], v[60:63], a[68:71]
    ds_read_b128 v[24:27], v11 offset:60416
    s_waitcnt lgkmcnt(5)
    v_mfma_f32_16x16x32_bf16 a[0:3], v[28:31], v[64:67], a[0:3]
    v_mfma_f32_16x16x32_bf16 a[36:39], v[28:31], v[68:71], a[36:39]
    ds_read_b128 v[28:31], v11 offset:61440
    s_waitcnt lgkmcnt(5)
    v_mfma_f32_16x16x32_bf16 a[4:7], v[32:35], v[64:67], a[4:7]
    v_mfma_f32_16x16x32_bf16 a[40:43], v[32:35], v[68:71], a[40:43]
    ds_read_b128 v[32:35], v11 offset:62464
    s_waitcnt lgkmcnt(5)
    v_mfma_f32_16x16x32_bf16 a[8:11], v[36:39], v[64:67], a[8:11]
    v_mfma_f32_16x16x32_bf16 a[44:47], v[36:39], v[68:71], a[44:47]
    ds_read_b128 v[36:39], v11 offset:63488
    s_waitcnt lgkmcnt(5)
    v_mfma_f32_16x16x32_bf16 a[12:15], v[16:19], v[64:67], a[12:15]
    v_mfma_f32_16x16x32_bf16 a[48:51], v[16:19], v[68:71], a[48:51]
    s_waitcnt lgkmcnt(4)
    v_mfma_f32_16x16x32_bf16 a[16:19], v[20:23], v[64:67], a[16:19]
    v_mfma_f32_16x16x32_bf16 a[52:55], v[20:23], v[68:71], a[52:55]
    s_waitcnt lgkmcnt(3)
    v_mfma_f32_16x16x32_bf16 a[20:23], v[24:27], v[64:67], a[20:23]
    v_mfma_f32_16x16x32_bf16 a[56:59], v[24:27], v[68:71], a[56:59]
    s_waitcnt lgkmcnt(2)
    v_mfma_f32_16x16x32_bf16 a[24:27], v[28:31], v[64:67], a[24:27]
    v_mfma_f32_16x16x32_bf16 a[60:63], v[28:31], v[68:71], a[60:63]
    s_waitcnt lgkmcnt(1)
    v_mfma_f32_16x16x32_bf16 a[28:31], v[32:35], v[64:67], a[28:31]
    v_mfma_f32_16x16x32_bf16 a[64:67], v[32:35], v[68:71], a[64:67]
    s_waitcnt lgkmcnt(0)
    v_mfma_f32_16x16x32_bf16 a[32:35], v[36:39], v[64:67], a[32:35]
    v_mfma_f32_16x16x32_bf16 a[68:71], v[36:39], v[68:71], a[68:71]
    s_barrier
    s_mul_i32 s64, s45, 9216
    v_add_u32 v1, s64, v8
    s_xor_b32 s64, s45, 4
    s_mul_i32 s64, s64, 9216
    v_add_u32 v4, s64, v8
    s_cmp_eq_u32 s60, 1
    s_cbranch_scc1 g2_kernel_hi3
    s_nop 7
    v_accvgpr_read_b32 v16, a36
    v_accvgpr_read_b32 v17, a37
    v_accvgpr_read_b32 v18, a38
    v_accvgpr_read_b32 v19, a39
    ds_write_b128 v1, v[16:19] offset:0
    v_accvgpr_read_b32 v20, a40
    v_accvgpr_read_b32 v21, a41
    v_accvgpr_read_b32 v22, a42
    v_accvgpr_read_b32 v23, a43
    ds_write_b128 v1, v[20:23] offset:1024
    v_accvgpr_read_b32 v24, a44
    v_accvgpr_read_b32 v25, a45
    v_accvgpr_read_b32 v26, a46
    v_accvgpr_read_b32 v27, a47
    ds_write_b128 v1, v[24:27] offset:2048
    v_accvgpr_read_b32 v28, a48
    v_accvgpr_read_b32 v29, a49
    v_accvgpr_read_b32 v30, a50
    v_accvgpr_read_b32 v31, a51
    ds_write_b128 v1, v[28:31] offset:3072
    v_accvgpr_read_b32 v32, a52
    v_accvgpr_read_b32 v33, a53
    v_accvgpr_read_b32 v34, a54
    v_accvgpr_read_b32 v35, a55
    ds_write_b128 v1, v[32:35] offset:4096
    v_accvgpr_read_b32 v36, a56
    v_accvgpr_read_b32 v37, a57
    v_accvgpr_read_b32 v38, a58
    v_accvgpr_read_b32 v39, a59
    ds_write_b128 v1, v[36:39] offset:5120
    v_accvgpr_read_b32 v40, a60
    v_accvgpr_read_b32 v41, a61
    v_accvgpr_read_b32 v42, a62
    v_accvgpr_read_b32 v43, a63
    ds_write_b128 v1, v[40:43] offset:6144
    v_accvgpr_read_b32 v44, a64
    v_accvgpr_read_b32 v45, a65
    v_accvgpr_read_b32 v46, a66
    v_accvgpr_read_b32 v47, a67
    ds_write_b128 v1, v[44:47] offset:7168
    v_accvgpr_read_b32 v48, a68
    v_accvgpr_read_b32 v49, a69
    v_accvgpr_read_b32 v50, a70
    v_accvgpr_read_b32 v51, a71
    ds_write_b128 v1, v[48:51] offset:8192
    s_waitcnt lgkmcnt(0)
    s_barrier
    s_add_u32 s20, s4, 0x1250000
    s_addc_u32 s21, s5, 0
    s_mov_b32 s22, 0x1200000
    s_mov_b32 s23, 0x00020000
    s_mul_i32 s57, s44, 2621440
    s_lshr_b32 s64, s48, 4
    s_lshl_b32 s64, s64, 2
    s_add_u32 s64, s64, s43
    s_mul_i32 s64, s64, 5120
    s_add_u32 s57, s57, s64
    ds_read_b128 v[16:19], v4 offset:0
    ds_read_b128 v[20:23], v4 offset:1024
    ds_read_b128 v[24:27], v4 offset:2048
    ds_read_b128 v[28:31], v4 offset:3072
    ds_read_b128 v[32:35], v4 offset:4096
    ds_read_b128 v[36:39], v4 offset:5120
    ds_read_b128 v[40:43], v4 offset:6144
    ds_read_b128 v[44:47], v4 offset:7168
    ds_read_b128 v[48:51], v4 offset:8192
    v_accvgpr_read_b32 v52, a0
    v_accvgpr_read_b32 v53, a1
    v_accvgpr_read_b32 v54, a2
    v_accvgpr_read_b32 v55, a3
    s_waitcnt lgkmcnt(8)
    v_add_f32 v16, v16, v52
    v_add_f32 v17, v17, v53
    v_add_f32 v18, v18, v54
    v_add_f32 v19, v19, v55
    v_cvt_pk_bf16_f32 v16, v16, v17
    v_cvt_pk_bf16_f32 v17, v18, v19
    v_accvgpr_read_b32 v60, a4
    v_accvgpr_read_b32 v61, a5
    v_accvgpr_read_b32 v62, a6
    v_accvgpr_read_b32 v63, a7
    s_waitcnt lgkmcnt(7)
    v_add_f32 v20, v20, v60
    v_add_f32 v21, v21, v61
    v_add_f32 v22, v22, v62
    v_add_f32 v23, v23, v63
    v_cvt_pk_bf16_f32 v18, v20, v21
    v_cvt_pk_bf16_f32 v19, v22, v23
    buffer_store_dwordx4 v[16:19], v8, s[20:23], s57 offen offset:0 sc0 sc1
    v_accvgpr_read_b32 v52, a8
    v_accvgpr_read_b32 v53, a9
    v_accvgpr_read_b32 v54, a10
    v_accvgpr_read_b32 v55, a11
    s_waitcnt lgkmcnt(6)
    v_add_f32 v24, v24, v52
    v_add_f32 v25, v25, v53
    v_add_f32 v26, v26, v54
    v_add_f32 v27, v27, v55
    v_cvt_pk_bf16_f32 v24, v24, v25
    v_cvt_pk_bf16_f32 v25, v26, v27
    v_accvgpr_read_b32 v60, a12
    v_accvgpr_read_b32 v61, a13
    v_accvgpr_read_b32 v62, a14
    v_accvgpr_read_b32 v63, a15
    s_waitcnt lgkmcnt(5)
    v_add_f32 v28, v28, v60
    v_add_f32 v29, v29, v61
    v_add_f32 v30, v30, v62
    v_add_f32 v31, v31, v63
    v_cvt_pk_bf16_f32 v26, v28, v29
    v_cvt_pk_bf16_f32 v27, v30, v31
    buffer_store_dwordx4 v[24:27], v8, s[20:23], s57 offen offset:1024 sc0 sc1
    v_accvgpr_read_b32 v52, a16
    v_accvgpr_read_b32 v53, a17
    v_accvgpr_read_b32 v54, a18
    v_accvgpr_read_b32 v55, a19
    s_waitcnt lgkmcnt(4)
    v_add_f32 v32, v32, v52
    v_add_f32 v33, v33, v53
    v_add_f32 v34, v34, v54
    v_add_f32 v35, v35, v55
    v_cvt_pk_bf16_f32 v32, v32, v33
    v_cvt_pk_bf16_f32 v33, v34, v35
    v_accvgpr_read_b32 v60, a20
    v_accvgpr_read_b32 v61, a21
    v_accvgpr_read_b32 v62, a22
    v_accvgpr_read_b32 v63, a23
    s_waitcnt lgkmcnt(3)
    v_add_f32 v36, v36, v60
    v_add_f32 v37, v37, v61
    v_add_f32 v38, v38, v62
    v_add_f32 v39, v39, v63
    v_cvt_pk_bf16_f32 v34, v36, v37
    v_cvt_pk_bf16_f32 v35, v38, v39
    buffer_store_dwordx4 v[32:35], v8, s[20:23], s57 offen offset:2048 sc0 sc1
    v_accvgpr_read_b32 v52, a24
    v_accvgpr_read_b32 v53, a25
    v_accvgpr_read_b32 v54, a26
    v_accvgpr_read_b32 v55, a27
    s_waitcnt lgkmcnt(2)
    v_add_f32 v40, v40, v52
    v_add_f32 v41, v41, v53
    v_add_f32 v42, v42, v54
    v_add_f32 v43, v43, v55
    v_cvt_pk_bf16_f32 v40, v40, v41
    v_cvt_pk_bf16_f32 v41, v42, v43
    v_accvgpr_read_b32 v60, a28
    v_accvgpr_read_b32 v61, a29
    v_accvgpr_read_b32 v62, a30
    v_accvgpr_read_b32 v63, a31
    s_waitcnt lgkmcnt(1)
    v_add_f32 v44, v44, v60
    v_add_f32 v45, v45, v61
    v_add_f32 v46, v46, v62
    v_add_f32 v47, v47, v63
    v_cvt_pk_bf16_f32 v42, v44, v45
    v_cvt_pk_bf16_f32 v43, v46, v47
    buffer_store_dwordx4 v[40:43], v8, s[20:23], s57 offen offset:3072 sc0 sc1
    v_accvgpr_read_b32 v52, a32
    v_accvgpr_read_b32 v53, a33
    v_accvgpr_read_b32 v54, a34
    v_accvgpr_read_b32 v55, a35
    s_waitcnt lgkmcnt(0)
    v_add_f32 v48, v48, v52
    v_add_f32 v49, v49, v53
    v_add_f32 v50, v50, v54
    v_add_f32 v51, v51, v55
    v_cvt_pk_bf16_f32 v48, v48, v49
    v_cvt_pk_bf16_f32 v49, v50, v51
    s_add_u32 s57, s57, 4096
    v_lshlrev_b32 v6, 3, v2
    buffer_store_dwordx2 v[48:49], v6, s[20:23], s57 offen sc0 sc1
    s_branch g2_kernel_end4
g2_kernel_hi3:
    s_nop 7
    v_accvgpr_read_b32 v16, a0
    v_accvgpr_read_b32 v17, a1
    v_accvgpr_read_b32 v18, a2
    v_accvgpr_read_b32 v19, a3
    ds_write_b128 v1, v[16:19] offset:0
    v_accvgpr_read_b32 v20, a4
    v_accvgpr_read_b32 v21, a5
    v_accvgpr_read_b32 v22, a6
    v_accvgpr_read_b32 v23, a7
    ds_write_b128 v1, v[20:23] offset:1024
    v_accvgpr_read_b32 v24, a8
    v_accvgpr_read_b32 v25, a9
    v_accvgpr_read_b32 v26, a10
    v_accvgpr_read_b32 v27, a11
    ds_write_b128 v1, v[24:27] offset:2048
    v_accvgpr_read_b32 v28, a12
    v_accvgpr_read_b32 v29, a13
    v_accvgpr_read_b32 v30, a14
    v_accvgpr_read_b32 v31, a15
    ds_write_b128 v1, v[28:31] offset:3072
    v_accvgpr_read_b32 v32, a16
    v_accvgpr_read_b32 v33, a17
    v_accvgpr_read_b32 v34, a18
    v_accvgpr_read_b32 v35, a19
    ds_write_b128 v1, v[32:35] offset:4096
    v_accvgpr_read_b32 v36, a20
    v_accvgpr_read_b32 v37, a21
    v_accvgpr_read_b32 v38, a22
    v_accvgpr_read_b32 v39, a23
    ds_write_b128 v1, v[36:39] offset:5120
    v_accvgpr_read_b32 v40, a24
    v_accvgpr_read_b32 v41, a25
    v_accvgpr_read_b32 v42, a26
    v_accvgpr_read_b32 v43, a27
    ds_write_b128 v1, v[40:43] offset:6144
    v_accvgpr_read_b32 v44, a28
    v_accvgpr_read_b32 v45, a29
    v_accvgpr_read_b32 v46, a30
    v_accvgpr_read_b32 v47, a31
    ds_write_b128 v1, v[44:47] offset:7168
    v_accvgpr_read_b32 v48, a32
    v_accvgpr_read_b32 v49, a33
    v_accvgpr_read_b32 v50, a34
    v_accvgpr_read_b32 v51, a35
    ds_write_b128 v1, v[48:51] offset:8192
    s_waitcnt lgkmcnt(0)
    s_barrier
    s_add_u32 s20, s4, 0x1250000
    s_addc_u32 s21, s5, 0
    s_mov_b32 s22, 0x1200000
    s_mov_b32 s23, 0x00020000
    s_mul_i32 s57, s44, 2621440
    s_lshr_b32 s64, s48, 4
    s_lshl_b32 s64, s64, 2
    s_add_u32 s64, s64, s43
    s_mul_i32 s64, s64, 5120
    s_add_u32 s57, s57, s64
    ds_read_b128 v[16:19], v4 offset:0
    ds_read_b128 v[20:23], v4 offset:1024
    ds_read_b128 v[24:27], v4 offset:2048
    ds_read_b128 v[28:31], v4 offset:3072
    ds_read_b128 v[32:35], v4 offset:4096
    ds_read_b128 v[36:39], v4 offset:5120
    ds_read_b128 v[40:43], v4 offset:6144
    ds_read_b128 v[44:47], v4 offset:7168
    ds_read_b128 v[48:51], v4 offset:8192
    v_accvgpr_read_b32 v52, a36
    v_accvgpr_read_b32 v53, a37
    v_accvgpr_read_b32 v54, a38
    v_accvgpr_read_b32 v55, a39
    s_waitcnt lgkmcnt(8)
    v_add_f32 v16, v16, v52
    v_add_f32 v17, v17, v53
    v_add_f32 v18, v18, v54
    v_add_f32 v19, v19, v55
    v_cvt_pk_bf16_f32 v16, v16, v17
    v_cvt_pk_bf16_f32 v17, v18, v19
    v_accvgpr_read_b32 v60, a40
    v_accvgpr_read_b32 v61, a41
    v_accvgpr_read_b32 v62, a42
    v_accvgpr_read_b32 v63, a43
    s_waitcnt lgkmcnt(7)
    v_add_f32 v20, v20, v60
    v_add_f32 v21, v21, v61
    v_add_f32 v22, v22, v62
    v_add_f32 v23, v23, v63
    v_cvt_pk_bf16_f32 v18, v20, v21
    v_cvt_pk_bf16_f32 v19, v22, v23
    buffer_store_dwordx4 v[16:19], v8, s[20:23], s57 offen offset:0 sc0 sc1
    v_accvgpr_read_b32 v52, a44
    v_accvgpr_read_b32 v53, a45
    v_accvgpr_read_b32 v54, a46
    v_accvgpr_read_b32 v55, a47
    s_waitcnt lgkmcnt(6)
    v_add_f32 v24, v24, v52
    v_add_f32 v25, v25, v53
    v_add_f32 v26, v26, v54
    v_add_f32 v27, v27, v55
    v_cvt_pk_bf16_f32 v24, v24, v25
    v_cvt_pk_bf16_f32 v25, v26, v27
    v_accvgpr_read_b32 v60, a48
    v_accvgpr_read_b32 v61, a49
    v_accvgpr_read_b32 v62, a50
    v_accvgpr_read_b32 v63, a51
    s_waitcnt lgkmcnt(5)
    v_add_f32 v28, v28, v60
    v_add_f32 v29, v29, v61
    v_add_f32 v30, v30, v62
    v_add_f32 v31, v31, v63
    v_cvt_pk_bf16_f32 v26, v28, v29
    v_cvt_pk_bf16_f32 v27, v30, v31
    buffer_store_dwordx4 v[24:27], v8, s[20:23], s57 offen offset:1024 sc0 sc1
    v_accvgpr_read_b32 v52, a52
    v_accvgpr_read_b32 v53, a53
    v_accvgpr_read_b32 v54, a54
    v_accvgpr_read_b32 v55, a55
    s_waitcnt lgkmcnt(4)
    v_add_f32 v32, v32, v52
    v_add_f32 v33, v33, v53
    v_add_f32 v34, v34, v54
    v_add_f32 v35, v35, v55
    v_cvt_pk_bf16_f32 v32, v32, v33
    v_cvt_pk_bf16_f32 v33, v34, v35
    v_accvgpr_read_b32 v60, a56
    v_accvgpr_read_b32 v61, a57
    v_accvgpr_read_b32 v62, a58
    v_accvgpr_read_b32 v63, a59
    s_waitcnt lgkmcnt(3)
    v_add_f32 v36, v36, v60
    v_add_f32 v37, v37, v61
    v_add_f32 v38, v38, v62
    v_add_f32 v39, v39, v63
    v_cvt_pk_bf16_f32 v34, v36, v37
    v_cvt_pk_bf16_f32 v35, v38, v39
    buffer_store_dwordx4 v[32:35], v8, s[20:23], s57 offen offset:2048 sc0 sc1
    v_accvgpr_read_b32 v52, a60
    v_accvgpr_read_b32 v53, a61
    v_accvgpr_read_b32 v54, a62
    v_accvgpr_read_b32 v55, a63
    s_waitcnt lgkmcnt(2)
    v_add_f32 v40, v40, v52
    v_add_f32 v41, v41, v53
    v_add_f32 v42, v42, v54
    v_add_f32 v43, v43, v55
    v_cvt_pk_bf16_f32 v40, v40, v41
    v_cvt_pk_bf16_f32 v41, v42, v43
    v_accvgpr_read_b32 v60, a64
    v_accvgpr_read_b32 v61, a65
    v_accvgpr_read_b32 v62, a66
    v_accvgpr_read_b32 v63, a67
    s_waitcnt lgkmcnt(1)
    v_add_f32 v44, v44, v60
    v_add_f32 v45, v45, v61
    v_add_f32 v46, v46, v62
    v_add_f32 v47, v47, v63
    v_cvt_pk_bf16_f32 v42, v44, v45
    v_cvt_pk_bf16_f32 v43, v46, v47
    buffer_store_dwordx4 v[40:43], v8, s[20:23], s57 offen offset:3072 sc0 sc1
    v_accvgpr_read_b32 v52, a68
    v_accvgpr_read_b32 v53, a69
    v_accvgpr_read_b32 v54, a70
    v_accvgpr_read_b32 v55, a71
    s_waitcnt lgkmcnt(0)
    v_add_f32 v48, v48, v52
    v_add_f32 v49, v49, v53
    v_add_f32 v50, v50, v54
    v_add_f32 v51, v51, v55
    v_cvt_pk_bf16_f32 v48, v48, v49
    v_cvt_pk_bf16_f32 v49, v50, v51
    s_add_u32 s57, s57, 4096
    v_lshlrev_b32 v6, 3, v2
    buffer_store_dwordx2 v[48:49], v6, s[20:23], s57 offen sc0 sc1
g2_kernel_end4:
g2_kernel_done1:
    s_endpgm
.globl ln2_kernel
.type ln2_kernel,@function
.p2align 8
ln2_kernel:
    s_cmp_ge_u32 s2, 128
    s_cbranch_scc1 ln2_kernel_done1
    s_load_dwordx2 s[4:5], s[0:1], 0
    s_load_dwordx2 s[6:7], s[0:1], 112
    v_lshrrev_b32 v1, 6, v0
    v_and_b32 v2, 63, v0
    v_readfirstlane_b32 s3, v1
    v_and_b32 v4, 15, v2
    v_lshrrev_b32 v5, 4, v2
    v_lshlrev_b32 v3, 4, v2
    v_lshlrev_b32 v15, 3, v2
    s_lshl_b32 s32, s2, 2
    s_add_u32 s32, s32, s3
    s_mul_i32 s33, s32, 5120
    s_lshl_b32 s34, s2, 4
    v_add_u32 v6, s34, v4
    v_mul_u32_u24 v6, 1152, v6
    v_lshl_add_u32 v6, v5, 3, v6
    s_mul_i32 s34, s3, 288
    v_lshlrev_b32 v7, 4, v5
    s_mul_i32 s35, s3, 576
    s_waitcnt lgkmcnt(0)
    s_mov_b32 s12, s4
    s_mov_b32 s13, s5
    s_mov_b32 s14, 0x240000
    s_mov_b32 s15, 0x00020000
    s_add_u32 s16, s6, 0x0
    s_addc_u32 s17, s7, 0
    s_mov_b32 s18, 0x8000
    s_mov_b32 s19, 0x00020000
    s_add_u32 s20, s6, 0x2690000
    s_addc_u32 s21, s7, 0
    s_mov_b32 s22, 0x240000
    s_mov_b32 s23, 0x00020000
    s_add_u32 s24, s6, 0x1250000
    s_addc_u32 s25, s7, 0
    s_mov_b32 s26, 0x1200000
    s_mov_b32 s27, 0x00020000
    s_add_u32 s28, s6, 0x2450000
    s_addc_u32 s29, s7, 0
    s_mov_b32 s30, 0x240000
    s_mov_b32 s31, 0x00020000
    s_add_u32 s36, s33, 0
    s_add_u32 s37, s36, 4096
    buffer_load_dwordx4 v[52:55], v3, s[24:27], s36 offen offset:0
    buffer_load_dwordx4 v[56:59], v3, s[24:27], s36 offen offset:1024
    buffer_load_dwordx4 v[60:63], v3, s[24:27], s36 offen offset:2048
    buffer_load_dwordx4 v[64:67], v3, s[24:27], s36 offen offset:3072
    buffer_load_dwordx2 v[68:69], v15, s[24:27], s37 offen
    s_add_u32 s36, s33, 2621440
    s_add_u32 s37, s36, 4096
    buffer_load_dwordx4 v[70:73], v3, s[24:27], s36 offen offset:0
    buffer_load_dwordx4 v[74:77], v3, s[24:27], s36 offen offset:1024
    buffer_load_dwordx4 v[78:81], v3, s[24:27], s36 offen offset:2048
    buffer_load_dwordx4 v[82:85], v3, s[24:27], s36 offen offset:3072
    buffer_load_dwordx2 v[86:87], v15, s[24:27], s37 offen
    s_add_u32 s36, s33, 5242880
    s_add_u32 s37, s36, 4096
    buffer_load_dwordx4 v[88:91], v3, s[24:27], s36 offen offset:0
    buffer_load_dwordx4 v[92:95], v3, s[24:27], s36 offen offset:1024
    buffer_load_dwordx4 v[96:99], v3, s[24:27], s36 offen offset:2048
    buffer_load_dwordx4 v[100:103], v3, s[24:27], s36 offen offset:3072
    buffer_load_dwordx2 v[104:105], v15, s[24:27], s37 offen
    s_add_u32 s36, s33, 7864320
    s_add_u32 s37, s36, 4096
    buffer_load_dwordx4 v[106:109], v3, s[24:27], s36 offen offset:0
    buffer_load_dwordx4 v[110:113], v3, s[24:27], s36 offen offset:1024
    buffer_load_dwordx4 v[114:117], v3, s[24:27], s36 offen offset:2048
    buffer_load_dwordx4 v[118:121], v3, s[24:27], s36 offen offset:3072
    buffer_load_dwordx2 v[122:123], v15, s[24:27], s37 offen
    buffer_load_dwordx2 v[124:125], v6, s[12:15], s34 offen offset:0
    buffer_load_dwordx2 v[126:127], v6, s[12:15], s34 offen offset:32
    buffer_load_dwordx2 v[128:129], v6, s[12:15], s34 offen offset:64
    buffer_load_dwordx2 v[130:131], v6, s[12:15], s34 offen offset:96
    buffer_load_dwordx2 v[132:133], v6, s[12:15], s34 offen offset:128
    buffer_load_dwordx2 v[134:135], v6, s[12:15], s34 offen offset:160
    buffer_load_dwordx2 v[136:137], v6, s[12:15], s34 offen offset:192
    buffer_load_dwordx2 v[138:139], v6, s[12:15], s34 offen offset:224
    buffer_load_dwordx2 v[140:141], v6, s[12:15], s34 offen offset:256
    s_add_u32 s36, s35, 4608
    buffer_load_dwordx4 v[142:145], v7, s[16:19], s36 offen offset:0
    buffer_load_dwordx4 v[146:149], v7, s[16:19], s36 offen offset:64
    buffer_load_dwordx4 v[150:153], v7, s[16:19], s36 offen offset:128
    buffer_load_dwordx4 v[154:157], v7, s[16:19], s36 offen offset:192
    buffer_load_dwordx4 v[158:161], v7, s[16:19], s36 offen offset:256
    buffer_load_dwordx4 v[162:165], v7, s[16:19], s36 offen offset:320
    buffer_load_dwordx4 v[166:169], v7, s[16:19], s36 offen offset:384
    buffer_load_dwordx4 v[170:173], v7, s[16:19], s36 offen offset:448
    buffer_load_dwordx4 v[174:177], v7, s[16:19], s36 offen offset:512
    s_add_u32 s36, s35, 9216
    buffer_load_dwordx4 v[178:181], v7, s[16:19], s36 offen offset:0
    buffer_load_dwordx4 v[182:185], v7, s[16:19], s36 offen offset:64
    buffer_load_dwordx4 v[186:189], v7, s[16:19], s36 offen offset:128
    buffer_load_dwordx4 v[190:193], v7, s[16:19], s36 offen offset:192
    buffer_load_dwordx4 v[194:197], v7, s[16:19], s36 offen offset:256
    buffer_load_dwordx4 v[198:201], v7, s[16:19], s36 offen offset:320
    buffer_load_dwordx4 v[202:205], v7, s[16:19], s36 offen offset:384
    buffer_load_dwordx4 v[206:209], v7, s[16:19], s36 offen offset:448
    buffer_load_dwordx4 v[210:213], v7, s[16:19], s36 offen offset:512
    s_add_u32 s36, s35, 6912
    buffer_load_dwordx4 v[214:217], v7, s[16:19], s36 offen offset:0
    buffer_load_dwordx4 v[218:221], v7, s[16:19], s36 offen offset:64
    buffer_load_dwordx4 v[222:225], v7, s[16:19], s36 offen offset:128
    buffer_load_dwordx4 v[226:229], v7, s[16:19], s36 offen offset:192
    buffer_load_dwordx4 v[230:233], v7, s[16:19], s36 offen offset:256
    buffer_load_dwordx4 v[234:237], v7, s[16:19], s36 offen offset:320
    buffer_load_dwordx4 v[238:241], v7, s[16:19], s36 offen offset:384
    buffer_load_dwordx4 v[242:245], v7, s[16:19], s36 offen offset:448
    buffer_load_dwordx4 v[246:249], v7, s[16:19], s36 offen offset:512
    s_waitcnt vmcnt(51)
    v_lshlrev_b32 v16, 16, v52
    v_and_b32 v17, 0xffff0000, v52
    v_lshlrev_b32 v18, 16, v53
    v_and_b32 v19, 0xffff0000, v53
    v_lshlrev_b32 v20, 16, v54
    v_and_b32 v21, 0xffff0000, v54
    v_lshlrev_b32 v22, 16, v55
    v_and_b32 v23, 0xffff0000, v55
    v_lshlrev_b32 v24, 16, v56
    v_and_b32 v25, 0xffff0000, v56
    v_lshlrev_b32 v26, 16, v57
    v_and_b32 v27, 0xffff0000, v57
    v_lshlrev_b32 v28, 16, v58
    v_and_b32 v29, 0xffff0000, v58
    v_lshlrev_b32 v30, 16, v59
    v_and_b32 v31, 0xffff0000, v59
    v_lshlrev_b32 v32, 16, v60
    v_and_b32 v33, 0xffff0000, v60
    v_lshlrev_b32 v34, 16, v61
    v_and_b32 v35, 0xffff0000, v61
    v_lshlrev_b32 v36, 16, v62
    v_and_b32 v37, 0xffff0000, v62
    v_lshlrev_b32 v38, 16, v63
    v_and_b32 v39, 0xffff0000, v63
    v_lshlrev_b32 v40, 16, v64
    v_and_b32 v41, 0xffff0000, v64
    v_lshlrev_b32 v42, 16, v65
    v_and_b32 v43, 0xffff0000, v65
    v_lshlrev_b32 v44, 16, v66
    v_and_b32 v45, 0xffff0000, v66
    v_lshlrev_b32 v46, 16, v67
    v_and_b32 v47, 0xffff0000, v67
    v_lshlrev_b32 v48, 16, v68
    v_and_b32 v49, 0xffff0000, v68
    v_lshlrev_b32 v50, 16, v69
    v_and_b32 v51, 0xffff0000, v69
    s_waitcnt vmcnt(46)
    v_lshlrev_b32 v8, 16, v70
    v_and_b32 v9, 0xffff0000, v70
    v_add_f32 v16, v16, v8
    v_add_f32 v17, v17, v9
    v_lshlrev_b32 v8, 16, v71
    v_and_b32 v9, 0xffff0000, v71
    v_add_f32 v18, v18, v8
    v_add_f32 v19, v19, v9
    v_lshlrev_b32 v8, 16, v72
    v_and_b32 v9, 0xffff0000, v72
    v_add_f32 v20, v20, v8
    v_add_f32 v21, v21, v9
    v_lshlrev_b32 v8, 16, v73
    v_and_b32 v9, 0xffff0000, v73
    v_add_f32 v22, v22, v8
    v_add_f32 v23, v23, v9
    v_lshlrev_b32 v8, 16, v74
    v_and_b32 v9, 0xffff0000, v74
    v_add_f32 v24, v24, v8
    v_add_f32 v25, v25, v9
    v_lshlrev_b32 v8, 16, v75
    v_and_b32 v9, 0xffff0000, v75
    v_add_f32 v26, v26, v8
    v_add_f32 v27, v27, v9
    v_lshlrev_b32 v8, 16, v76
    v_and_b32 v9, 0xffff0000, v76
    v_add_f32 v28, v28, v8
    v_add_f32 v29, v29, v9
    v_lshlrev_b32 v8, 16, v77
    v_and_b32 v9, 0xffff0000, v77
    v_add_f32 v30, v30, v8
    v_add_f32 v31, v31, v9
    v_lshlrev_b32 v8, 16, v78
    v_and_b32 v9, 0xffff0000, v78
    v_add_f32 v32, v32, v8
    v_add_f32 v33, v33, v9
    v_lshlrev_b32 v8, 16, v79
    v_and_b32 v9, 0xffff0000, v79
    v_add_f32 v34, v34, v8
    v_add_f32 v35, v35, v9
    v_lshlrev_b32 v8, 16, v80
    v_and_b32 v9, 0xffff0000, v80
    v_add_f32 v36, v36, v8
    v_add_f32 v37, v37, v9
    v_lshlrev_b32 v8, 16, v81
    v_and_b32 v9, 0xffff0000, v81
    v_add_f32 v38, v38, v8
    v_add_f32 v39, v39, v9
    v_lshlrev_b32 v8, 16, v82
    v_and_b32 v9, 0xffff0000, v82
    v_add_f32 v40, v40, v8
    v_add_f32 v41, v41, v9
    v_lshlrev_b32 v8, 16, v83
    v_and_b32 v9, 0xffff0000, v83
    v_add_f32 v42, v42, v8
    v_add_f32 v43, v43, v9
    v_lshlrev_b32 v8, 16, v84
    v_and_b32 v9, 0xffff0000, v84
    v_add_f32 v44, v44, v8
    v_add_f32 v45, v45, v9
    v_lshlrev_b32 v8, 16, v85
    v_and_b32 v9, 0xffff0000, v85
    v_add_f32 v46, v46, v8
    v_add_f32 v47, v47, v9
    v_lshlrev_b32 v8, 16, v86
    v_and_b32 v9, 0xffff0000, v86
    v_add_f32 v48, v48, v8
    v_add_f32 v49, v49, v9
    v_lshlrev_b32 v8, 16, v87
    v_and_b32 v9, 0xffff0000, v87
    v_add_f32 v50, v50, v8
    v_add_f32 v51, v51, v9
    s_waitcnt vmcnt(41)
    v_lshlrev_b32 v8, 16, v88
    v_and_b32 v9, 0xffff0000, v88
    v_add_f32 v16, v16, v8
    v_add_f32 v17, v17, v9
    v_lshlrev_b32 v8, 16, v89
    v_and_b32 v9, 0xffff0000, v89
    v_add_f32 v18, v18, v8
    v_add_f32 v19, v19, v9
    v_lshlrev_b32 v8, 16, v90
    v_and_b32 v9, 0xffff0000, v90
    v_add_f32 v20, v20, v8
    v_add_f32 v21, v21, v9
    v_lshlrev_b32 v8, 16, v91
    v_and_b32 v9, 0xffff0000, v91
    v_add_f32 v22, v22, v8
    v_add_f32 v23, v23, v9
    v_lshlrev_b32 v8, 16, v92
    v_and_b32 v9, 0xffff0000, v92
    v_add_f32 v24, v24, v8
    v_add_f32 v25, v25, v9
    v_lshlrev_b32 v8, 16, v93
    v_and_b32 v9, 0xffff0000, v93
    v_add_f32 v26, v26, v8
    v_add_f32 v27, v27, v9
    v_lshlrev_b32 v8, 16, v94
    v_and_b32 v9, 0xffff0000, v94
    v_add_f32 v28, v28, v8
    v_add_f32 v29, v29, v9
    v_lshlrev_b32 v8, 16, v95
    v_and_b32 v9, 0xffff0000, v95
    v_add_f32 v30, v30, v8
    v_add_f32 v31, v31, v9
    v_lshlrev_b32 v8, 16, v96
    v_and_b32 v9, 0xffff0000, v96
    v_add_f32 v32, v32, v8
    v_add_f32 v33, v33, v9
    v_lshlrev_b32 v8, 16, v97
    v_and_b32 v9, 0xffff0000, v97
    v_add_f32 v34, v34, v8
    v_add_f32 v35, v35, v9
    v_lshlrev_b32 v8, 16, v98
    v_and_b32 v9, 0xffff0000, v98
    v_add_f32 v36, v36, v8
    v_add_f32 v37, v37, v9
    v_lshlrev_b32 v8, 16, v99
    v_and_b32 v9, 0xffff0000, v99
    v_add_f32 v38, v38, v8
    v_add_f32 v39, v39, v9
    v_lshlrev_b32 v8, 16, v100
    v_and_b32 v9, 0xffff0000, v100
    v_add_f32 v40, v40, v8
    v_add_f32 v41, v41, v9
    v_lshlrev_b32 v8, 16, v101
    v_and_b32 v9, 0xffff0000, v101
    v_add_f32 v42, v42, v8
    v_add_f32 v43, v43, v9
    v_lshlrev_b32 v8, 16, v102
    v_and_b32 v9, 0xffff0000, v102
    v_add_f32 v44, v44, v8
    v_add_f32 v45, v45, v9
    v_lshlrev_b32 v8, 16, v103
    v_and_b32 v9, 0xffff0000, v103
    v_add_f32 v46, v46, v8
    v_add_f32 v47, v47, v9
    v_lshlrev_b32 v8, 16, v104
    v_and_b32 v9, 0xffff0000, v104
    v_add_f32 v48, v48, v8
    v_add_f32 v49, v49, v9
    v_lshlrev_b32 v8, 16, v105
    v_and_b32 v9, 0xffff0000, v105
    v_add_f32 v50, v50, v8
    v_add_f32 v51, v51, v9
    s_waitcnt vmcnt(36)
    v_lshlrev_b32 v8, 16, v106
    v_and_b32 v9, 0xffff0000, v106
    v_add_f32 v16, v16, v8
    v_add_f32 v17, v17, v9
    v_lshlrev_b32 v8, 16, v107
    v_and_b32 v9, 0xffff0000, v107
    v_add_f32 v18, v18, v8
    v_add_f32 v19, v19, v9
    v_lshlrev_b32 v8, 16, v108
    v_and_b32 v9, 0xffff0000, v108
    v_add_f32 v20, v20, v8
    v_add_f32 v21, v21, v9
    v_lshlrev_b32 v8, 16, v109
    v_and_b32 v9, 0xffff0000, v109
    v_add_f32 v22, v22, v8
    v_add_f32 v23, v23, v9
    v_lshlrev_b32 v8, 16, v110
    v_and_b32 v9, 0xffff0000, v110
    v_add_f32 v24, v24, v8
    v_add_f32 v25, v25, v9
    v_lshlrev_b32 v8, 16, v111
    v_and_b32 v9, 0xffff0000, v111
    v_add_f32 v26, v26, v8
    v_add_f32 v27, v27, v9
    v_lshlrev_b32 v8, 16, v112
    v_and_b32 v9, 0xffff0000, v112
    v_add_f32 v28, v28, v8
    v_add_f32 v29, v29, v9
    v_lshlrev_b32 v8, 16, v113
    v_and_b32 v9, 0xffff0000, v113
    v_add_f32 v30, v30, v8
    v_add_f32 v31, v31, v9
    v_lshlrev_b32 v8, 16, v114
    v_and_b32 v9, 0xffff0000, v114
    v_add_f32 v32, v32, v8
    v_add_f32 v33, v33, v9
    v_lshlrev_b32 v8, 16, v115
    v_and_b32 v9, 0xffff0000, v115
    v_add_f32 v34, v34, v8
    v_add_f32 v35, v35, v9
    v_lshlrev_b32 v8, 16, v116
    v_and_b32 v9, 0xffff0000, v116
    v_add_f32 v36, v36, v8
    v_add_f32 v37, v37, v9
    v_lshlrev_b32 v8, 16, v117
    v_and_b32 v9, 0xffff0000, v117
    v_add_f32 v38, v38, v8
    v_add_f32 v39, v39, v9
    v_lshlrev_b32 v8, 16, v118
    v_and_b32 v9, 0xffff0000, v118
    v_add_f32 v40, v40, v8
    v_add_f32 v41, v41, v9
    v_lshlrev_b32 v8, 16, v119
    v_and_b32 v9, 0xffff0000, v119
    v_add_f32 v42, v42, v8
    v_add_f32 v43, v43, v9
    v_lshlrev_b32 v8, 16, v120
    v_and_b32 v9, 0xffff0000, v120
    v_add_f32 v44, v44, v8
    v_add_f32 v45, v45, v9
    v_lshlrev_b32 v8, 16, v121
    v_and_b32 v9, 0xffff0000, v121
    v_add_f32 v46, v46, v8
    v_add_f32 v47, v47, v9
    v_lshlrev_b32 v8, 16, v122
    v_and_b32 v9, 0xffff0000, v122
    v_add_f32 v48, v48, v8
    v_add_f32 v49, v49, v9
    v_lshlrev_b32 v8, 16, v123
    v_and_b32 v9, 0xffff0000, v123
    v_add_f32 v50, v50, v8
    v_add_f32 v51, v51, v9
    s_waitcnt vmcnt(0)
    s_mul_i32 s36, s32, 4608
    v_lshlrev_b32 v8, 16, v124
    v_and_b32 v9, 0xffff0000, v124
    v_fma_f32 v16, v16, v142, v8
    v_fma_f32 v17, v17, v143, v9
    v_cvt_pk_bf16_f32 v124, v16, v17
    v_lshlrev_b32 v16, 16, v124
    v_and_b32 v17, 0xffff0000, v124
    v_lshlrev_b32 v8, 16, v125
    v_and_b32 v9, 0xffff0000, v125
    v_fma_f32 v18, v18, v144, v8
    v_fma_f32 v19, v19, v145, v9
    v_cvt_pk_bf16_f32 v125, v18, v19
    v_lshlrev_b32 v18, 16, v125
    v_and_b32 v19, 0xffff0000, v125
    buffer_store_dwordx2 v[124:125], v15, s[28:31], s36 offen offset:0
    v_lshlrev_b32 v8, 16, v126
    v_and_b32 v9, 0xffff0000, v126
    v_fma_f32 v20, v20, v146, v8
    v_fma_f32 v21, v21, v147, v9
    v_cvt_pk_bf16_f32 v126, v20, v21
    v_lshlrev_b32 v20, 16, v126
    v_and_b32 v21, 0xffff0000, v126
    v_lshlrev_b32 v8, 16, v127
    v_and_b32 v9, 0xffff0000, v127
    v_fma_f32 v22, v22, v148, v8
    v_fma_f32 v23, v23, v149, v9
    v_cvt_pk_bf16_f32 v127, v22, v23
    v_lshlrev_b32 v22, 16, v127
    v_and_b32 v23, 0xffff0000, v127
    buffer_store_dwordx2 v[126:127], v15, s[28:31], s36 offen offset:512
    v_lshlrev_b32 v8, 16, v128
    v_and_b32 v9, 0xffff0000, v128
    v_fma_f32 v24, v24, v150, v8
    v_fma_f32 v25, v25, v151, v9
    v_cvt_pk_bf16_f32 v128, v24, v25
    v_lshlrev_b32 v24, 16, v128
    v_and_b32 v25, 0xffff0000, v128
    v_lshlrev_b32 v8, 16, v129
    v_and_b32 v9, 0xffff0000, v129
    v_fma_f32 v26, v26, v152, v8
    v_fma_f32 v27, v27, v153, v9
    v_cvt_pk_bf16_f32 v129, v26, v27
    v_lshlrev_b32 v26, 16, v129
    v_and_b32 v27, 0xffff0000, v129
    buffer_store_dwordx2 v[128:129], v15, s[28:31], s36 offen offset:1024
    v_lshlrev_b32 v8, 16, v130
    v_and_b32 v9, 0xffff0000, v130
    v_fma_f32 v28, v28, v154, v8
    v_fma_f32 v29, v29, v155, v9
    v_cvt_pk_bf16_f32 v130, v28, v29
    v_lshlrev_b32 v28, 16, v130
    v_and_b32 v29, 0xffff0000, v130
    v_lshlrev_b32 v8, 16, v131
    v_and_b32 v9, 0xffff0000, v131
    v_fma_f32 v30, v30, v156, v8
    v_fma_f32 v31, v31, v157, v9
    v_cvt_pk_bf16_f32 v131, v30, v31
    v_lshlrev_b32 v30, 16, v131
    v_and_b32 v31, 0xffff0000, v131
    buffer_store_dwordx2 v[130:131], v15, s[28:31], s36 offen offset:1536
    v_lshlrev_b32 v8, 16, v132
    v_and_b32 v9, 0xffff0000, v132
    v_fma_f32 v32, v32, v158, v8
    v_fma_f32 v33, v33, v159, v9
    v_cvt_pk_bf16_f32 v132, v32, v33
    v_lshlrev_b32 v32, 16, v132
    v_and_b32 v33, 0xffff0000, v132
    v_lshlrev_b32 v8, 16, v133
    v_and_b32 v9, 0xffff0000, v133
    v_fma_f32 v34, v34, v160, v8
    v_fma_f32 v35, v35, v161, v9
    v_cvt_pk_bf16_f32 v133, v34, v35
    v_lshlrev_b32 v34, 16, v133
    v_and_b32 v35, 0xffff0000, v133
    buffer_store_dwordx2 v[132:133], v15, s[28:31], s36 offen offset:2048
    v_lshlrev_b32 v8, 16, v134
    v_and_b32 v9, 0xffff0000, v134
    v_fma_f32 v36, v36, v162, v8
    v_fma_f32 v37, v37, v163, v9
    v_cvt_pk_bf16_f32 v134, v36, v37
    v_lshlrev_b32 v36, 16, v134
    v_and_b32 v37, 0xffff0000, v134
    v_lshlrev_b32 v8, 16, v135
    v_and_b32 v9, 0xffff0000, v135
    v_fma_f32 v38, v38, v164, v8
    v_fma_f32 v39, v39, v165, v9
    v_cvt_pk_bf16_f32 v135, v38, v39
    v_lshlrev_b32 v38, 16, v135
    v_and_b32 v39, 0xffff0000, v135
    buffer_store_dwordx2 v[134:135], v15, s[28:31], s36 offen offset:2560
    v_lshlrev_b32 v8, 16, v136
    v_and_b32 v9, 0xffff0000, v136
    v_fma_f32 v40, v40, v166, v8
    v_fma_f32 v41, v41, v167, v9
    v_cvt_pk_bf16_f32 v136, v40, v41
    v_lshlrev_b32 v40, 16, v136
    v_and_b32 v41, 0xffff0000, v136
    v_lshlrev_b32 v8, 16, v137
    v_and_b32 v9, 0xffff0000, v137
    v_fma_f32 v42, v42, v168, v8
    v_fma_f32 v43, v43, v169, v9
    v_cvt_pk_bf16_f32 v137, v42, v43
    v_lshlrev_b32 v42, 16, v137
    v_and_b32 v43, 0xffff0000, v137
    buffer_store_dwordx2 v[136:137], v15, s[28:31], s36 offen offset:3072
    v_lshlrev_b32 v8, 16, v138
    v_and_b32 v9, 0xffff0000, v138
    v_fma_f32 v44, v44, v170, v8
    v_fma_f32 v45, v45, v171, v9
    v_cvt_pk_bf16_f32 v138, v44, v45
    v_lshlrev_b32 v44, 16, v138
    v_and_b32 v45, 0xffff0000, v138
    v_lshlrev_b32 v8, 16, v139
    v_and_b32 v9, 0xffff0000, v139
    v_fma_f32 v46, v46, v172, v8
    v_fma_f32 v47, v47, v173, v9
    v_cvt_pk_bf16_f32 v139, v46, v47
    v_lshlrev_b32 v46, 16, v139
    v_and_b32 v47, 0xffff0000, v139
    buffer_store_dwordx2 v[138:139], v15, s[28:31], s36 offen offset:3584
    v_lshlrev_b32 v8, 16, v140
    v_and_b32 v9, 0xffff0000, v140
    v_fma_f32 v48, v48, v174, v8
    v_fma_f32 v49, v49, v175, v9
    v_cvt_pk_bf16_f32 v140, v48, v49
    v_lshlrev_b32 v48, 16, v140
    v_and_b32 v49, 0xffff0000, v140
    v_lshlrev_b32 v8, 16, v141
    v_and_b32 v9, 0xffff0000, v141
    v_fma_f32 v50, v50, v176, v8
    v_fma_f32 v51, v51, v177, v9
    v_cvt_pk_bf16_f32 v141, v50, v51
    v_lshlrev_b32 v50, 16, v141
    v_and_b32 v51, 0xffff0000, v141
    s_add_u32 s36, s36, 4096
    buffer_store_dwordx2 v[140:141], v15, s[28:31], s36 offen offset:0
    v_add_f32 v10, v16, v17
    v_add_f32 v11, v18, v19
    v_add_f32 v10, v10, v20
    v_add_f32 v11, v11, v21
    v_add_f32 v10, v10, v22
    v_add_f32 v11, v11, v23
    v_add_f32 v10, v10, v24
    v_add_f32 v11, v11, v25
    v_add_f32 v10, v10, v26
    v_add_f32 v11, v11, v27
    v_add_f32 v10, v10, v28
    v_add_f32 v11, v11, v29
    v_add_f32 v10, v10, v30
    v_add_f32 v11, v11, v31
    v_add_f32 v10, v10, v32
    v_add_f32 v11, v11, v33
    v_add_f32 v10, v10, v34
    v_add_f32 v11, v11, v35
    v_add_f32 v10, v10, v36
    v_add_f32 v11, v11, v37
    v_add_f32 v10, v10, v38
    v_add_f32 v11, v11, v39
    v_add_f32 v10, v10, v40
    v_add_f32 v11, v11, v41
    v_add_f32 v10, v10, v42
    v_add_f32 v11, v11, v43
    v_add_f32 v10, v10, v44
    v_add_f32 v11, v11, v45
    v_add_f32 v10, v10, v46
    v_add_f32 v11, v11, v47
    v_add_f32 v10, v10, v48
    v_add_f32 v11, v11, v49
    v_add_f32 v10, v10, v50
    v_add_f32 v11, v11, v51
    v_add_f32 v10, v10, v11
    ds_swizzle_b32 v8, v10 offset:0x401F
    s_waitcnt lgkmcnt(0)
    v_add_f32 v10, v10, v8
    v_mov_b32 v8, v10
    s_nop 1
    v_permlane32_swap_b32 v8, v10
    v_add_f32 v10, v10, v8
    v_lshlrev_b32 v8, 4, v4
    s_lshl_b32 s37, s3, 2
    v_add_u32 v9, s37, v8
    ds_write_b32 v9, v10 offset:0
    s_waitcnt lgkmcnt(0)
    s_barrier
    ds_read_b128 v[72:75], v8 offset:0
    s_waitcnt lgkmcnt(0)
    v_add_f32 v72, v72, v73
    v_add_f32 v74, v74, v75
    v_add_f32 v10, v72, v74
    v_mul_f32 v10, 0x3ae38e39, v10
    v_sub_f32 v16, v16, v10
    v_sub_f32 v17, v17, v10
    v_sub_f32 v18, v18, v10
    v_sub_f32 v19, v19, v10
    v_sub_f32 v20, v20, v10
    v_sub_f32 v21, v21, v10
    v_sub_f32 v22, v22, v10
    v_sub_f32 v23, v23, v10
    v_sub_f32 v24, v24, v10
    v_sub_f32 v25, v25, v10
    v_sub_f32 v26, v26, v10
    v_sub_f32 v27, v27, v10
    v_sub_f32 v28, v28, v10
    v_sub_f32 v29, v29, v10
    v_sub_f32 v30, v30, v10
    v_sub_f32 v31, v31, v10
    v_sub_f32 v32, v32, v10
    v_sub_f32 v33, v33, v10
    v_sub_f32 v34, v34, v10
    v_sub_f32 v35, v35, v10
    v_sub_f32 v36, v36, v10
    v_sub_f32 v37, v37, v10
    v_sub_f32 v38, v38, v10
    v_sub_f32 v39, v39, v10
    v_sub_f32 v40, v40, v10
    v_sub_f32 v41, v41, v10
    v_sub_f32 v42, v42, v10
    v_sub_f32 v43, v43, v10
    v_sub_f32 v44, v44, v10
    v_sub_f32 v45, v45, v10
    v_sub_f32 v46, v46, v10
    v_sub_f32 v47, v47, v10
    v_sub_f32 v48, v48, v10
    v_sub_f32 v49, v49, v10
    v_sub_f32 v50, v50, v10
    v_sub_f32 v51, v51, v10
    v_mul_f32 v11, v16, v16
    v_mul_f32 v12, v17, v17
    v_fmac_f32 v11, v18, v18
    v_fmac_f32 v12, v19, v19
    v_fmac_f32 v11, v20, v20
    v_fmac_f32 v12, v21, v21
    v_fmac_f32 v11, v22, v22
    v_fmac_f32 v12, v23, v23
    v_fmac_f32 v11, v24, v24
    v_fmac_f32 v12, v25, v25
    v_fmac_f32 v11, v26, v26
    v_fmac_f32 v12, v27, v27
    v_fmac_f32 v11, v28, v28
    v_fmac_f32 v12, v29, v29
    v_fmac_f32 v11, v30, v30
    v_fmac_f32 v12, v31, v31
    v_fmac_f32 v11, v32, v32
    v_fmac_f32 v12, v33, v33
    v_fmac_f32 v11, v34, v34
    v_fmac_f32 v12, v35, v35
    v_fmac_f32 v11, v36, v36
    v_fmac_f32 v12, v37, v37
    v_fmac_f32 v11, v38, v38
    v_fmac_f32 v12, v39, v39
    v_fmac_f32 v11, v40, v40
    v_fmac_f32 v12, v41, v41
    v_fmac_f32 v11, v42, v42
    v_fmac_f32 v12, v43, v43
    v_fmac_f32 v11, v44, v44
    v_fmac_f32 v12, v45, v45
    v_fmac_f32 v11, v46, v46
    v_fmac_f32 v12, v47, v47
    v_fmac_f32 v11, v48, v48
    v_fmac_f32 v12, v49, v49
    v_fmac_f32 v11, v50, v50
    v_fmac_f32 v12, v51, v51
    v_add_f32 v11, v11, v12
    ds_swizzle_b32 v8, v11 offset:0x401F
    s_waitcnt lgkmcnt(0)
    v_add_f32 v11, v11, v8
    v_mov_b32 v8, v11
    s_nop 1
    v_permlane32_swap_b32 v8, v11
    v_add_f32 v11, v11, v8
    v_lshlrev_b32 v8, 4, v4
    s_lshl_b32 s37, s3, 2
    v_add_u32 v9, s37, v8
    ds_write_b32 v9, v11 offset:256
    s_waitcnt lgkmcnt(0)
    s_barrier
    ds_read_b128 v[72:75], v8 offset:256
    s_waitcnt lgkmcnt(0)
    v_add_f32 v72, v72, v73
    v_add_f32 v74, v74, v75
    v_add_f32 v11, v72, v74
    v_mov_b32 v12, 0x3727c5ac
    v_fmac_f32 v12, 0x3ae38e39, v11
    v_rsq_f32 v13, v12
    s_nop 0
    v_mul_f32 v8, v12, v13
    v_fma_f32 v8, -v8, v13, 1.0
    v_mul_f32 v9, 0.5, v13
    v_fmac_f32 v13, v8, v9
    s_mul_i32 s36, s2, 18432
    s_mul_i32 s37, s3, 9
    v_fma_f32 v178, v178, v13, v13
    v_fma_f32 v16, v16, v178, v214
    v_fma_f32 v179, v179, v13, v13
    v_fma_f32 v17, v17, v179, v215
    v_fma_f32 v180, v180, v13, v13
    v_fma_f32 v18, v18, v180, v216
    v_fma_f32 v181, v181, v13, v13
    v_fma_f32 v19, v19, v181, v217
    v_cvt_pk_bf16_f32 v16, v16, v17
    v_cvt_pk_bf16_f32 v17, v18, v19
    s_add_u32 s38, s37, 0
    s_lshr_b32 s39, s38, 1
    s_lshl_b32 s39, s39, 10
    s_and_b32 s38, s38, 1
    s_lshl_b32 s38, s38, 3
    s_add_u32 s38, s38, s39
    s_add_u32 s38, s38, s36
    buffer_store_dwordx2 v[16:17], v3, s[20:23], s38 offen
    v_fma_f32 v182, v182, v13, v13
    v_fma_f32 v20, v20, v182, v218
    v_fma_f32 v183, v183, v13, v13
    v_fma_f32 v21, v21, v183, v219
    v_fma_f32 v184, v184, v13, v13
    v_fma_f32 v22, v22, v184, v220
    v_fma_f32 v185, v185, v13, v13
    v_fma_f32 v23, v23, v185, v221
    v_cvt_pk_bf16_f32 v20, v20, v21
    v_cvt_pk_bf16_f32 v21, v22, v23
    s_add_u32 s38, s37, 1
    s_lshr_b32 s39, s38, 1
    s_lshl_b32 s39, s39, 10
    s_and_b32 s38, s38, 1
    s_lshl_b32 s38, s38, 3
    s_add_u32 s38, s38, s39
    s_add_u32 s38, s38, s36
    buffer_store_dwordx2 v[20:21], v3, s[20:23], s38 offen
    v_fma_f32 v186, v186, v13, v13
    v_fma_f32 v24, v24, v186, v222
    v_fma_f32 v187, v187, v13, v13
    v_fma_f32 v25, v25, v187, v223
    v_fma_f32 v188, v188, v13, v13
    v_fma_f32 v26, v26, v188, v224
    v_fma_f32 v189, v189, v13, v13
    v_fma_f32 v27, v27, v189, v225
    v_cvt_pk_bf16_f32 v24, v24, v25
    v_cvt_pk_bf16_f32 v25, v26, v27
    s_add_u32 s38, s37, 2
    s_lshr_b32 s39, s38, 1
    s_lshl_b32 s39, s39, 10
    s_and_b32 s38, s38, 1
    s_lshl_b32 s38, s38, 3
    s_add_u32 s38, s38, s39
    s_add_u32 s38, s38, s36
    buffer_store_dwordx2 v[24:25], v3, s[20:23], s38 offen
    v_fma_f32 v190, v190, v13, v13
    v_fma_f32 v28, v28, v190, v226
    v_fma_f32 v191, v191, v13, v13
    v_fma_f32 v29, v29, v191, v227
    v_fma_f32 v192, v192, v13, v13
    v_fma_f32 v30, v30, v192, v228
    v_fma_f32 v193, v193, v13, v13
    v_fma_f32 v31, v31, v193, v229
    v_cvt_pk_bf16_f32 v28, v28, v29
    v_cvt_pk_bf16_f32 v29, v30, v31
    s_add_u32 s38, s37, 3
    s_lshr_b32 s39, s38, 1
    s_lshl_b32 s39, s39, 10
    s_and_b32 s38, s38, 1
    s_lshl_b32 s38, s38, 3
    s_add_u32 s38, s38, s39
    s_add_u32 s38, s38, s36
    buffer_store_dwordx2 v[28:29], v3, s[20:23], s38 offen
    v_fma_f32 v194, v194, v13, v13
    v_fma_f32 v32, v32, v194, v230
    v_fma_f32 v195, v195, v13, v13
    v_fma_f32 v33, v33, v195, v231
    v_fma_f32 v196, v196, v13, v13
    v_fma_f32 v34, v34, v196, v232
    v_fma_f32 v197, v197, v13, v13
    v_fma_f32 v35, v35, v197, v233
    v_cvt_pk_bf16_f32 v32, v32, v33
    v_cvt_pk_bf16_f32 v33, v34, v35
    s_add_u32 s38, s37, 4
    s_lshr_b32 s39, s38, 1
    s_lshl_b32 s39, s39, 10
    s_and_b32 s38, s38, 1
    s_lshl_b32 s38, s38, 3
    s_add_u32 s38, s38, s39
    s_add_u32 s38, s38, s36
    buffer_store_dwordx2 v[32:33], v3, s[20:23], s38 offen
    v_fma_f32 v198, v198, v13, v13
    v_fma_f32 v36, v36, v198, v234
    v_fma_f32 v199, v199, v13, v13
    v_fma_f32 v37, v37, v199, v235
    v_fma_f32 v200, v200, v13, v13
    v_fma_f32 v38, v38, v200, v236
    v_fma_f32 v201, v201, v13, v13
    v_fma_f32 v39, v39, v201, v237
    v_cvt_pk_bf16_f32 v36, v36, v37
    v_cvt_pk_bf16_f32 v37, v38, v39
    s_add_u32 s38, s37, 5
    s_lshr_b32 s39, s38, 1
    s_lshl_b32 s39, s39, 10
    s_and_b32 s38, s38, 1
    s_lshl_b32 s38, s38, 3
    s_add_u32 s38, s38, s39
    s_add_u32 s38, s38, s36
    buffer_store_dwordx2 v[36:37], v3, s[20:23], s38 offen
    v_fma_f32 v202, v202, v13, v13
    v_fma_f32 v40, v40, v202, v238
    v_fma_f32 v203, v203, v13, v13
    v_fma_f32 v41, v41, v203, v239
    v_fma_f32 v204, v204, v13, v13
    v_fma_f32 v42, v42, v204, v240
    v_fma_f32 v205, v205, v13, v13
    v_fma_f32 v43, v43, v205, v241
    v_cvt_pk_bf16_f32 v40, v40, v41
    v_cvt_pk_bf16_f32 v41, v42, v43
    s_add_u32 s38, s37, 6
    s_lshr_b32 s39, s38, 1
    s_lshl_b32 s39, s39, 10
    s_and_b32 s38, s38, 1
    s_lshl_b32 s38, s38, 3
    s_add_u32 s38, s38, s39
    s_add_u32 s38, s38, s36
    buffer_store_dwordx2 v[40:41], v3, s[20:23], s38 offen
    v_fma_f32 v206, v206, v13, v13
    v_fma_f32 v44, v44, v206, v242
    v_fma_f32 v207, v207, v13, v13
    v_fma_f32 v45, v45, v207, v243
    v_fma_f32 v208, v208, v13, v13
    v_fma_f32 v46, v46, v208, v244
    v_fma_f32 v209, v209, v13, v13
    v_fma_f32 v47, v47, v209, v245
    v_cvt_pk_bf16_f32 v44, v44, v45
    v_cvt_pk_bf16_f32 v45, v46, v47
    s_add_u32 s38, s37, 7
    s_lshr_b32 s39, s38, 1
    s_lshl_b32 s39, s39, 10
    s_and_b32 s38, s38, 1
    s_lshl_b32 s38, s38, 3
    s_add_u32 s38, s38, s39
    s_add_u32 s38, s38, s36
    buffer_store_dwordx2 v[44:45], v3, s[20:23], s38 offen
    v_fma_f32 v210, v210, v13, v13
    v_fma_f32 v48, v48, v210, v246
    v_fma_f32 v211, v211, v13, v13
    v_fma_f32 v49, v49, v211, v247
    v_fma_f32 v212, v212, v13, v13
    v_fma_f32 v50, v50, v212, v248
    v_fma_f32 v213, v213, v13, v13
    v_fma_f32 v51, v51, v213, v249
    v_cvt_pk_bf16_f32 v48, v48, v49
    v_cvt_pk_bf16_f32 v49, v50, v51
    s_add_u32 s38, s37, 8
    s_lshr_b32 s39, s38, 1
    s_lshl_b32 s39, s39, 10
    s_and_b32 s38, s38, 1
    s_lshl_b32 s38, s38, 3
    s_add_u32 s38, s38, s39
    s_add_u32 s38, s38, s36
    buffer_store_dwordx2 v[48:49], v3, s[20:23], s38 offen
ln2_kernel_done1:
    s_endpgm
.globl g3_kernel
.type g3_kernel,@function
.p2align 8
g3_kernel:
    s_cmp_ge_u32 s2, 256
    s_cbranch_scc1 g3_kernel_done1
    s_load_dwordx2 s[4:5], s[0:1], 112
    s_load_dwordx2 s[6:7], s[0:1], 104
    s_and_b32 s40, s2, 7
    s_lshr_b32 s41, s2, 3
    s_lshr_b32 s42, s40, 1
    s_lshl_b32 s42, s42, 2
    s_and_b32 s43, s41, 3
    s_add_u32 s42, s42, s43
    s_and_b32 s43, s40, 1
    s_lshl_b32 s43, s43, 3
    s_lshr_b32 s44, s41, 2
    s_add_u32 s43, s43, s44
    v_lshrrev_b32 v1, 6, v0
    v_and_b32 v2, 63, v0
    v_readfirstlane_b32 s45, v1
    v_lshlrev_b32 v8, 4, v2
    s_lshr_b32 s46, s45, 1
    s_and_b32 s47, s45, 1
    s_lshl_b32 s48, s42, 7
    s_lshl_b32 s49, s46, 5
    s_add_u32 s48, s48, s49
    s_lshr_b32 s50, s48, 4
    s_mul_i32 s50, s50, 18432
    v_add_u32 v9, s50, v8
    v_add_u32 v10, 18432, v9
    s_mov_b32 s51, 0
    s_lshr_b32 s60, s45, 2
    s_and_b32 s61, s45, 3
    s_mul_i32 s52, s60, 294912
    s_mul_i32 s53, s43, 18432
    s_add_u32 s52, s52, s53
    s_mul_i32 s53, s61, 4608
    s_add_u32 s52, s52, s53
    s_mul_i32 s55, s60, 18432
    s_add_u32 s55, s55, s53
    s_mul_i32 s53, s47, 9216
    v_add_u32 v11, s53, v8
    v_add_u32 v12, 65536, v11
    v_add_u32 v13, 131072, v11
    s_mov_b32 s62, -1
    s_mov_b32 s63, 0xffff
    s_waitcnt lgkmcnt(0)
    s_add_u32 s12, s4, 0x2690000
    s_addc_u32 s13, s5, 0
    s_mov_b32 s14, 0x240000
    s_mov_b32 s15, 0x00020000
    s_add_u32 s16, s4, 0x7fd0000
    s_addc_u32 s17, s5, 0
    s_mov_b32 s18, 0x510000
    s_mov_b32 s19, 0x00020000
    buffer_load_dwordx4 v[40:43], v9, s[12:15], s51 offen offset:0
    buffer_load_dwordx4 v[44:47], v10, s[12:15], s51 offen offset:0
    buffer_load_dwordx4 v[48:51], v9, s[12:15], s51 offen offset:1024
    buffer_load_dwordx4 v[52:55], v10, s[12:15], s51 offen offset:1024
    s_add_u32 s51, s51, 2048
    s_add_u32 m0, s55, 0
    s_mov_b64 exec, s[62:63]
    buffer_load_dwordx4 v8, s[16:19], s52 offen offset:0 lds
    s_mov_b64 exec, -1
    s_mov_b64 exec, s[62:63]
    buffer_load_dwordx4 v8, s[16:19], s52 offen offset:768 lds
    s_mov_b64 exec, -1
    s_mov_b64 exec, s[62:63]
    buffer_load_dwordx4 v8, s[16:19], s52 offen offset:1536 lds
    s_mov_b64 exec, -1
    s_add_u32 m0, s55, 2304
    s_add_u32 s52, s52, 2304
    s_mov_b64 exec, s[62:63]
    buffer_load_dwordx4 v8, s[16:19], s52 offen offset:0 lds
    s_mov_b64 exec, -1
    s_mov_b64 exec, s[62:63]
    buffer_load_dwordx4 v8, s[16:19], s52 offen offset:768 lds
    s_mov_b64 exec, -1
    s_mov_b64 exec, s[62:63]
    buffer_load_dwordx4 v8, s[16:19], s52 offen offset:1536 lds
    s_mov_b64 exec, -1
    s_add_u32 s52, s52, 587520
    buffer_load_dwordx4 v[56:59], v9, s[12:15], s51 offen offset:0
    buffer_load_dwordx4 v[60:63], v10, s[12:15], s51 offen offset:0
    buffer_load_dwordx4 v[64:67], v9, s[12:15], s51 offen offset:1024
    buffer_load_dwordx4 v[68:71], v10, s[12:15], s51 offen offset:1024
    s_add_u32 s51, s51, 2048
    s_add_u32 m0, s55, 36864
    s_mov_b64 exec, s[62:63]
    buffer_load_dwordx4 v8, s[16:19], s52 offen offset:0 lds
    s_mov_b64 exec, -1
    s_mov_b64 exec, s[62:63]
    buffer_load_dwordx4 v8, s[16:19], s52 offen offset:768 lds
    s_mov_b64 exec, -1
    s_mov_b64 exec, s[62:63]
    buffer_load_dwordx4 v8, s[16:19], s52 offen offset:1536 lds
    s_mov_b64 exec, -1
    s_add_u32 m0, s55, 39168
    s_add_u32 s52, s52, 2304
    s_mov_b64 exec, s[62:63]
    buffer_load_dwordx4 v8, s[16:19], s52 offen offset:0 lds
    s_mov_b64 exec, -1
    s_mov_b64 exec, s[62:63]
    buffer_load_dwordx4 v8, s[16:19], s52 offen offset:768 lds
    s_mov_b64 exec, -1
    s_mov_b64 exec, s[62:63]
    buffer_load_dwordx4 v8, s[16:19], s52 offen offset:1536 lds
    s_mov_b64 exec, -1
    s_add_u32 s52, s52, 587520
    buffer_load_dwordx4 v[72:75], v9, s[12:15], s51 offen offset:0
    buffer_load_dwordx4 v[76:79], v10, s[12:15], s51 offen offset:0
    buffer_load_dwordx4 v[80:83], v9, s[12:15], s51 offen offset:1024
    buffer_load_dwordx4 v[84:87], v10, s[12:15], s51 offen offset:1024
    s_add_u32 s51, s51, 2048
    s_add_u32 m0, s55, 73728
    s_mov_b64 exec, s[62:63]
    buffer_load_dwordx4 v8, s[16:19], s52 offen offset:0 lds
    s_mov_b64 exec, -1
    s_mov_b64 exec, s[62:63]
    buffer_load_dwordx4 v8, s[16:19], s52 offen offset:768 lds
    s_mov_b64 exec, -1
    s_mov_b64 exec, s[62:63]
    buffer_load_dwordx4 v8, s[16:19], s52 offen offset:1536 lds
    s_mov_b64 exec, -1
    s_add_u32 m0, s55, 76032
    s_add_u32 s52, s52, 2304
    s_mov_b64 exec, s[62:63]
    buffer_load_dwordx4 v8, s[16:19], s52 offen offset:0 lds
    s_mov_b64 exec, -1
    s_mov_b64 exec, s[62:63]
    buffer_load_dwordx4 v8, s[16:19], s52 offen offset:768 lds
    s_mov_b64 exec, -1
    s_mov_b64 exec, s[62:63]
    buffer_load_dwordx4 v8, s[16:19], s52 offen offset:1536 lds
    s_mov_b64 exec, -1
    s_add_u32 s52, s52, 587520
    v_accvgpr_write_b32 a0, 0
    v_accvgpr_write_b32 a1, 0
    v_accvgpr_write_b32 a2, 0
    v_accvgpr_write_b32 a3, 0
    v_accvgpr_write_b32 a4, 0
    v_accvgpr_write_b32 a5, 0
    v_accvgpr_write_b32 a6, 0
    v_accvgpr_write_b32 a7, 0
    v_accvgpr_write_b32 a8, 0
    v_accvgpr_write_b32 a9, 0
    v_accvgpr_write_b32 a10, 0
    v_accvgpr_write_b32 a11, 0
    v_accvgpr_write_b32 a12, 0
    v_accvgpr_write_b32 a13, 0
    v_accvgpr_write_b32 a14, 0
    v_accvgpr_write_b32 a15, 0
    v_accvgpr_write_b32 a16, 0
    v_accvgpr_write_b32 a17, 0
    v_accvgpr_write_b32 a18, 0
    v_accvgpr_write_b32 a19, 0
    v_accvgpr_write_b32 a20, 0
    v_accvgpr_write_b32 a21, 0
    v_accvgpr_write_b32 a22, 0
    v_accvgpr_write_b32 a23, 0
    v_accvgpr_write_b32 a24, 0
    v_accvgpr_write_b32 a25, 0
    v_accvgpr_write_b32 a26, 0
    v_accvgpr_write_b32 a27, 0
    v_accvgpr_write_b32 a28, 0
    v_accvgpr_write_b32 a29, 0
    v_accvgpr_write_b32 a30, 0
    v_accvgpr_write_b32 a31, 0
    v_accvgpr_write_b32 a32, 0
    v_accvgpr_write_b32 a33, 0
    v_accvgpr_write_b32 a34, 0
    v_accvgpr_write_b32 a35, 0
    v_accvgpr_write_b32 a36, 0
    v_accvgpr_write_b32 a37, 0
    v_accvgpr_write_b32 a38, 0
    v_accvgpr_write_b32 a39, 0
    v_accvgpr_write_b32 a40, 0
    v_accvgpr_write_b32 a41, 0
    v_accvgpr_write_b32 a42, 0
    v_accvgpr_write_b32 a43, 0
    v_accvgpr_write_b32 a44, 0
    v_accvgpr_write_b32 a45, 0
    v_accvgpr_write_b32 a46, 0
    v_accvgpr_write_b32 a47, 0
    v_accvgpr_write_b32 a48, 0
    v_accvgpr_write_b32 a49, 0
    v_accvgpr_write_b32 a50, 0
    v_accvgpr_write_b32 a51, 0
    v_accvgpr_write_b32 a52, 0
    v_accvgpr_write_b32 a53, 0
    v_accvgpr_write_b32 a54, 0
    v_accvgpr_write_b32 a55, 0
    v_accvgpr_write_b32 a56, 0
    v_accvgpr_write_b32 a57, 0
    v_accvgpr_write_b32 a58, 0
    v_accvgpr_write_b32 a59, 0
    v_accvgpr_write_b32 a60, 0
    v_accvgpr_write_b32 a61, 0
    v_accvgpr_write_b32 a62, 0
    v_accvgpr_write_b32 a63, 0
    v_accvgpr_write_b32 a64, 0
    v_accvgpr_write_b32 a65, 0
    v_accvgpr_write_b32 a66, 0
    v_accvgpr_write_b32 a67, 0
    v_accvgpr_write_b32 a68, 0
    v_accvgpr_write_b32 a69, 0
    v_accvgpr_write_b32 a70, 0
    v_accvgpr_write_b32 a71, 0
    s_waitcnt vmcnt(20)
    s_barrier
    ds_read_b128 v[16:19], v11 offset:0
    ds_read_b128 v[20:23], v11 offset:1024
    ds_read_b128 v[24:27], v11 offset:2048
    ds_read_b128 v[28:31], v11 offset:3072
    ds_read_b128 v[32:35], v11 offset:4096
    ds_read_b128 v[36:39], v11 offset:5120
    s_waitcnt lgkmcnt(5)
    v_mfma_f32_16x16x32_bf16 a[0:3], v[16:19], v[40:43], a[0:3]
    v_mfma_f32_16x16x32_bf16 a[36:39], v[16:19], v[44:47], a[36:39]
    ds_read_b128 v[16:19], v11 offset:6144
    s_waitcnt lgkmcnt(5)
    v_mfma_f32_16x16x32_bf16 a[4:7], v[20:23], v[40:43], a[4:7]
    v_mfma_f32_16x16x32_bf16 a[40:43], v[20:23], v[44:47], a[40:43]
    ds_read_b128 v[20:23], v11 offset:7168
    s_waitcnt lgkmcnt(5)
    v_mfma_f32_16x16x32_bf16 a[8:11], v[24:27], v[40:43], a[8:11]
    v_mfma_f32_16x16x32_bf16 a[44:47], v[24:27], v[44:47], a[44:47]
    ds_read_b128 v[24:27], v11 offset:8192
    s_waitcnt lgkmcnt(5)
    v_mfma_f32_16x16x32_bf16 a[12:15], v[28:31], v[40:43], a[12:15]
    v_mfma_f32_16x16x32_bf16 a[48:51], v[28:31], v[44:47], a[48:51]
    ds_read_b128 v[28:31], v11 offset:18432
    s_waitcnt lgkmcnt(5)
    v_mfma_f32_16x16x32_bf16 a[16:19], v[32:35], v[40:43], a[16:19]
    v_mfma_f32_16x16x32_bf16 a[52:55], v[32:35], v[44:47], a[52:55]
    ds_read_b128 v[32:35], v11 offset:19456
    s_waitcnt lgkmcnt(5)
    v_mfma_f32_16x16x32_bf16 a[20:23], v[36:39], v[40:43], a[20:23]
    v_mfma_f32_16x16x32_bf16 a[56:59], v[36:39], v[44:47], a[56:59]
    s_waitcnt vmcnt(10)
    s_barrier
    ds_read_b128 v[36:39], v11 offset:20480
    s_waitcnt lgkmcnt(5)
    v_mfma_f32_16x16x32_bf16 a[24:27], v[16:19], v[40:43], a[24:27]
    v_mfma_f32_16x16x32_bf16 a[60:63], v[16:19], v[44:47], a[60:63]
    buffer_load_dwordx4 v[88:91], v9, s[12:15], s51 offen offset:0
    ds_read_b128 v[16:19], v11 offset:21504
    s_waitcnt lgkmcnt(5)
    v_mfma_f32_16x16x32_bf16 a[28:31], v[20:23], v[40:43], a[28:31]
    v_mfma_f32_16x16x32_bf16 a[64:67], v[20:23], v[44:47], a[64:67]
    buffer_load_dwordx4 v[92:95], v10, s[12:15], s51 offen offset:0
    ds_read_b128 v[20:23], v11 offset:22528
    s_waitcnt lgkmcnt(5)
    v_mfma_f32_16x16x32_bf16 a[32:35], v[24:27], v[40:43], a[32:35]
    v_mfma_f32_16x16x32_bf16 a[68:71], v[24:27], v[44:47], a[68:71]
    buffer_load_dwordx4 v[96:99], v9, s[12:15], s51 offen offset:1024
    ds_read_b128 v[24:27], v11 offset:23552
    s_waitcnt lgkmcnt(5)
    v_mfma_f32_16x16x32_bf16 a[0:3], v[28:31], v[48:51], a[0:3]
    v_mfma_f32_16x16x32_bf16 a[36:39], v[28:31], v[52:55], a[36:39]
    buffer_load_dwordx4 v[100:103], v10, s[12:15], s51 offen offset:1024
    s_add_u32 s51, s51, 2048
    ds_read_b128 v[28:31], v11 offset:24576
    s_waitcnt lgkmcnt(5)
    v_mfma_f32_16x16x32_bf16 a[4:7], v[32:35], v[48:51], a[4:7]
    v_mfma_f32_16x16x32_bf16 a[40:43], v[32:35], v[52:55], a[40:43]
    s_add_u32 m0, s55, 110592
    s_mov_b64 exec, s[62:63]
    buffer_load_dwordx4 v8, s[16:19], s52 offen offset:0 lds
    s_mov_b64 exec, -1
    ds_read_b128 v[32:35], v11 offset:25600
    s_waitcnt lgkmcnt(5)
    v_mfma_f32_16x16x32_bf16 a[8:11], v[36:39], v[48:51], a[8:11]
    v_mfma_f32_16x16x32_bf16 a[44:47], v[36:39], v[52:55], a[44:47]
    s_mov_b64 exec, s[62:63]
    buffer_load_dwordx4 v8, s[16:19], s52 offen offset:768 lds
    s_mov_b64 exec, -1
    ds_read_b128 v[36:39], v11 offset:26624
    s_waitcnt lgkmcnt(5)
    v_mfma_f32_16x16x32_bf16 a[12:15], v[16:19], v[48:51], a[12:15]
    v_mfma_f32_16x16x32_bf16 a[48:51], v[16:19], v[52:55], a[48:51]
    s_mov_b64 exec, s[62:63]
    buffer_load_dwordx4 v8, s[16:19], s52 offen offset:1536 lds
    s_mov_b64 exec, -1
    ds_read_b128 v[16:19], v11 offset:36864
    s_waitcnt lgkmcnt(5)
    v_mfma_f32_16x16x32_bf16 a[16:19], v[20:23], v[48:51], a[16:19]
    v_mfma_f32_16x16x32_bf16 a[52:55], v[20:23], v[52:55], a[52:55]
    s_add_u32 m0, s55, 112896
    s_add_u32 s52, s52, 2304
    s_mov_b64 exec, s[62:63]
    buffer_load_dwordx4 v8, s[16:19], s52 offen offset:0 lds
    s_mov_b64 exec, -1
    ds_read_b128 v[20:23], v11 offset:37888
    s_waitcnt lgkmcnt(5)
    v_mfma_f32_16x16x32_bf16 a[20:23], v[24:27], v[48:51], a[20:23]
    v_mfma_f32_16x16x32_bf16 a[56:59], v[24:27], v[52:55], a[56:59]
    s_mov_b64 exec, s[62:63]
    buffer_load_dwordx4 v8, s[16:19], s52 offen offset:768 lds
    s_mov_b64 exec, -1
    ds_read_b128 v[24:27], v11 offset:38912
    s_waitcnt lgkmcnt(5)
    v_mfma_f32_16x16x32_bf16 a[24:27], v[28:31], v[48:51], a[24:27]
    v_mfma_f32_16x16x32_bf16 a[60:63], v[28:31], v[52:55], a[60:63]
    s_mov_b64 exec, s[62:63]
    buffer_load_dwordx4 v8, s[16:19], s52 offen offset:1536 lds
    s_mov_b64 exec, -1
    s_add_u32 s52, s52, 587520
    ds_read_b128 v[28:31], v11 offset:39936
    s_waitcnt lgkmcnt(5)
    v_mfma_f32_16x16x32_bf16 a[28:31], v[32:35], v[48:51], a[28:31]
    v_mfma_f32_16x16x32_bf16 a[64:67], v[32:35], v[52:55], a[64:67]
    ds_read_b128 v[32:35], v11 offset:40960
    s_waitcnt lgkmcnt(5)
    v_mfma_f32_16x16x32_bf16 a[32:35], v[36:39], v[48:51], a[32:35]
    v_mfma_f32_16x16x32_bf16 a[68:71], v[36:39], v[52:55], a[68:71]
    ds_read_b128 v[36:39], v11 offset:41984
    s_waitcnt lgkmcnt(5)
    v_mfma_f32_16x16x32_bf16 a[0:3], v[16:19], v[56:59], a[0:3]
    v_mfma_f32_16x16x32_bf16 a[36:39], v[16:19], v[60:63], a[36:39]
    ds_read_b128 v[16:19], v11 offset:43008
    s_waitcnt lgkmcnt(5)
    v_mfma_f32_16x16x32_bf16 a[4:7], v[20:23], v[56:59], a[4:7]
    v_mfma_f32_16x16x32_bf16 a[40:43], v[20:23], v[60:63], a[40:43]
    ds_read_b128 v[20:23], v11 offset:44032
    s_waitcnt lgkmcnt(5)
    v_mfma_f32_16x16x32_bf16 a[8:11], v[24:27], v[56:59], a[8:11]
    v_mfma_f32_16x16x32_bf16 a[44:47], v[24:27], v[60:63], a[44:47]
    ds_read_b128 v[24:27], v11 offset:45056
    s_waitcnt lgkmcnt(5)
    v_mfma_f32_16x16x32_bf16 a[12:15], v[28:31], v[56:59], a[12:15]
    v_mfma_f32_16x16x32_bf16 a[48:51], v[28:31], v[60:63], a[48:51]
    ds_read_b128 v[28:31], v11 offset:55296
    s_waitcnt lgkmcnt(5)
    v_mfma_f32_16x16x32_bf16 a[16:19], v[32:35], v[56:59], a[16:19]
    v_mfma_f32_16x16x32_bf16 a[52:55], v[32:35], v[60:63], a[52:55]
    ds_read_b128 v[32:35], v11 offset:56320
    s_waitcnt lgkmcnt(5)
    v_mfma_f32_16x16x32_bf16 a[20:23], v[36:39], v[56:59], a[20:23]
    v_mfma_f32_16x16x32_bf16 a[56:59], v[36:39], v[60:63], a[56:59]
    s_waitcnt vmcnt(10)
    s_barrier
    ds_read_b128 v[36:39], v11 offset:57344
    s_waitcnt lgkmcnt(5)
    v_mfma_f32_16x16x32_bf16 a[24:27], v[16:19], v[56:59], a[24:27]
    v_mfma_f32_16x16x32_bf16 a[60:63], v[16:19], v[60:63], a[60:63]
    buffer_load_dwordx4 v[40:43], v9, s[12:15], s51 offen offset:0
    ds_read_b128 v[16:19], v11 offset:58368
    s_waitcnt lgkmcnt(5)
    v_mfma_f32_16x16x32_bf16 a[28:31], v[20:23], v[56:59], a[28:31]
    v_mfma_f32_16x16x32_bf16 a[64:67], v[20:23], v[60:63], a[64:67]
    buffer_load_dwordx4 v[44:47], v10, s[12:15], s51 offen offset:0
    ds_read_b128 v[20:23], v11 offset:59392
    s_waitcnt lgkmcnt(5)
    v_mfma_f32_16x16x32_bf16 a[32:35], v[24:27], v[56:59], a[32:35]
    v_mfma_f32_16x16x32_bf16 a[68:71], v[24:27], v[60:63], a[68:71]
    buffer_load_dwordx4 v[48:51], v9, s[12:15], s51 offen offset:1024
    ds_read_b128 v[24:27], v11 offset:60416
    s_waitcnt lgkmcnt(5)
    v_mfma_f32_16x16x32_bf16 a[0:3], v[28:31], v[64:67], a[0:3]
    v_mfma_f32_16x16x32_bf16 a[36:39], v[28:31], v[68:71], a[36:39]
    buffer_load_dwordx4 v[52:55], v10, s[12:15], s51 offen offset:1024
    s_add_u32 s51, s51, 2048
    ds_read_b128 v[28:31], v11 offset:61440
    s_waitcnt lgkmcnt(5)
    v_mfma_f32_16x16x32_bf16 a[4:7], v[32:35], v[64:67], a[4:7]
    v_mfma_f32_16x16x32_bf16 a[40:43], v[32:35], v[68:71], a[40:43]
    s_add_u32 m0, s55, 0
    s_mov_b64 exec, s[62:63]
    buffer_load_dwordx4 v8, s[16:19], s52 offen offset:0 lds
    s_mov_b64 exec, -1
    ds_read_b128 v[32:35], v11 offset:62464
    s_waitcnt lgkmcnt(5)
    v_mfma_f32_16x16x32_bf16 a[8:11], v[36:39], v[64:67], a[8:11]
    v_mfma_f32_16x16x32_bf16 a[44:47], v[36:39], v[68:71], a[44:47]
    s_mov_b64 exec, s[62:63]
    buffer_load_dwordx4 v8, s[16:19], s52 offen offset:768 lds
    s_mov_b64 exec, -1
    ds_read_b128 v[36:39], v11 offset:63488
    s_waitcnt lgkmcnt(5)
    v_mfma_f32_16x16x32_bf16 a[12:15], v[16:19], v[64:67], a[12:15]
    v_mfma_f32_16x16x32_bf16 a[48:51], v[16:19], v[68:71], a[48:51]
    s_mov_b64 exec, s[62:63]
    buffer_load_dwordx4 v8, s[16:19], s52 offen offset:1536 lds
    s_mov_b64 exec, -1
    ds_read_b128 v[16:19], v12 offset:8192
    s_waitcnt lgkmcnt(5)
    v_mfma_f32_16x16x32_bf16 a[16:19], v[20:23], v[64:67], a[16:19]
    v_mfma_f32_16x16x32_bf16 a[52:55], v[20:23], v[68:71], a[52:55]
    s_add_u32 m0, s55, 2304
    s_add_u32 s52, s52, 2304
    s_mov_b64 exec, s[62:63]
    buffer_load_dwordx4 v8, s[16:19], s52 offen offset:0 lds
    s_mov_b64 exec, -1
    ds_read_b128 v[20:23], v12 offset:9216
    s_waitcnt lgkmcnt(5)
    v_mfma_f32_16x16x32_bf16 a[20:23], v[24:27], v[64:67], a[20:23]
    v_mfma_f32_16x16x32_bf16 a[56:59], v[24:27], v[68:71], a[56:59]
    s_mov_b64 exec, s[62:63]
    buffer_load_dwordx4 v8, s[16:19], s52 offen offset:768 lds
    s_mov_b64 exec, -1
    ds_read_b128 v[24:27], v12 offset:10240
    s_waitcnt lgkmcnt(5)
    v_mfma_f32_16x16x32_bf16 a[24:27], v[28:31], v[64:67], a[24:27]
    v_mfma_f32_16x16x32_bf16 a[60:63], v[28:31], v[68:71], a[60:63]
    s_mov_b64 exec, s[62:63]
    buffer_load_dwordx4 v8, s[16:19], s52 offen offset:1536 lds
    s_mov_b64 exec, -1
    s_add_u32 s52, s52, 587520
    ds_read_b128 v[28:31], v12 offset:11264
    s_waitcnt lgkmcnt(5)
    v_mfma_f32_16x16x32_bf16 a[28:31], v[32:35], v[64:67], a[28:31]
    v_mfma_f32_16x16x32_bf16 a[64:67], v[32:35], v[68:71], a[64:67]
    ds_read_b128 v[32:35], v12 offset:12288
    s_waitcnt lgkmcnt(5)
    v_mfma_f32_16x16x32_bf16 a[32:35], v[36:39], v[64:67], a[32:35]
    v_mfma_f32_16x16x32_bf16 a[68:71], v[36:39], v[68:71], a[68:71]
    ds_read_b128 v[36:39], v12 offset:13312
    s_waitcnt lgkmcnt(5)
    v_mfma_f32_16x16x32_bf16 a[0:3], v[16:19], v[72:75], a[0:3]
    v_mfma_f32_16x16x32_bf16 a[36:39], v[16:19], v[76:79], a[36:39]
    ds_read_b128 v[16:19], v12 offset:14336
    s_waitcnt lgkmcnt(5)
    v_mfma_f32_16x16x32_bf16 a[4:7], v[20:23], v[72:75], a[4:7]
    v_mfma_f32_16x16x32_bf16 a[40:43], v[20:23], v[76:79], a[40:43]
    ds_read_b128 v[20:23], v12 offset:15360
    s_waitcnt lgkmcnt(5)
    v_mfma_f32_16x16x32_bf16 a[8:11], v[24:27], v[72:75], a[8:11]
    v_mfma_f32_16x16x32_bf16 a[44:47], v[24:27], v[76:79], a[44:47]
    ds_read_b128 v[24:27], v12 offset:16384
    s_waitcnt lgkmcnt(5)
    v_mfma_f32_16x16x32_bf16 a[12:15], v[28:31], v[72:75], a[12:15]
    v_mfma_f32_16x16x32_bf16 a[48:51], v[28:31], v[76:79], a[48:51]
    ds_read_b128 v[28:31], v12 offset:26624
    s_waitcnt lgkmcnt(5)
    v_mfma_f32_16x16x32_bf16 a[16:19], v[32:35], v[72:75], a[16:19]
    v_mfma_f32_16x16x32_bf16 a[52:55], v[32:35], v[76:79], a[52:55]
    ds_read_b128 v[32:35], v12 offset:27648
    s_waitcnt lgkmcnt(5)
    v_mfma_f32_16x16x32_bf16 a[20:23], v[36:39], v[72:75], a[20:23]
    v_mfma_f32_16x16x32_bf16 a[56:59], v[36:39], v[76:79], a[56:59]
    s_waitcnt vmcnt(10)
    s_barrier
    ds_read_b128 v[36:39], v12 offset:28672
    s_waitcnt lgkmcnt(5)
    v_mfma_f32_16x16x32_bf16 a[24:27], v[16:19], v[72:75], a[24:27]
    v_mfma_f32_16x16x32_bf16 a[60:63], v[16:19], v[76:79], a[60:63]
    buffer_load_dwordx4 v[56:59], v9, s[12:15], s51 offen offset:0
    ds_read_b128 v[16:19], v12 offset:29696
    s_waitcnt lgkmcnt(5)
    v_mfma_f32_16x16x32_bf16 a[28:31], v[20:23], v[72:75], a[28:31]
    v_mfma_f32_16x16x32_bf16 a[64:67], v[20:23], v[76:79], a[64:67]
    buffer_load_dwordx4 v[60:63], v10, s[12:15], s51 offen offset:0
    ds_read_b128 v[20:23], v12 offset:30720
    s_waitcnt lgkmcnt(5)
    v_mfma_f32_16x16x32_bf16 a[32:35], v[24:27], v[72:75], a[32:35]
    v_mfma_f32_16x16x32_bf16 a[68:71], v[24:27], v[76:79], a[68:71]
    buffer_load_dwordx4 v[64:67], v9, s[12:15], s51 offen offset:1024
    ds_read_b128 v[24:27], v12 offset:31744
    s_waitcnt lgkmcnt(5)
    v_mfma_f32_16x16x32_bf16 a[0:3], v[28:31], v[80:83], a[0:3]
    v_mfma_f32_16x16x32_bf16 a[36:39], v[28:31], v[84:87], a[36:39]
    buffer_load_dwordx4 v[68:71], v10, s[12:15], s51 offen offset:1024
    s_add_u32 s51, s51, 2048
    ds_read_b128 v[28:31], v12 offset:32768
    s_waitcnt lgkmcnt(5)
    v_mfma_f32_16x16x32_bf16 a[4:7], v[32:35], v[80:83], a[4:7]
    v_mfma_f32_16x16x32_bf16 a[40:43], v[32:35], v[84:87], a[40:43]
    s_add_u32 m0, s55, 36864
    s_mov_b64 exec, s[62:63]
    buffer_load_dwordx4 v8, s[16:19], s52 offen offset:0 lds
    s_mov_b64 exec, -1
    ds_read_b128 v[32:35], v12 offset:33792
    s_waitcnt lgkmcnt(5)
    v_mfma_f32_16x16x32_bf16 a[8:11], v[36:39], v[80:83], a[8:11]
    v_mfma_f32_16x16x32_bf16 a[44:47], v[36:39], v[84:87], a[44:47]
    s_mov_b64 exec, s[62:63]
    buffer_load_dwordx4 v8, s[16:19], s52 offen offset:768 lds
    s_mov_b64 exec, -1
    ds_read_b128 v[36:39], v12 offset:34816
    s_waitcnt lgkmcnt(5)
    v_mfma_f32_16x16x32_bf16 a[12:15], v[16:19], v[80:83], a[12:15]
    v_mfma_f32_16x16x32_bf16 a[48:51], v[16:19], v[84:87], a[48:51]
    s_mov_b64 exec, s[62:63]
    buffer_load_dwordx4 v8, s[16:19], s52 offen offset:1536 lds
    s_mov_b64 exec, -1
    ds_read_b128 v[16:19], v12 offset:45056
    s_waitcnt lgkmcnt(5)
    v_mfma_f32_16x16x32_bf16 a[16:19], v[20:23], v[80:83], a[16:19]
    v_mfma_f32_16x16x32_bf16 a[52:55], v[20:23], v[84:87], a[52:55]
    s_add_u32 m0, s55, 39168
    s_add_u32 s52, s52, 2304
    s_mov_b64 exec, s[62:63]
    buffer_load_dwordx4 v8, s[16:19], s52 offen offset:0 lds
    s_mov_b64 exec, -1
    ds_read_b128 v[20:23], v12 offset:46080
    s_waitcnt lgkmcnt(5)
    v_mfma_f32_16x16x32_bf16 a[20:23], v[24:27], v[80:83], a[20:23]
    v_mfma_f32_16x16x32_bf16 a[56:59], v[24:27], v[84:87], a[56:59]
    s_mov_b64 exec, s[62:63]
    buffer_load_dwordx4 v8, s[16:19], s52 offen offset:768 lds
    s_mov_b64 exec, -1
    ds_read_b128 v[24:27], v12 offset:47104
    s_waitcnt lgkmcnt(5)
    v_mfma_f32_16x16x32_bf16 a[24:27], v[28:31], v[80:83], a[24:27]
    v_mfma_f32_16x16x32_bf16 a[60:63], v[28:31], v[84:87], a[60:63]
    s_mov_b64 exec, s[62:63]
    buffer_load_dwordx4 v8, s[16:19], s52 offen offset:1536 lds
    s_mov_b64 exec, -1
    s_add_u32 s52, s52, 587520
    ds_read_b128 v[28:31], v12 offset:48128
    s_waitcnt lgkmcnt(5)
    v_mfma_f32_16x16x32_bf16 a[28:31], v[32:35], v[80:83], a[28:31]
    v_mfma_f32_16x16x32_bf16 a[64:67], v[32:35], v[84:87], a[64:67]
    ds_read_b128 v[32:35], v12 offset:49152
    s_waitcnt lgkmcnt(5)
    v_mfma_f32_16x16x32_bf16 a[32:35], v[36:39], v[80:83], a[32:35]
    v_mfma_f32_16x16x32_bf16 a[68:71], v[36:39], v[84:87], a[68:71]
    ds_read_b128 v[36:39], v12 offset:50176
    s_waitcnt lgkmcnt(5)
    v_mfma_f32_16x16x32_bf16 a[0:3], v[16:19], v[88:91], a[0:3]
    v_mfma_f32_16x16x32_bf16 a[36:39], v[16:19], v[92:95], a[36:39]
    ds_read_b128 v[16:19], v12 offset:51200
    s_waitcnt lgkmcnt(5)
    v_mfma_f32_16x16x32_bf16 a[4:7], v[20:23], v[88:91], a[4:7]
    v_mfma_f32_16x16x32_bf16 a[40:43], v[20:23], v[92:95], a[40:43]
    ds_read_b128 v[20:23], v12 offset:52224
    s_waitcnt lgkmcnt(5)
    v_mfma_f32_16x16x32_bf16 a[8:11], v[24:27], v[88:91], a[8:11]
    v_mfma_f32_16x16x32_bf16 a[44:47], v[24:27], v[92:95], a[44:47]
    ds_read_b128 v[24:27], v12 offset:53248
    s_waitcnt lgkmcnt(5)
    v_mfma_f32_16x16x32_bf16 a[12:15], v[28:31], v[88:91], a[12:15]
    v_mfma_f32_16x16x32_bf16 a[48:51], v[28:31], v[92:95], a[48:51]
    ds_read_b128 v[28:31], v12 offset:63488
    s_waitcnt lgkmcnt(5)
    v_mfma_f32_16x16x32_bf16 a[16:19], v[32:35], v[88:91], a[16:19]
    v_mfma_f32_16x16x32_bf16 a[52:55], v[32:35], v[92:95], a[52:55]
    ds_read_b128 v[32:35], v12 offset:64512
    s_waitcnt lgkmcnt(5)
    v_mfma_f32_16x16x32_bf16 a[20:23], v[36:39], v[88:91], a[20:23]
    v_mfma_f32_16x16x32_bf16 a[56:59], v[36:39], v[92:95], a[56:59]
    s_waitcnt vmcnt(10)
    s_barrier
    ds_read_b128 v[36:39], v13 offset:0
    s_waitcnt lgkmcnt(5)
    v_mfma_f32_16x16x32_bf16 a[24:27], v[16:19], v[88:91], a[24:27]
    v_mfma_f32_16x16x32_bf16 a[60:63], v[16:19], v[92:95], a[60:63]
    buffer_load_dwordx4 v[72:75], v9, s[12:15], s51 offen offset:0
    ds_read_b128 v[16:19], v13 offset:1024
    s_waitcnt lgkmcnt(5)
    v_mfma_f32_16x16x32_bf16 a[28:31], v[20:23], v[88:91], a[28:31]
    v_mfma_f32_16x16x32_bf16 a[64:67], v[20:23], v[92:95], a[64:67]
    buffer_load_dwordx4 v[76:79], v10, s[12:15], s51 offen offset:0
    ds_read_b128 v[20:23], v13 offset:2048
    s_waitcnt lgkmcnt(5)
    v_mfma_f32_16x16x32_bf16 a[32:35], v[24:27], v[88:91], a[32:35]
    v_mfma_f32_16x16x32_bf16 a[68:71], v[24:27], v[92:95], a[68:71]
    buffer_load_dwordx4 v[80:83], v9, s[12:15], s51 offen offset:1024
    ds_read_b128 v[24:27], v13 offset:3072
    s_waitcnt lgkmcnt(5)
    v_mfma_f32_16x16x32_bf16 a[0:3], v[28:31], v[96:99], a[0:3]
    v_mfma_f32_16x16x32_bf16 a[36:39], v[28:31], v[100:103], a[36:39]
    buffer_load_dwordx4 v[84:87], v10, s[12:15], s51 offen offset:1024
    s_add_u32 s51, s51, 2048
    ds_read_b128 v[28:31], v13 offset:4096
    s_waitcnt lgkmcnt(5)
    v_mfma_f32_16x16x32_bf16 a[4:7], v[32:35], v[96:99], a[4:7]
    v_mfma_f32_16x16x32_bf16 a[40:43], v[32:35], v[100:103], a[40:43]
    s_add_u32 m0, s55, 73728
    s_mov_b64 exec, s[62:63]
    buffer_load_dwordx4 v8, s[16:19], s52 offen offset:0 lds
    s_mov_b64 exec, -1
    ds_read_b128 v[32:35], v13 offset:5120
    s_waitcnt lgkmcnt(5)
    v_mfma_f32_16x16x32_bf16 a[8:11], v[36:39], v[96:99], a[8:11]
    v_mfma_f32_16x16x32_bf16 a[44:47], v[36:39], v[100:103], a[44:47]
    s_mov_b64 exec, s[62:63]
    buffer_load_dwordx4 v8, s[16:19], s52 offen offset:768 lds
    s_mov_b64 exec, -1
    ds_read_b128 v[36:39], v13 offset:6144
    s_waitcnt lgkmcnt(5)
    v_mfma_f32_16x16x32_bf16 a[12:15], v[16:19], v[96:99], a[12:15]
    v_mfma_f32_16x16x32_bf16 a[48:51], v[16:19], v[100:103], a[48:51]
    s_mov_b64 exec, s[62:63]
    buffer_load_dwordx4 v8, s[16:19], s52 offen offset:1536 lds
    s_mov_b64 exec, -1
    ds_read_b128 v[16:19], v11 offset:0
    s_waitcnt lgkmcnt(5)
    v_mfma_f32_16x16x32_bf16 a[16:19], v[20:23], v[96:99], a[16:19]
    v_mfma_f32_16x16x32_bf16 a[52:55], v[20:23], v[100:103], a[52:55]
    s_add_u32 m0, s55, 76032
    s_add_u32 s52, s52, 2304
    s_mov_b64 exec, s[62:63]
    buffer_load_dwordx4 v8, s[16:19], s52 offen offset:0 lds
    s_mov_b64 exec, -1
    ds_read_b128 v[20:23], v11 offset:1024
    s_waitcnt lgkmcnt(5)
    v_mfma_f32_16x16x32_bf16 a[20:23], v[24:27], v[96:99], a[20:23]
    v_mfma_f32_16x16x32_bf16 a[56:59], v[24:27], v[100:103], a[56:59]
    s_mov_b64 exec, s[62:63]
    buffer_load_dwordx4 v8, s[16:19], s52 offen offset:768 lds
    s_mov_b64 exec, -1
    ds_read_b128 v[24:27], v11 offset:2048
    s_waitcnt lgkmcnt(5)
    v_mfma_f32_16x16x32_bf16 a[24:27], v[28:31], v[96:99], a[24:27]
    v_mfma_f32_16x16x32_bf16 a[60:63], v[28:31], v[100:103], a[60:63]
    s_mov_b64 exec, s[62:63]
    buffer_load_dwordx4 v8, s[16:19], s52 offen offset:1536 lds
    s_mov_b64 exec, -1
    s_add_u32 s52, s52, 587520
    ds_read_b128 v[28:31], v11 offset:3072
    s_waitcnt lgkmcnt(5)
    v_mfma_f32_16x16x32_bf16 a[28:31], v[32:35], v[96:99], a[28:31]
    v_mfma_f32_16x16x32_bf16 a[64:67], v[32:35], v[100:103], a[64:67]
    ds_read_b128 v[32:35], v11 offset:4096
    s_waitcnt lgkmcnt(5)
    v_mfma_f32_16x16x32_bf16 a[32:35], v[36:39], v[96:99], a[32:35]
    v_mfma_f32_16x16x32_bf16 a[68:71], v[36:39], v[100:103], a[68:71]
    ds_read_b128 v[36:39], v11 offset:5120
    s_waitcnt lgkmcnt(5)
    v_mfma_f32_16x16x32_bf16 a[0:3], v[16:19], v[40:43], a[0:3]
    v_mfma_f32_16x16x32_bf16 a[36:39], v[16:19], v[44:47], a[36:39]
    ds_read_b128 v[16:19], v11 offset:6144
    s_waitcnt lgkmcnt(5)
    v_mfma_f32_16x16x32_bf16 a[4:7], v[20:23], v[40:43], a[4:7]
    v_mfma_f32_16x16x32_bf16 a[40:43], v[20:23], v[44:47], a[40:43]
    ds_read_b128 v[20:23], v11 offset:7168
    s_waitcnt lgkmcnt(5)
    v_mfma_f32_16x16x32_bf16 a[8:11], v[24:27], v[40:43], a[8:11]
    v_mfma_f32_16x16x32_bf16 a[44:47], v[24:27], v[44:47], a[44:47]
    ds_read_b128 v[24:27], v11 offset:8192
    s_waitcnt lgkmcnt(5)
    v_mfma_f32_16x16x32_bf16 a[12:15], v[28:31], v[40:43], a[12:15]
    v_mfma_f32_16x16x32_bf16 a[48:51], v[28:31], v[44:47], a[48:51]
    ds_read_b128 v[28:31], v11 offset:18432
    s_waitcnt lgkmcnt(5)
    v_mfma_f32_16x16x32_bf16 a[16:19], v[32:35], v[40:43], a[16:19]
    v_mfma_f32_16x16x32_bf16 a[52:55], v[32:35], v[44:47], a[52:55]
    ds_read_b128 v[32:35], v11 offset:19456
    s_waitcnt lgkmcnt(5)
    v_mfma_f32_16x16x32_bf16 a[20:23], v[36:39], v[40:43], a[20:23]
    v_mfma_f32_16x16x32_bf16 a[56:59], v[36:39], v[44:47], a[56:59]
    s_waitcnt vmcnt(10)
    s_barrier
    ds_read_b128 v[36:39], v11 offset:20480
    s_waitcnt lgkmcnt(5)
    v_mfma_f32_16x16x32_bf16 a[24:27], v[16:19], v[40:43], a[24:27]
    v_mfma_f32_16x16x32_bf16 a[60:63], v[16:19], v[44:47], a[60:63]
    buffer_load_dwordx4 v[88:91], v9, s[12:15], s51 offen offset:0
    ds_read_b128 v[16:19], v11 offset:21504
    s_waitcnt lgkmcnt(5)
    v_mfma_f32_16x16x32_bf16 a[28:31], v[20:23], v[40:43], a[28:31]
    v_mfma_f32_16x16x32_bf16 a[64:67], v[20:23], v[44:47], a[64:67]
    buffer_load_dwordx4 v[92:95], v10, s[12:15], s51 offen offset:0
    ds_read_b128 v[20:23], v11 offset:22528
    s_waitcnt lgkmcnt(5)
    v_mfma_f32_16x16x32_bf16 a[32:35], v[24:27], v[40:43], a[32:35]
    v_mfma_f32_16x16x32_bf16 a[68:71], v[24:27], v[44:47], a[68:71]
    buffer_load_dwordx4 v[96:99], v9, s[12:15], s51 offen offset:1024
    ds_read_b128 v[24:27], v11 offset:23552
    s_waitcnt lgkmcnt(5)
    v_mfma_f32_16x16x32_bf16 a[0:3], v[28:31], v[48:51], a[0:3]
    v_mfma_f32_16x16x32_bf16 a[36:39], v[28:31], v[52:55], a[36:39]
    buffer_load_dwordx4 v[100:103], v10, s[12:15], s51 offen offset:1024
    s_add_u32 s51, s51, 2048
    ds_read_b128 v[28:31], v11 offset:24576
    s_waitcnt lgkmcnt(5)
    v_mfma_f32_16x16x32_bf16 a[4:7], v[32:35], v[48:51], a[4:7]
    v_mfma_f32_16x16x32_bf16 a[40:43], v[32:35], v[52:55], a[40:43]
    s_add_u32 m0, s55, 110592
    s_mov_b64 exec, s[62:63]
    buffer_load_dwordx4 v8, s[16:19], s52 offen offset:0 lds
    s_mov_b64 exec, -1
    ds_read_b128 v[32:35], v11 offset:25600
    s_waitcnt lgkmcnt(5)
    v_mfma_f32_16x16x32_bf16 a[8:11], v[36:39], v[48:51], a[8:11]
    v_mfma_f32_16x16x32_bf16 a[44:47], v[36:39], v[52:55], a[44:47]
    s_mov_b64 exec, s[62:63]
    buffer_load_dwordx4 v8, s[16:19], s52 offen offset:768 lds
    s_mov_b64 exec, -1
    ds_read_b128 v[36:39], v11 offset:26624
    s_waitcnt lgkmcnt(5)
    v_mfma_f32_16x16x32_bf16 a[12:15], v[16:19], v[48:51], a[12:15]
    v_mfma_f32_16x16x32_bf16 a[48:51], v[16:19], v[52:55], a[48:51]
    s_mov_b64 exec, s[62:63]
    buffer_load_dwordx4 v8, s[16:19], s52 offen offset:1536 lds
    s_mov_b64 exec, -1
    ds_read_b128 v[16:19], v11 offset:36864
    s_waitcnt lgkmcnt(5)
    v_mfma_f32_16x16x32_bf16 a[16:19], v[20:23], v[48:51], a[16:19]
    v_mfma_f32_16x16x32_bf16 a[52:55], v[20:23], v[52:55], a[52:55]
    s_add_u32 m0, s55, 112896
    s_add_u32 s52, s52, 2304
    s_mov_b64 exec, s[62:63]
    buffer_load_dwordx4 v8, s[16:19], s52 offen offset:0 lds
    s_mov_b64 exec, -1
    ds_read_b128 v[20:23], v11 offset:37888
    s_waitcnt lgkmcnt(5)
    v_mfma_f32_16x16x32_bf16 a[20:23], v[24:27], v[48:51], a[20:23]
    v_mfma_f32_16x16x32_bf16 a[56:59], v[24:27], v[52:55], a[56:59]
    s_mov_b64 exec, s[62:63]
    buffer_load_dwordx4 v8, s[16:19], s52 offen offset:768 lds
    s_mov_b64 exec, -1
    ds_read_b128 v[24:27], v11 offset:38912
    s_waitcnt lgkmcnt(5)
    v_mfma_f32_16x16x32_bf16 a[24:27], v[28:31], v[48:51], a[24:27]
    v_mfma_f32_16x16x32_bf16 a[60:63], v[28:31], v[52:55], a[60:63]
    s_mov_b64 exec, s[62:63]
    buffer_load_dwordx4 v8, s[16:19], s52 offen offset:1536 lds
    s_mov_b64 exec, -1
    s_add_u32 s52, s52, 587520
    ds_read_b128 v[28:31], v11 offset:39936
    s_waitcnt lgkmcnt(5)
    v_mfma_f32_16x16x32_bf16 a[28:31], v[32:35], v[48:51], a[28:31]
    v_mfma_f32_16x16x32_bf16 a[64:67], v[32:35], v[52:55], a[64:67]
    ds_read_b128 v[32:35], v11 offset:40960
    s_waitcnt lgkmcnt(5)
    v_mfma_f32_16x16x32_bf16 a[32:35], v[36:39], v[48:51], a[32:35]
    v_mfma_f32_16x16x32_bf16 a[68:71], v[36:39], v[52:55], a[68:71]
    ds_read_b128 v[36:39], v11 offset:41984
    s_waitcnt lgkmcnt(5)
    v_mfma_f32_16x16x32_bf16 a[0:3], v[16:19], v[56:59], a[0:3]
    v_mfma_f32_16x16x32_bf16 a[36:39], v[16:19], v[60:63], a[36:39]
    ds_read_b128 v[16:19], v11 offset:43008
    s_waitcnt lgkmcnt(5)
    v_mfma_f32_16x16x32_bf16 a[4:7], v[20:23], v[56:59], a[4:7]
    v_mfma_f32_16x16x32_bf16 a[40:43], v[20:23], v[60:63], a[40:43]
    ds_read_b128 v[20:23], v11 offset:44032
    s_waitcnt lgkmcnt(5)
    v_mfma_f32_16x16x32_bf16 a[8:11], v[24:27], v[56:59], a[8:11]
    v_mfma_f32_16x16x32_bf16 a[44:47], v[24:27], v[60:63], a[44:47]
    ds_read_b128 v[24:27], v11 offset:45056
    s_waitcnt lgkmcnt(5)
    v_mfma_f32_16x16x32_bf16 a[12:15], v[28:31], v[56:59], a[12:15]
    v_mfma_f32_16x16x32_bf16 a[48:51], v[28:31], v[60:63], a[48:51]
    ds_read_b128 v[28:31], v11 offset:55296
    s_waitcnt lgkmcnt(5)
    v_mfma_f32_16x16x32_bf16 a[16:19], v[32:35], v[56:59], a[16:19]
    v_mfma_f32_16x16x32_bf16 a[52:55], v[32:35], v[60:63], a[52:55]
    ds_read_b128 v[32:35], v11 offset:56320
    s_waitcnt lgkmcnt(5)
    v_mfma_f32_16x16x32_bf16 a[20:23], v[36:39], v[56:59], a[20:23]
    v_mfma_f32_16x16x32_bf16 a[56:59], v[36:39], v[60:63], a[56:59]
    s_waitcnt vmcnt(10)
    s_barrier
    ds_read_b128 v[36:39], v11 offset:57344
    s_waitcnt lgkmcnt(5)
    v_mfma_f32_16x16x32_bf16 a[24:27], v[16:19], v[56:59], a[24:27]
    v_mfma_f32_16x16x32_bf16 a[60:63], v[16:19], v[60:63], a[60:63]
    buffer_load_dwordx4 v[40:43], v9, s[12:15], s51 offen offset:0
    ds_read_b128 v[16:19], v11 offset:58368
    s_waitcnt lgkmcnt(5)
    v_mfma_f32_16x16x32_bf16 a[28:31], v[20:23], v[56:59], a[28:31]
    v_mfma_f32_16x16x32_bf16 a[64:67], v[20:23], v[60:63], a[64:67]
    buffer_load_dwordx4 v[44:47], v10, s[12:15], s51 offen offset:0
    ds_read_b128 v[20:23], v11 offset:59392
    s_waitcnt lgkmcnt(5)
    v_mfma_f32_16x16x32_bf16 a[32:35], v[24:27], v[56:59], a[32:35]
    v_mfma_f32_16x16x32_bf16 a[68:71], v[24:27], v[60:63], a[68:71]
    buffer_load_dwordx4 v[48:51], v9, s[12:15], s51 offen offset:1024
    ds_read_b128 v[24:27], v11 offset:60416
    s_waitcnt lgkmcnt(5)
    v_mfma_f32_16x16x32_bf16 a[0:3], v[28:31], v[64:67], a[0:3]
    v_mfma_f32_16x16x32_bf16 a[36:39], v[28:31], v[68:71], a[36:39]
    buffer_load_dwordx4 v[52:55], v10, s[12:15], s51 offen offset:1024
    s_add_u32 s51, s51, 2048
    ds_read_b128 v[28:31], v11 offset:61440
    s_waitcnt lgkmcnt(5)
    v_mfma_f32_16x16x32_bf16 a[4:7], v[32:35], v[64:67], a[4:7]
    v_mfma_f32_16x16x32_bf16 a[40:43], v[32:35], v[68:71], a[40:43]
    s_add_u32 m0, s55, 0
    s_mov_b64 exec, s[62:63]
    buffer_load_dwordx4 v8, s[16:19], s52 offen offset:0 lds
    s_mov_b64 exec, -1
    ds_read_b128 v[32:35], v11 offset:62464
    s_waitcnt lgkmcnt(5)
    v_mfma_f32_16x16x32_bf16 a[8:11], v[36:39], v[64:67], a[8:11]
    v_mfma_f32_16x16x32_bf16 a[44:47], v[36:39], v[68:71], a[44:47]
    s_mov_b64 exec, s[62:63]
    buffer_load_dwordx4 v8, s[16:19], s52 offen offset:768 lds
    s_mov_b64 exec, -1
    ds_read_b128 v[36:39], v11 offset:63488
    s_waitcnt lgkmcnt(5)
    v_mfma_f32_16x16x32_bf16 a[12:15], v[16:19], v[64:67], a[12:15]
    v_mfma_f32_16x16x32_bf16 a[48:51], v[16:19], v[68:71], a[48:51]
    s_mov_b64 exec, s[62:63]
    buffer_load_dwordx4 v8, s[16:19], s52 offen offset:1536 lds
    s_mov_b64 exec, -1
    ds_read_b128 v[16:19], v12 offset:8192
    s_waitcnt lgkmcnt(5)
    v_mfma_f32_16x16x32_bf16 a[16:19], v[20:23], v[64:67], a[16:19]
    v_mfma_f32_16x16x32_bf16 a[52:55], v[20:23], v[68:71], a[52:55]
    s_add_u32 m0, s55, 2304
    s_add_u32 s52, s52, 2304
    s_mov_b64 exec, s[62:63]
    buffer_load_dwordx4 v8, s[16:19], s52 offen offset:0 lds
    s_mov_b64 exec, -1
    ds_read_b128 v[20:23], v12 offset:9216
    s_waitcnt lgkmcnt(5)
    v_mfma_f32_16x16x32_bf16 a[20:23], v[24:27], v[64:67], a[20:23]
    v_mfma_f32_16x16x32_bf16 a[56:59], v[24:27], v[68:71], a[56:59]
    s_mov_b64 exec, s[62:63]
    buffer_load_dwordx4 v8, s[16:19], s52 offen offset:768 lds
    s_mov_b64 exec, -1
    ds_read_b128 v[24:27], v12 offset:10240
    s_waitcnt lgkmcnt(5)
    v_mfma_f32_16x16x32_bf16 a[24:27], v[28:31], v[64:67], a[24:27]
    v_mfma_f32_16x16x32_bf16 a[60:63], v[28:31], v[68:71], a[60:63]
    s_mov_b64 exec, s[62:63]
    buffer_load_dwordx4 v8, s[16:19], s52 offen offset:1536 lds
    s_mov_b64 exec, -1
    s_add_u32 s52, s52, 587520
    ds_read_b128 v[28:31], v12 offset:11264
    s_waitcnt lgkmcnt(5)
    v_mfma_f32_16x16x32_bf16 a[28:31], v[32:35], v[64:67], a[28:31]
    v_mfma_f32_16x16x32_bf16 a[64:67], v[32:35], v[68:71], a[64:67]
    ds_read_b128 v[32:35], v12 offset:12288
    s_waitcnt lgkmcnt(5)
    v_mfma_f32_16x16x32_bf16 a[32:35], v[36:39], v[64:67], a[32:35]
    v_mfma_f32_16x16x32_bf16 a[68:71], v[36:39], v[68:71], a[68:71]
    ds_read_b128 v[36:39], v12 offset:13312
    s_waitcnt lgkmcnt(5)
    v_mfma_f32_16x16x32_bf16 a[0:3], v[16:19], v[72:75], a[0:3]
    v_mfma_f32_16x16x32_bf16 a[36:39], v[16:19], v[76:79], a[36:39]
    ds_read_b128 v[16:19], v12 offset:14336
    s_waitcnt lgkmcnt(5)
    v_mfma_f32_16x16x32_bf16 a[4:7], v[20:23], v[72:75], a[4:7]
    v_mfma_f32_16x16x32_bf16 a[40:43], v[20:23], v[76:79], a[40:43]
    ds_read_b128 v[20:23], v12 offset:15360
    s_waitcnt lgkmcnt(5)
    v_mfma_f32_16x16x32_bf16 a[8:11], v[24:27], v[72:75], a[8:11]
    v_mfma_f32_16x16x32_bf16 a[44:47], v[24:27], v[76:79], a[44:47]
    ds_read_b128 v[24:27], v12 offset:16384
    s_waitcnt lgkmcnt(5)
    v_mfma_f32_16x16x32_bf16 a[12:15], v[28:31], v[72:75], a[12:15]
    v_mfma_f32_16x16x32_bf16 a[48:51], v[28:31], v[76:79], a[48:51]
    ds_read_b128 v[28:31], v12 offset:26624
    s_waitcnt lgkmcnt(5)
    v_mfma_f32_16x16x32_bf16 a[16:19], v[32:35], v[72:75], a[16:19]
    v_mfma_f32_16x16x32_bf16 a[52:55], v[32:35], v[76:79], a[52:55]
    ds_read_b128 v[32:35], v12 offset:27648
    s_waitcnt lgkmcnt(5)
    v_mfma_f32_16x16x32_bf16 a[20:23], v[36:39], v[72:75], a[20:23]
    v_mfma_f32_16x16x32_bf16 a[56:59], v[36:39], v[76:79], a[56:59]
    s_waitcnt vmcnt(10)
    s_barrier
    ds_read_b128 v[36:39], v12 offset:28672
    s_waitcnt lgkmcnt(5)
    v_mfma_f32_16x16x32_bf16 a[24:27], v[16:19], v[72:75], a[24:27]
    v_mfma_f32_16x16x32_bf16 a[60:63], v[16:19], v[76:79], a[60:63]
    ds_read_b128 v[16:19], v12 offset:29696
    s_waitcnt lgkmcnt(5)
    v_mfma_f32_16x16x32_bf16 a[28:31], v[20:23], v[72:75], a[28:31]
    v_mfma_f32_16x16x32_bf16 a[64:67], v[20:23], v[76:79], a[64:67]
    ds_read_b128 v[20:23], v12 offset:30720
    s_waitcnt lgkmcnt(5)
    v_mfma_f32_16x16x32_bf16 a[32:35], v[24:27], v[72:75], a[32:35]
    v_mfma_f32_16x16x32_bf16 a[68:71], v[24:27], v[76:79], a[68:71]
    ds_read_b128 v[24:27], v12 offset:31744
    s_waitcnt lgkmcnt(5)
    v_mfma_f32_16x16x32_bf16 a[0:3], v[28:31], v[80:83], a[0:3]
    v_mfma_f32_16x16x32_bf16 a[36:39], v[28:31], v[84:87], a[36:39]
    ds_read_b128 v[28:31], v12 offset:32768
    s_waitcnt lgkmcnt(5)
    v_mfma_f32_16x16x32_bf16 a[4:7], v[32:35], v[80:83], a[4:7]
    v_mfma_f32_16x16x32_bf16 a[40:43], v[32:35], v[84:87], a[40:43]
    ds_read_b128 v[32:35], v12 offset:33792
    s_waitcnt lgkmcnt(5)
    v_mfma_f32_16x16x32_bf16 a[8:11], v[36:39], v[80:83], a[8:11]
    v_mfma_f32_16x16x32_bf16 a[44:47], v[36:39], v[84:87], a[44:47]
    ds_read_b128 v[36:39], v12 offset:34816
    s_waitcnt lgkmcnt(5)
    v_mfma_f32_16x16x32_bf16 a[12:15], v[16:19], v[80:83], a[12:15]
    v_mfma_f32_16x16x32_bf16 a[48:51], v[16:19], v[84:87], a[48:51]
    ds_read_b128 v[16:19], v12 offset:45056
    s_waitcnt lgkmcnt(5)
    v_mfma_f32_16x16x32_bf16 a[16:19], v[20:23], v[80:83], a[16:19]
    v_mfma_f32_16x16x32_bf16 a[52:55], v[20:23], v[84:87], a[52:55]
    ds_read_b128 v[20:23], v12 offset:46080
    s_waitcnt lgkmcnt(5)
    v_mfma_f32_16x16x32_bf16 a[20:23], v[24:27], v[80:83], a[20:23]
    v_mfma_f32_16x16x32_bf16 a[56:59], v[24:27], v[84:87], a[56:59]
    ds_read_b128 v[24:27], v12 offset:47104
    s_waitcnt lgkmcnt(5)
    v_mfma_f32_16x16x32_bf16 a[24:27], v[28:31], v[80:83], a[24:27]
    v_mfma_f32_16x16x32_bf16 a[60:63], v[28:31], v[84:87], a[60:63]
    ds_read_b128 v[28:31], v12 offset:48128
    s_waitcnt lgkmcnt(5)
    v_mfma_f32_16x16x32_bf16 a[28:31], v[32:35], v[80:83], a[28:31]
    v_mfma_f32_16x16x32_bf16 a[64:67], v[32:35], v[84:87], a[64:67]
    ds_read_b128 v[32:35], v12 offset:49152
    s_waitcnt lgkmcnt(5)
    v_mfma_f32_16x16x32_bf16 a[32:35], v[36:39], v[80:83], a[32:35]
    v_mfma_f32_16x16x32_bf16 a[68:71], v[36:39], v[84:87], a[68:71]
    ds_read_b128 v[36:39], v12 offset:50176
    s_waitcnt lgkmcnt(5)
    v_mfma_f32_16x16x32_bf16 a[0:3], v[16:19], v[88:91], a[0:3]
    v_mfma_f32_16x16x32_bf16 a[36:39], v[16:19], v[92:95], a[36:39]
    ds_read_b128 v[16:19], v12 offset:51200
    s_waitcnt lgkmcnt(5)
    v_mfma_f32_16x16x32_bf16 a[4:7], v[20:23], v[88:91], a[4:7]
    v_mfma_f32_16x16x32_bf16 a[40:43], v[20:23], v[92:95], a[40:43]
    ds_read_b128 v[20:23], v12 offset:52224
    s_waitcnt lgkmcnt(5)
    v_mfma_f32_16x16x32_bf16 a[8:11], v[24:27], v[88:91], a[8:11]
    v_mfma_f32_16x16x32_bf16 a[44:47], v[24:27], v[92:95], a[44:47]
    ds_read_b128 v[24:27], v12 offset:53248
    s_waitcnt lgkmcnt(5)
    v_mfma_f32_16x16x32_bf16 a[12:15], v[28:31], v[88:91], a[12:15]
    v_mfma_f32_16x16x32_bf16 a[48:51], v[28:31], v[92:95], a[48:51]
    ds_read_b128 v[28:31], v12 offset:63488
    s_waitcnt lgkmcnt(5)
    v_mfma_f32_16x16x32_bf16 a[16:19], v[32:35], v[88:91], a[16:19]
    v_mfma_f32_16x16x32_bf16 a[52:55], v[32:35], v[92:95], a[52:55]
    ds_read_b128 v[32:35], v12 offset:64512
    s_waitcnt lgkmcnt(5)
    v_mfma_f32_16x16x32_bf16 a[20:23], v[36:39], v[88:91], a[20:23]
    v_mfma_f32_16x16x32_bf16 a[56:59], v[36:39], v[92:95], a[56:59]
    s_waitcnt vmcnt(0)
    s_barrier
    ds_read_b128 v[36:39], v13 offset:0
    s_waitcnt lgkmcnt(5)
    v_mfma_f32_16x16x32_bf16 a[24:27], v[16:19], v[88:91], a[24:27]
    v_mfma_f32_16x16x32_bf16 a[60:63], v[16:19], v[92:95], a[60:63]
    ds_read_b128 v[16:19], v13 offset:1024
    s_waitcnt lgkmcnt(5)
    v_mfma_f32_16x16x32_bf16 a[28:31], v[20:23], v[88:91], a[28:31]
    v_mfma_f32_16x16x32_bf16 a[64:67], v[20:23], v[92:95], a[64:67]
    ds_read_b128 v[20:23], v13 offset:2048
    s_waitcnt lgkmcnt(5)
    v_mfma_f32_16x16x32_bf16 a[32:35], v[24:27], v[88:91], a[32:35]
    v_mfma_f32_16x16x32_bf16 a[68:71], v[24:27], v[92:95], a[68:71]
    ds_read_b128 v[24:27], v13 offset:3072
    s_waitcnt lgkmcnt(5)
    v_mfma_f32_16x16x32_bf16 a[0:3], v[28:31], v[96:99], a[0:3]
    v_mfma_f32_16x16x32_bf16 a[36:39], v[28:31], v[100:103], a[36:39]
    ds_read_b128 v[28:31], v13 offset:4096
    s_waitcnt lgkmcnt(5)
    v_mfma_f32_16x16x32_bf16 a[4:7], v[32:35], v[96:99], a[4:7]
    v_mfma_f32_16x16x32_bf16 a[40:43], v[32:35], v[100:103], a[40:43]
    ds_read_b128 v[32:35], v13 offset:5120
    s_waitcnt lgkmcnt(5)
    v_mfma_f32_16x16x32_bf16 a[8:11], v[36:39], v[96:99], a[8:11]
    v_mfma_f32_16x16x32_bf16 a[44:47], v[36:39], v[100:103], a[44:47]
    ds_read_b128 v[36:39], v13 offset:6144
    s_waitcnt lgkmcnt(5)
    v_mfma_f32_16x16x32_bf16 a[12:15], v[16:19], v[96:99], a[12:15]
    v_mfma_f32_16x16x32_bf16 a[48:51], v[16:19], v[100:103], a[48:51]
    ds_read_b128 v[16:19], v11 offset:0
    s_waitcnt lgkmcnt(5)
    v_mfma_f32_16x16x32_bf16 a[16:19], v[20:23], v[96:99], a[16:19]
    v_mfma_f32_16x16x32_bf16 a[52:55], v[20:23], v[100:103], a[52:55]
    ds_read_b128 v[20:23], v11 offset:1024
    s_waitcnt lgkmcnt(5)
    v_mfma_f32_16x16x32_bf16 a[20:23], v[24:27], v[96:99], a[20:23]
    v_mfma_f32_16x16x32_bf16 a[56:59], v[24:27], v[100:103], a[56:59]
    ds_read_b128 v[24:27], v11 offset:2048
    s_waitcnt lgkmcnt(5)
    v_mfma_f32_16x16x32_bf16 a[24:27], v[28:31], v[96:99], a[24:27]
    v_mfma_f32_16x16x32_bf16 a[60:63], v[28:31], v[100:103], a[60:63]
    ds_read_b128 v[28:31], v11 offset:3072
    s_waitcnt lgkmcnt(5)
    v_mfma_f32_16x16x32_bf16 a[28:31], v[32:35], v[96:99], a[28:31]
    v_mfma_f32_16x16x32_bf16 a[64:67], v[32:35], v[100:103], a[64:67]
    ds_read_b128 v[32:35], v11 offset:4096
    s_waitcnt lgkmcnt(5)
    v_mfma_f32_16x16x32_bf16 a[32:35], v[36:39], v[96:99], a[32:35]
    v_mfma_f32_16x16x32_bf16 a[68:71], v[36:39], v[100:103], a[68:71]
    ds_read_b128 v[36:39], v11 offset:5120
    s_waitcnt lgkmcnt(5)
    v_mfma_f32_16x16x32_bf16 a[0:3], v[16:19], v[40:43], a[0:3]
    v_mfma_f32_16x16x32_bf16 a[36:39], v[16:19], v[44:47], a[36:39]
    ds_read_b128 v[16:19], v11 offset:6144
    s_waitcnt lgkmcnt(5)
    v_mfma_f32_16x16x32_bf16 a[4:7], v[20:23], v[40:43], a[4:7]
    v_mfma_f32_16x16x32_bf16 a[40:43], v[20:23], v[44:47], a[40:43]
    ds_read_b128 v[20:23], v11 offset:7168
    s_waitcnt lgkmcnt(5)
    v_mfma_f32_16x16x32_bf16 a[8:11], v[24:27], v[40:43], a[8:11]
    v_mfma_f32_16x16x32_bf16 a[44:47], v[24:27], v[44:47], a[44:47]
    ds_read_b128 v[24:27], v11 offset:8192
    s_waitcnt lgkmcnt(5)
    v_mfma_f32_16x16x32_bf16 a[12:15], v[28:31], v[40:43], a[12:15]
    v_mfma_f32_16x16x32_bf16 a[48:51], v[28:31], v[44:47], a[48:51]
    ds_read_b128 v[28:31], v11 offset:18432
    s_waitcnt lgkmcnt(5)
    v_mfma_f32_16x16x32_bf16 a[16:19], v[32:35], v[40:43], a[16:19]
    v_mfma_f32_16x16x32_bf16 a[52:55], v[32:35], v[44:47], a[52:55]
    ds_read_b128 v[32:35], v11 offset:19456
    s_waitcnt lgkmcnt(5)
    v_mfma_f32_16x16x32_bf16 a[20:23], v[36:39], v[40:43], a[20:23]
    v_mfma_f32_16x16x32_bf16 a[56:59], v[36:39], v[44:47], a[56:59]
    ds_read_b128 v[36:39], v11 offset:20480
    s_waitcnt lgkmcnt(5)
    v_mfma_f32_16x16x32_bf16 a[24:27], v[16:19], v[40:43], a[24:27]
    v_mfma_f32_16x16x32_bf16 a[60:63], v[16:19], v[44:47], a[60:63]
    ds_read_b128 v[16:19], v11 offset:21504
    s_waitcnt lgkmcnt(5)
    v_mfma_f32_16x16x32_bf16 a[28:31], v[20:23], v[40:43], a[28:31]
    v_mfma_f32_16x16x32_bf16 a[64:67], v[20:23], v[44:47], a[64:67]
    ds_read_b128 v[20:23], v11 offset:22528
    s_waitcnt lgkmcnt(5)
    v_mfma_f32_16x16x32_bf16 a[32:35], v[24:27], v[40:43], a[32:35]
    v_mfma_f32_16x16x32_bf16 a[68:71], v[24:27], v[44:47], a[68:71]
    ds_read_b128 v[24:27], v11 offset:23552
    s_waitcnt lgkmcnt(5)
    v_mfma_f32_16x16x32_bf16 a[0:3], v[28:31], v[48:51], a[0:3]
    v_mfma_f32_16x16x32_bf16 a[36:39], v[28:31], v[52:55], a[36:39]
    ds_read_b128 v[28:31], v11 offset:24576
    s_waitcnt lgkmcnt(5)
    v_mfma_f32_16x16x32_bf16 a[4:7], v[32:35], v[48:51], a[4:7]
    v_mfma_f32_16x16x32_bf16 a[40:43], v[32:35], v[52:55], a[40:43]
    ds_read_b128 v[32:35], v11 offset:25600
    s_waitcnt lgkmcnt(5)
    v_mfma_f32_16x16x32_bf16 a[8:11], v[36:39], v[48:51], a[8:11]
    v_mfma_f32_16x16x32_bf16 a[44:47], v[36:39], v[52:55], a[44:47]
    ds_read_b128 v[36:39], v11 offset:26624
    s_waitcnt lgkmcnt(5)
    v_mfma_f32_16x16x32_bf16 a[12:15], v[16:19], v[48:51], a[12:15]
    v_mfma_f32_16x16x32_bf16 a[48:51], v[16:19], v[52:55], a[48:51]
    s_waitcnt lgkmcnt(4)
    v_mfma_f32_16x16x32_bf16 a[16:19], v[20:23], v[48:51], a[16:19]
    v_mfma_f32_16x16x32_bf16 a[52:55], v[20:23], v[52:55], a[52:55]
    s_waitcnt lgkmcnt(3)
    v_mfma_f32_16x16x32_bf16 a[20:23], v[24:27], v[48:51], a[20:23]
    v_mfma_f32_16x16x32_bf16 a[56:59], v[24:27], v[52:55], a[56:59]
    s_waitcnt lgkmcnt(2)
    v_mfma_f32_16x16x32_bf16 a[24:27], v[28:31], v[48:51], a[24:27]
    v_mfma_f32_16x16x32_bf16 a[60:63], v[28:31], v[52:55], a[60:63]
    s_waitcnt lgkmcnt(1)
    v_mfma_f32_16x16x32_bf16 a[28:31], v[32:35], v[48:51], a[28:31]
    v_mfma_f32_16x16x32_bf16 a[64:67], v[32:35], v[52:55], a[64:67]
    s_waitcnt lgkmcnt(0)
    v_mfma_f32_16x16x32_bf16 a[32:35], v[36:39], v[48:51], a[32:35]
    v_mfma_f32_16x16x32_bf16 a[68:71], v[36:39], v[52:55], a[68:71]
    s_add_u32 s20, s4, 0x28d0000
    s_addc_u32 s21, s5, 0
    s_mov_b32 s22, 0x1200000
    s_mov_b32 s23, 0x00020000
    s_mov_b32 s58, 0xc0135761
    s_mov_b32 s59, 0xbdd2d3e8
    v_mov_b32 v7, s58
    s_lshr_b32 s57, s48, 5
    s_mul_i32 s57, s57, 294912
    s_mul_i32 s64, s43, 18432
    s_add_u32 s57, s57, s64
    s_mul_i32 s64, s47, 9216
    s_add_u32 s57, s57, s64
    s_nop 7
    v_accvgpr_read_b32 v16, a0
    v_accvgpr_read_b32 v17, a1
    v_accvgpr_read_b32 v18, a2
    v_accvgpr_read_b32 v19, a3
    v_accvgpr_read_b32 v20, a36
    v_accvgpr_read_b32 v21, a37
    v_accvgpr_read_b32 v22, a38
    v_accvgpr_read_b32 v23, a39
    v_mul_f32 v24, v16, v16
    v_mul_f32 v25, v17, v17
    v_mul_f32 v26, v18, v18
    v_mul_f32 v27, v19, v19
    v_mul_f32 v28, v20, v20
    v_mul_f32 v29, v21, v21
    v_mul_f32 v30, v22, v22
    v_mul_f32 v31, v23, v23
    v_fma_f32 v24, v24, s59, v7
    v_fma_f32 v25, v25, s59, v7
    v_fma_f32 v26, v26, s59, v7
    v_fma_f32 v27, v27, s59, v7
    v_fma_f32 v28, v28, s59, v7
    v_fma_f32 v29, v29, s59, v7
    v_fma_f32 v30, v30, s59, v7
    v_fma_f32 v31, v31, s59, v7
    v_mul_f32 v24, v24, v16
    v_mul_f32 v25, v25, v17
    v_mul_f32 v26, v26, v18
    v_mul_f32 v27, v27, v19
    v_mul_f32 v28, v28, v20
    v_mul_f32 v29, v29, v21
    v_mul_f32 v30, v30, v22
    v_mul_f32 v31, v31, v23
    v_exp_f32 v24, v24
    v_exp_f32 v25, v25
    v_exp_f32 v26, v26
    v_exp_f32 v27, v27
    v_exp_f32 v28, v28
    v_exp_f32 v29, v29
    v_exp_f32 v30, v30
    v_exp_f32 v31, v31
    v_add_f32 v24, 1.0, v24
    v_add_f32 v25, 1.0, v25
    v_add_f32 v26, 1.0, v26
    v_add_f32 v27, 1.0, v27
    v_add_f32 v28, 1.0, v28
    v_add_f32 v29, 1.0, v29
    v_add_f32 v30, 1.0, v30
    v_add_f32 v31, 1.0, v31
    v_rcp_f32 v24, v24
    v_rcp_f32 v25, v25
    v_rcp_f32 v26, v26
    v_rcp_f32 v27, v27
    v_rcp_f32 v28, v28
    v_rcp_f32 v29, v29
    v_rcp_f32 v30, v30
    v_rcp_f32 v31, v31
    v_mul_f32 v16, v16, v24
    v_mul_f32 v17, v17, v25
    v_mul_f32 v18, v18, v26
    v_mul_f32 v19, v19, v27
    v_mul_f32 v20, v20, v28
    v_mul_f32 v21, v21, v29
    v_mul_f32 v22, v22, v30
    v_mul_f32 v23, v23, v31
    v_cvt_pk_bf16_f32 v16, v16, v17
    v_cvt_pk_bf16_f32 v17, v18, v19
    v_cvt_pk_bf16_f32 v18, v20, v21
    v_cvt_pk_bf16_f32 v19, v22, v23
    buffer_store_dwordx4 v[16:19], v8, s[20:23], s57 offen offset:0 sc0 sc1
    v_accvgpr_read_b32 v32, a4
    v_accvgpr_read_b32 v33, a5
    v_accvgpr_read_b32 v34, a6
    v_accvgpr_read_b32 v35, a7
    v_accvgpr_read_b32 v36, a40
    v_accvgpr_read_b32 v37, a41
    v_accvgpr_read_b32 v38, a42
    v_accvgpr_read_b32 v39, a43
    v_mul_f32 v40, v32, v32
    v_mul_f32 v41, v33, v33
    v_mul_f32 v42, v34, v34
    v_mul_f32 v43, v35, v35
    v_mul_f32 v44, v36, v36
    v_mul_f32 v45, v37, v37
    v_mul_f32 v46, v38, v38
    v_mul_f32 v47, v39, v39
    v_fma_f32 v40, v40, s59, v7
    v_fma_f32 v41, v41, s59, v7
    v_fma_f32 v42, v42, s59, v7
    v_fma_f32 v43, v43, s59, v7
    v_fma_f32 v44, v44, s59, v7
    v_fma_f32 v45, v45, s59, v7
    v_fma_f32 v46, v46, s59, v7
    v_fma_f32 v47, v47, s59, v7
    v_mul_f32 v40, v40, v32
    v_mul_f32 v41, v41, v33
    v_mul_f32 v42, v42, v34
    v_mul_f32 v43, v43, v35
    v_mul_f32 v44, v44, v36
    v_mul_f32 v45, v45, v37
    v_mul_f32 v46, v46, v38
    v_mul_f32 v47, v47, v39
    v_exp_f32 v40, v40
    v_exp_f32 v41, v41
    v_exp_f32 v42, v42
    v_exp_f32 v43, v43
    v_exp_f32 v44, v44
    v_exp_f32 v45, v45
    v_exp_f32 v46, v46
    v_exp_f32 v47, v47
    v_add_f32 v40, 1.0, v40
    v_add_f32 v41, 1.0, v41
    v_add_f32 v42, 1.0, v42
    v_add_f32 v43, 1.0, v43
    v_add_f32 v44, 1.0, v44
    v_add_f32 v45, 1.0, v45
    v_add_f32 v46, 1.0, v46
    v_add_f32 v47, 1.0, v47
    v_rcp_f32 v40, v40
    v_rcp_f32 v41, v41
    v_rcp_f32 v42, v42
    v_rcp_f32 v43, v43
    v_rcp_f32 v44, v44
    v_rcp_f32 v45, v45
    v_rcp_f32 v46, v46
    v_rcp_f32 v47, v47
    v_mul_f32 v32, v32, v40
    v_mul_f32 v33, v33, v41
    v_mul_f32 v34, v34, v42
    v_mul_f32 v35, v35, v43
    v_mul_f32 v36, v36, v44
    v_mul_f32 v37, v37, v45
    v_mul_f32 v38, v38, v46
    v_mul_f32 v39, v39, v47
    v_cvt_pk_bf16_f32 v32, v32, v33
    v_cvt_pk_bf16_f32 v33, v34, v35
    v_cvt_pk_bf16_f32 v34, v36, v37
    v_cvt_pk_bf16_f32 v35, v38, v39
    buffer_store_dwordx4 v[32:35], v8, s[20:23], s57 offen offset:1024 sc0 sc1
    v_accvgpr_read_b32 v48, a8
    v_accvgpr_read_b32 v49, a9
    v_accvgpr_read_b32 v50, a10
    v_accvgpr_read_b32 v51, a11
    v_accvgpr_read_b32 v52, a44
    v_accvgpr_read_b32 v53, a45
    v_accvgpr_read_b32 v54, a46
    v_accvgpr_read_b32 v55, a47
    v_mul_f32 v56, v48, v48
    v_mul_f32 v57, v49, v49
    v_mul_f32 v58, v50, v50
    v_mul_f32 v59, v51, v51
    v_mul_f32 v60, v52, v52
    v_mul_f32 v61, v53, v53
    v_mul_f32 v62, v54, v54
    v_mul_f32 v63, v55, v55
    v_fma_f32 v56, v56, s59, v7
    v_fma_f32 v57, v57, s59, v7
    v_fma_f32 v58, v58, s59, v7
    v_fma_f32 v59, v59, s59, v7
    v_fma_f32 v60, v60, s59, v7
    v_fma_f32 v61, v61, s59, v7
    v_fma_f32 v62, v62, s59, v7
    v_fma_f32 v63, v63, s59, v7
    v_mul_f32 v56, v56, v48
    v_mul_f32 v57, v57, v49
    v_mul_f32 v58, v58, v50
    v_mul_f32 v59, v59, v51
    v_mul_f32 v60, v60, v52
    v_mul_f32 v61, v61, v53
    v_mul_f32 v62, v62, v54
    v_mul_f32 v63, v63, v55
    v_exp_f32 v56, v56
    v_exp_f32 v57, v57
    v_exp_f32 v58, v58
    v_exp_f32 v59, v59
    v_exp_f32 v60, v60
    v_exp_f32 v61, v61
    v_exp_f32 v62, v62
    v_exp_f32 v63, v63
    v_add_f32 v56, 1.0, v56
    v_add_f32 v57, 1.0, v57
    v_add_f32 v58, 1.0, v58
    v_add_f32 v59, 1.0, v59
    v_add_f32 v60, 1.0, v60
    v_add_f32 v61, 1.0, v61
    v_add_f32 v62, 1.0, v62
    v_add_f32 v63, 1.0, v63
    v_rcp_f32 v56, v56
    v_rcp_f32 v57, v57
    v_rcp_f32 v58, v58
    v_rcp_f32 v59, v59
    v_rcp_f32 v60, v60
    v_rcp_f32 v61, v61
    v_rcp_f32 v62, v62
    v_rcp_f32 v63, v63
    v_mul_f32 v48, v48, v56
    v_mul_f32 v49, v49, v57
    v_mul_f32 v50, v50, v58
    v_mul_f32 v51, v51, v59
    v_mul_f32 v52, v52, v60
    v_mul_f32 v53, v53, v61
    v_mul_f32 v54, v54, v62
    v_mul_f32 v55, v55, v63
    v_cvt_pk_bf16_f32 v48, v48, v49
    v_cvt_pk_bf16_f32 v49, v50, v51
    v_cvt_pk_bf16_f32 v50, v52, v53
    v_cvt_pk_bf16_f32 v51, v54, v55
    buffer_store_dwordx4 v[48:51], v8, s[20:23], s57 offen offset:2048 sc0 sc1
    v_accvgpr_read_b32 v64, a12
    v_accvgpr_read_b32 v65, a13
    v_accvgpr_read_b32 v66, a14
    v_accvgpr_read_b32 v67, a15
    v_accvgpr_read_b32 v68, a48
    v_accvgpr_read_b32 v69, a49
    v_accvgpr_read_b32 v70, a50
    v_accvgpr_read_b32 v71, a51
    v_mul_f32 v72, v64, v64
    v_mul_f32 v73, v65, v65
    v_mul_f32 v74, v66, v66
    v_mul_f32 v75, v67, v67
    v_mul_f32 v76, v68, v68
    v_mul_f32 v77, v69, v69
    v_mul_f32 v78, v70, v70
    v_mul_f32 v79, v71, v71
    v_fma_f32 v72, v72, s59, v7
    v_fma_f32 v73, v73, s59, v7
    v_fma_f32 v74, v74, s59, v7
    v_fma_f32 v75, v75, s59, v7
    v_fma_f32 v76, v76, s59, v7
    v_fma_f32 v77, v77, s59, v7
    v_fma_f32 v78, v78, s59, v7
    v_fma_f32 v79, v79, s59, v7
    v_mul_f32 v72, v72, v64
    v_mul_f32 v73, v73, v65
    v_mul_f32 v74, v74, v66
    v_mul_f32 v75, v75, v67
    v_mul_f32 v76, v76, v68
    v_mul_f32 v77, v77, v69
    v_mul_f32 v78, v78, v70
    v_mul_f32 v79, v79, v71
    v_exp_f32 v72, v72
    v_exp_f32 v73, v73
    v_exp_f32 v74, v74
    v_exp_f32 v75, v75
    v_exp_f32 v76, v76
    v_exp_f32 v77, v77
    v_exp_f32 v78, v78
    v_exp_f32 v79, v79
    v_add_f32 v72, 1.0, v72
    v_add_f32 v73, 1.0, v73
    v_add_f32 v74, 1.0, v74
    v_add_f32 v75, 1.0, v75
    v_add_f32 v76, 1.0, v76
    v_add_f32 v77, 1.0, v77
    v_add_f32 v78, 1.0, v78
    v_add_f32 v79, 1.0, v79
    v_rcp_f32 v72, v72
    v_rcp_f32 v73, v73
    v_rcp_f32 v74, v74
    v_rcp_f32 v75, v75
    v_rcp_f32 v76, v76
    v_rcp_f32 v77, v77
    v_rcp_f32 v78, v78
    v_rcp_f32 v79, v79
    v_mul_f32 v64, v64, v72
    v_mul_f32 v65, v65, v73
    v_mul_f32 v66, v66, v74
    v_mul_f32 v67, v67, v75
    v_mul_f32 v68, v68, v76
    v_mul_f32 v69, v69, v77
    v_mul_f32 v70, v70, v78
    v_mul_f32 v71, v71, v79
    v_cvt_pk_bf16_f32 v64, v64, v65
    v_cvt_pk_bf16_f32 v65, v66, v67
    v_cvt_pk_bf16_f32 v66, v68, v69
    v_cvt_pk_bf16_f32 v67, v70, v71
    buffer_store_dwordx4 v[64:67], v8, s[20:23], s57 offen offset:3072 sc0 sc1
    v_accvgpr_read_b32 v16, a16
    v_accvgpr_read_b32 v17, a17
    v_accvgpr_read_b32 v18, a18
    v_accvgpr_read_b32 v19, a19
    v_accvgpr_read_b32 v20, a52
    v_accvgpr_read_b32 v21, a53
    v_accvgpr_read_b32 v22, a54
    v_accvgpr_read_b32 v23, a55
    v_mul_f32 v24, v16, v16
    v_mul_f32 v25, v17, v17
    v_mul_f32 v26, v18, v18
    v_mul_f32 v27, v19, v19
    v_mul_f32 v28, v20, v20
    v_mul_f32 v29, v21, v21
    v_mul_f32 v30, v22, v22
    v_mul_f32 v31, v23, v23
    v_fma_f32 v24, v24, s59, v7
    v_fma_f32 v25, v25, s59, v7
    v_fma_f32 v26, v26, s59, v7
    v_fma_f32 v27, v27, s59, v7
    v_fma_f32 v28, v28, s59, v7
    v_fma_f32 v29, v29, s59, v7
    v_fma_f32 v30, v30, s59, v7
    v_fma_f32 v31, v31, s59, v7
    v_mul_f32 v24, v24, v16
    v_mul_f32 v25, v25, v17
    v_mul_f32 v26, v26, v18
    v_mul_f32 v27, v27, v19
    v_mul_f32 v28, v28, v20
    v_mul_f32 v29, v29, v21
    v_mul_f32 v30, v30, v22
    v_mul_f32 v31, v31, v23
    v_exp_f32 v24, v24
    v_exp_f32 v25, v25
    v_exp_f32 v26, v26
    v_exp_f32 v27, v27
    v_exp_f32 v28, v28
    v_exp_f32 v29, v29
    v_exp_f32 v30, v30
    v_exp_f32 v31, v31
    v_add_f32 v24, 1.0, v24
    v_add_f32 v25, 1.0, v25
    v_add_f32 v26, 1.0, v26
    v_add_f32 v27, 1.0, v27
    v_add_f32 v28, 1.0, v28
    v_add_f32 v29, 1.0, v29
    v_add_f32 v30, 1.0, v30
    v_add_f32 v31, 1.0, v31
    v_rcp_f32 v24, v24
    v_rcp_f32 v25, v25
    v_rcp_f32 v26, v26
    v_rcp_f32 v27, v27
    v_rcp_f32 v28, v28
    v_rcp_f32 v29, v29
    v_rcp_f32 v30, v30
    v_rcp_f32 v31, v31
    v_mul_f32 v16, v16, v24
    v_mul_f32 v17, v17, v25
    v_mul_f32 v18, v18, v26
    v_mul_f32 v19, v19, v27
    v_mul_f32 v20, v20, v28
    v_mul_f32 v21, v21, v29
    v_mul_f32 v22, v22, v30
    v_mul_f32 v23, v23, v31
    v_cvt_pk_bf16_f32 v16, v16, v17
    v_cvt_pk_bf16_f32 v17, v18, v19
    v_cvt_pk_bf16_f32 v18, v20, v21
    v_cvt_pk_bf16_f32 v19, v22, v23
    s_add_u32 s57, s57, 4096
    buffer_store_dwordx4 v[16:19], v8, s[20:23], s57 offen offset:0 sc0 sc1
    v_accvgpr_read_b32 v32, a20
    v_accvgpr_read_b32 v33, a21
    v_accvgpr_read_b32 v34, a22
    v_accvgpr_read_b32 v35, a23
    v_accvgpr_read_b32 v36, a56
    v_accvgpr_read_b32 v37, a57
    v_accvgpr_read_b32 v38, a58
    v_accvgpr_read_b32 v39, a59
    v_mul_f32 v40, v32, v32
    v_mul_f32 v41, v33, v33
    v_mul_f32 v42, v34, v34
    v_mul_f32 v43, v35, v35
    v_mul_f32 v44, v36, v36
    v_mul_f32 v45, v37, v37
    v_mul_f32 v46, v38, v38
    v_mul_f32 v47, v39, v39
    v_fma_f32 v40, v40, s59, v7
    v_fma_f32 v41, v41, s59, v7
    v_fma_f32 v42, v42, s59, v7
    v_fma_f32 v43, v43, s59, v7
    v_fma_f32 v44, v44, s59, v7
    v_fma_f32 v45, v45, s59, v7
    v_fma_f32 v46, v46, s59, v7
    v_fma_f32 v47, v47, s59, v7
    v_mul_f32 v40, v40, v32
    v_mul_f32 v41, v41, v33
    v_mul_f32 v42, v42, v34
    v_mul_f32 v43, v43, v35
    v_mul_f32 v44, v44, v36
    v_mul_f32 v45, v45, v37
    v_mul_f32 v46, v46, v38
    v_mul_f32 v47, v47, v39
    v_exp_f32 v40, v40
    v_exp_f32 v41, v41
    v_exp_f32 v42, v42
    v_exp_f32 v43, v43
    v_exp_f32 v44, v44
    v_exp_f32 v45, v45
    v_exp_f32 v46, v46
    v_exp_f32 v47, v47
    v_add_f32 v40, 1.0, v40
    v_add_f32 v41, 1.0, v41
    v_add_f32 v42, 1.0, v42
    v_add_f32 v43, 1.0, v43
    v_add_f32 v44, 1.0, v44
    v_add_f32 v45, 1.0, v45
    v_add_f32 v46, 1.0, v46
    v_add_f32 v47, 1.0, v47
    v_rcp_f32 v40, v40
    v_rcp_f32 v41, v41
    v_rcp_f32 v42, v42
    v_rcp_f32 v43, v43
    v_rcp_f32 v44, v44
    v_rcp_f32 v45, v45
    v_rcp_f32 v46, v46
    v_rcp_f32 v47, v47
    v_mul_f32 v32, v32, v40
    v_mul_f32 v33, v33, v41
    v_mul_f32 v34, v34, v42
    v_mul_f32 v35, v35, v43
    v_mul_f32 v36, v36, v44
    v_mul_f32 v37, v37, v45
    v_mul_f32 v38, v38, v46
    v_mul_f32 v39, v39, v47
    v_cvt_pk_bf16_f32 v32, v32, v33
    v_cvt_pk_bf16_f32 v33, v34, v35
    v_cvt_pk_bf16_f32 v34, v36, v37
    v_cvt_pk_bf16_f32 v35, v38, v39
    buffer_store_dwordx4 v[32:35], v8, s[20:23], s57 offen offset:1024 sc0 sc1
    v_accvgpr_read_b32 v48, a24
    v_accvgpr_read_b32 v49, a25
    v_accvgpr_read_b32 v50, a26
    v_accvgpr_read_b32 v51, a27
    v_accvgpr_read_b32 v52, a60
    v_accvgpr_read_b32 v53, a61
    v_accvgpr_read_b32 v54, a62
    v_accvgpr_read_b32 v55, a63
    v_mul_f32 v56, v48, v48
    v_mul_f32 v57, v49, v49
    v_mul_f32 v58, v50, v50
    v_mul_f32 v59, v51, v51
    v_mul_f32 v60, v52, v52
    v_mul_f32 v61, v53, v53
    v_mul_f32 v62, v54, v54
    v_mul_f32 v63, v55, v55
    v_fma_f32 v56, v56, s59, v7
    v_fma_f32 v57, v57, s59, v7
    v_fma_f32 v58, v58, s59, v7
    v_fma_f32 v59, v59, s59, v7
    v_fma_f32 v60, v60, s59, v7
    v_fma_f32 v61, v61, s59, v7
    v_fma_f32 v62, v62, s59, v7
    v_fma_f32 v63, v63, s59, v7
    v_mul_f32 v56, v56, v48
    v_mul_f32 v57, v57, v49
    v_mul_f32 v58, v58, v50
    v_mul_f32 v59, v59, v51
    v_mul_f32 v60, v60, v52
    v_mul_f32 v61, v61, v53
    v_mul_f32 v62, v62, v54
    v_mul_f32 v63, v63, v55
    v_exp_f32 v56, v56
    v_exp_f32 v57, v57
    v_exp_f32 v58, v58
    v_exp_f32 v59, v59
    v_exp_f32 v60, v60
    v_exp_f32 v61, v61
    v_exp_f32 v62, v62
    v_exp_f32 v63, v63
    v_add_f32 v56, 1.0, v56
    v_add_f32 v57, 1.0, v57
    v_add_f32 v58, 1.0, v58
    v_add_f32 v59, 1.0, v59
    v_add_f32 v60, 1.0, v60
    v_add_f32 v61, 1.0, v61
    v_add_f32 v62, 1.0, v62
    v_add_f32 v63, 1.0, v63
    v_rcp_f32 v56, v56
    v_rcp_f32 v57, v57
    v_rcp_f32 v58, v58
    v_rcp_f32 v59, v59
    v_rcp_f32 v60, v60
    v_rcp_f32 v61, v61
    v_rcp_f32 v62, v62
    v_rcp_f32 v63, v63
    v_mul_f32 v48, v48, v56
    v_mul_f32 v49, v49, v57
    v_mul_f32 v50, v50, v58
    v_mul_f32 v51, v51, v59
    v_mul_f32 v52, v52, v60
    v_mul_f32 v53, v53, v61
    v_mul_f32 v54, v54, v62
    v_mul_f32 v55, v55, v63
    v_cvt_pk_bf16_f32 v48, v48, v49
    v_cvt_pk_bf16_f32 v49, v50, v51
    v_cvt_pk_bf16_f32 v50, v52, v53
    v_cvt_pk_bf16_f32 v51, v54, v55
    buffer_store_dwordx4 v[48:51], v8, s[20:23], s57 offen offset:2048 sc0 sc1
    v_accvgpr_read_b32 v64, a28
    v_accvgpr_read_b32 v65, a29
    v_accvgpr_read_b32 v66, a30
    v_accvgpr_read_b32 v67, a31
    v_accvgpr_read_b32 v68, a64
    v_accvgpr_read_b32 v69, a65
    v_accvgpr_read_b32 v70, a66
    v_accvgpr_read_b32 v71, a67
    v_mul_f32 v72, v64, v64
    v_mul_f32 v73, v65, v65
    v_mul_f32 v74, v66, v66
    v_mul_f32 v75, v67, v67
    v_mul_f32 v76, v68, v68
    v_mul_f32 v77, v69, v69
    v_mul_f32 v78, v70, v70
    v_mul_f32 v79, v71, v71
    v_fma_f32 v72, v72, s59, v7
    v_fma_f32 v73, v73, s59, v7
    v_fma_f32 v74, v74, s59, v7
    v_fma_f32 v75, v75, s59, v7
    v_fma_f32 v76, v76, s59, v7
    v_fma_f32 v77, v77, s59, v7
    v_fma_f32 v78, v78, s59, v7
    v_fma_f32 v79, v79, s59, v7
    v_mul_f32 v72, v72, v64
    v_mul_f32 v73, v73, v65
    v_mul_f32 v74, v74, v66
    v_mul_f32 v75, v75, v67
    v_mul_f32 v76, v76, v68
    v_mul_f32 v77, v77, v69
    v_mul_f32 v78, v78, v70
    v_mul_f32 v79, v79, v71
    v_exp_f32 v72, v72
    v_exp_f32 v73, v73
    v_exp_f32 v74, v74
    v_exp_f32 v75, v75
    v_exp_f32 v76, v76
    v_exp_f32 v77, v77
    v_exp_f32 v78, v78
    v_exp_f32 v79, v79
    v_add_f32 v72, 1.0, v72
    v_add_f32 v73, 1.0, v73
    v_add_f32 v74, 1.0, v74
    v_add_f32 v75, 1.0, v75
    v_add_f32 v76, 1.0, v76
    v_add_f32 v77, 1.0, v77
    v_add_f32 v78, 1.0, v78
    v_add_f32 v79, 1.0, v79
    v_rcp_f32 v72, v72
    v_rcp_f32 v73, v73
    v_rcp_f32 v74, v74
    v_rcp_f32 v75, v75
    v_rcp_f32 v76, v76
    v_rcp_f32 v77, v77
    v_rcp_f32 v78, v78
    v_rcp_f32 v79, v79
    v_mul_f32 v64, v64, v72
    v_mul_f32 v65, v65, v73
    v_mul_f32 v66, v66, v74
    v_mul_f32 v67, v67, v75
    v_mul_f32 v68, v68, v76
    v_mul_f32 v69, v69, v77
    v_mul_f32 v70, v70, v78
    v_mul_f32 v71, v71, v79
    v_cvt_pk_bf16_f32 v64, v64, v65
    v_cvt_pk_bf16_f32 v65, v66, v67
    v_cvt_pk_bf16_f32 v66, v68, v69
    v_cvt_pk_bf16_f32 v67, v70, v71
    buffer_store_dwordx4 v[64:67], v8, s[20:23], s57 offen offset:3072 sc0 sc1
    v_accvgpr_read_b32 v16, a32
    v_accvgpr_read_b32 v17, a33
    v_accvgpr_read_b32 v18, a34
    v_accvgpr_read_b32 v19, a35
    v_accvgpr_read_b32 v20, a68
    v_accvgpr_read_b32 v21, a69
    v_accvgpr_read_b32 v22, a70
    v_accvgpr_read_b32 v23, a71
    v_mul_f32 v24, v16, v16
    v_mul_f32 v25, v17, v17
    v_mul_f32 v26, v18, v18
    v_mul_f32 v27, v19, v19
    v_mul_f32 v28, v20, v20
    v_mul_f32 v29, v21, v21
    v_mul_f32 v30, v22, v22
    v_mul_f32 v31, v23, v23
    v_fma_f32 v24, v24, s59, v7
    v_fma_f32 v25, v25, s59, v7
    v_fma_f32 v26, v26, s59, v7
    v_fma_f32 v27, v27, s59, v7
    v_fma_f32 v28, v28, s59, v7
    v_fma_f32 v29, v29, s59, v7
    v_fma_f32 v30, v30, s59, v7
    v_fma_f32 v31, v31, s59, v7
    v_mul_f32 v24, v24, v16
    v_mul_f32 v25, v25, v17
    v_mul_f32 v26, v26, v18
    v_mul_f32 v27, v27, v19
    v_mul_f32 v28, v28, v20
    v_mul_f32 v29, v29, v21
    v_mul_f32 v30, v30, v22
    v_mul_f32 v31, v31, v23
    v_exp_f32 v24, v24
    v_exp_f32 v25, v25
    v_exp_f32 v26, v26
    v_exp_f32 v27, v27
    v_exp_f32 v28, v28
    v_exp_f32 v29, v29
    v_exp_f32 v30, v30
    v_exp_f32 v31, v31
    v_add_f32 v24, 1.0, v24
    v_add_f32 v25, 1.0, v25
    v_add_f32 v26, 1.0, v26
    v_add_f32 v27, 1.0, v27
    v_add_f32 v28, 1.0, v28
    v_add_f32 v29, 1.0, v29
    v_add_f32 v30, 1.0, v30
    v_add_f32 v31, 1.0, v31
    v_rcp_f32 v24, v24
    v_rcp_f32 v25, v25
    v_rcp_f32 v26, v26
    v_rcp_f32 v27, v27
    v_rcp_f32 v28, v28
    v_rcp_f32 v29, v29
    v_rcp_f32 v30, v30
    v_rcp_f32 v31, v31
    v_mul_f32 v16, v16, v24
    v_mul_f32 v17, v17, v25
    v_mul_f32 v18, v18, v26
    v_mul_f32 v19, v19, v27
    v_mul_f32 v20, v20, v28
    v_mul_f32 v21, v21, v29
    v_mul_f32 v22, v22, v30
    v_mul_f32 v23, v23, v31
    v_cvt_pk_bf16_f32 v16, v16, v17
    v_cvt_pk_bf16_f32 v17, v18, v19
    v_cvt_pk_bf16_f32 v18, v20, v21
    v_cvt_pk_bf16_f32 v19, v22, v23
    s_add_u32 s57, s57, 4096
    buffer_store_dwordx4 v[16:19], v8, s[20:23], s57 offen offset:0 sc0 sc1
g3_kernel_done1:
    s_endpgm
.globl lnz_kernel
.type lnz_kernel,@function
.p2align 8
lnz_kernel:
    s_cmp_ge_u32 s2, 256
    s_cbranch_scc1 lnz_kernel_done1
    s_load_dwordx2 s[4:5], s[0:1], 112
    v_lshrrev_b32 v1, 6, v0
    v_and_b32 v2, 63, v0
    v_readfirstlane_b32 s22, v1
    v_and_b32 v4, 3, v2
    v_bfe_u32 v5, v2, 2, 2
    v_lshrrev_b32 v1, 4, v2
    v_lshlrev_b32 v3, 4, v4
    v_lshl_add_u32 v3, v5, 8, v3
    v_lshl_add_u32 v3, v1, 10, v3
    s_lshr_b32 s25, s2, 2
    s_and_b32 s26, s2, 3
    s_mul_i32 s20, s25, 294912
    s_mul_i32 s21, s22, 12288
    s_add_u32 s20, s20, s21
    s_lshl_b32 s27, s26, 6
    s_add_u32 s20, s20, s27
    s_add_u32 s20, s20, 147456
    s_add_u32 s28, s20, 4096
    s_add_u32 s29, s20, 8192
    s_mul_i32 s24, s25, 147456
    s_add_u32 s24, s24, s21
    s_lshl_b32 s27, s26, 8
    s_add_u32 s24, s24, s27
    s_waitcnt lgkmcnt(0)
    s_add_u32 s12, s4, 0x28d0000
    s_addc_u32 s13, s5, 0
    s_mov_b32 s14, 0x1200000
    s_mov_b32 s15, 0x00020000
    s_add_u32 s16, s4, 0x3ad0000
    s_addc_u32 s17, s5, 0
    s_mov_b32 s18, 0x900000
    s_mov_b32 s19, 0x00020000
    buffer_load_dwordx4 v[16:19], v3, s[12:15], s20 offen
    buffer_load_dwordx4 v[20:23], v3, s[12:15], s28 offen
    buffer_load_dwordx4 v[24:27], v3, s[12:15], s29 offen
    s_waitcnt vmcnt(0)
    v_lshlrev_b32 v28, 16, v16
    v_and_b32 v29, 0xffff0000, v16
    v_lshlrev_b32 v30, 16, v17
    v_and_b32 v31, 0xffff0000, v17
    v_lshlrev_b32 v40, 16, v18
    v_and_b32 v41, 0xffff0000, v18
    v_lshlrev_b32 v42, 16, v19
    v_and_b32 v43, 0xffff0000, v19
    v_lshlrev_b32 v32, 16, v20
    v_and_b32 v33, 0xffff0000, v20
    v_lshlrev_b32 v34, 16, v21
    v_and_b32 v35, 0xffff0000, v21
    v_lshlrev_b32 v44, 16, v22
    v_and_b32 v45, 0xffff0000, v22
    v_lshlrev_b32 v46, 16, v23
    v_and_b32 v47, 0xffff0000, v23
    v_lshlrev_b32 v36, 16, v24
    v_and_b32 v37, 0xffff0000, v24
    v_lshlrev_b32 v38, 16, v25
    v_and_b32 v39, 0xffff0000, v25
    v_lshlrev_b32 v48, 16, v26
    v_and_b32 v49, 0xffff0000, v26
    v_lshlrev_b32 v50, 16, v27
    v_and_b32 v51, 0xffff0000, v27
    v_add_f32 v8, v28, v29
    v_add_f32 v8, v8, v30
    v_add_f32 v8, v8, v31
    v_add_f32 v8, v8, v32
    v_add_f32 v8, v8, v33
    v_add_f32 v8, v8, v34
    v_add_f32 v8, v8, v35
    v_add_f32 v8, v8, v36
    v_add_f32 v8, v8, v37
    v_add_f32 v8, v8, v38
    v_add_f32 v8, v8, v39
    v_add_f32 v9, v40, v41
    v_add_f32 v9, v9, v42
    v_add_f32 v9, v9, v43
    v_add_f32 v9, v9, v44
    v_add_f32 v9, v9, v45
    v_add_f32 v9, v9, v46
    v_add_f32 v9, v9, v47
    v_add_f32 v9, v9, v48
    v_add_f32 v9, v9, v49
    v_add_f32 v9, v9, v50
    v_add_f32 v9, v9, v51
    v_add_f32_dpp v8, v8, v8 row_ror:4 row_mask:0xf bank_mask:0xf
    s_nop 0
    v_add_f32_dpp v9, v9, v9 row_ror:4 row_mask:0xf bank_mask:0xf
    v_add_f32_dpp v8, v8, v8 row_ror:8 row_mask:0xf bank_mask:0xf
    s_nop 0
    v_add_f32_dpp v9, v9, v9 row_ror:8 row_mask:0xf bank_mask:0xf
    v_lshlrev_b32 v6, 9, v4
    v_lshl_add_u32 v6, v1, 3, v6
    s_lshl_b32 s23, s22, 5
    v_add_u32 v6, s23, v6
    ds_write_b64 v6, v[8:9] offset:0
    s_waitcnt lgkmcnt(0)
    s_barrier
    v_lshl_add_u32 v7, v1, 2, v5
    v_mul_u32_u24 v7, 24, v7
    v_lshl_add_u32 v7, v4, 9, v7
    ds_read_b64 v[16:17], v7 offset:0
    ds_read_b64 v[18:19], v7 offset:8
    ds_read_b64 v[20:21], v7 offset:16
    s_waitcnt lgkmcnt(0)
    v_add_f32 v8, v16, v18
    v_add_f32 v8, v8, v20
    v_add_f32 v9, v17, v19
    v_add_f32 v9, v9, v21
    v_add_f32_dpp v8, v8, v8 row_ror:4 row_mask:0xf bank_mask:0xf
    s_nop 0
    v_add_f32_dpp v9, v9, v9 row_ror:4 row_mask:0xf bank_mask:0xf
    v_add_f32_dpp v8, v8, v8 row_ror:8 row_mask:0xf bank_mask:0xf
    s_nop 0
    v_add_f32_dpp v9, v9, v9 row_ror:8 row_mask:0xf bank_mask:0xf
    ds_swizzle_b32 v6, v8 offset:0x401F
    ds_swizzle_b32 v7, v9 offset:0x401F
    s_waitcnt lgkmcnt(0)
    v_add_f32 v8, v8, v6
    v_add_f32 v9, v9, v7
    v_mov_b32 v6, v8
    s_nop 1
    v_permlane32_swap_b32 v6, v8
    v_add_f32 v8, v8, v6
    v_mov_b32 v6, v9
    s_nop 1
    v_permlane32_swap_b32 v6, v9
    v_add_f32 v9, v9, v6
    v_mul_f32 v8, 0x39e38e39, v8
    v_mov_b32 v10, 0
    v_sub_f32 v28, v28, v8
    v_fmac_f32 v10, v28, v28
    v_sub_f32 v29, v29, v8
    v_fmac_f32 v10, v29, v29
    v_sub_f32 v30, v30, v8
    v_fmac_f32 v10, v30, v30
    v_sub_f32 v31, v31, v8
    v_fmac_f32 v10, v31, v31
    v_sub_f32 v32, v32, v8
    v_fmac_f32 v10, v32, v32
    v_sub_f32 v33, v33, v8
    v_fmac_f32 v10, v33, v33
    v_sub_f32 v34, v34, v8
    v_fmac_f32 v10, v34, v34
    v_sub_f32 v35, v35, v8
    v_fmac_f32 v10, v35, v35
    v_sub_f32 v36, v36, v8
    v_fmac_f32 v10, v36, v36
    v_sub_f32 v37, v37, v8
    v_fmac_f32 v10, v37, v37
    v_sub_f32 v38, v38, v8
    v_fmac_f32 v10, v38, v38
    v_sub_f32 v39, v39, v8
    v_fmac_f32 v10, v39, v39
    v_mul_f32 v9, 0x39e38e39, v9
    v_mov_b32 v11, 0
    v_sub_f32 v40, v40, v9
    v_fmac_f32 v11, v40, v40
    v_sub_f32 v41, v41, v9
    v_fmac_f32 v11, v41, v41
    v_sub_f32 v42, v42, v9
    v_fmac_f32 v11, v42, v42
    v_sub_f32 v43, v43, v9
    v_fmac_f32 v11, v43, v43
    v_sub_f32 v44, v44, v9
    v_fmac_f32 v11, v44, v44
    v_sub_f32 v45, v45, v9
    v_fmac_f32 v11, v45, v45
    v_sub_f32 v46, v46, v9
    v_fmac_f32 v11, v46, v46
    v_sub_f32 v47, v47, v9
    v_fmac_f32 v11, v47, v47
    v_sub_f32 v48, v48, v9
    v_fmac_f32 v11, v48, v48
    v_sub_f32 v49, v49, v9
    v_fmac_f32 v11, v49, v49
    v_sub_f32 v50, v50, v9
    v_fmac_f32 v11, v50, v50
    v_sub_f32 v51, v51, v9
    v_fmac_f32 v11, v51, v51
    v_add_f32_dpp v10, v10, v10 row_ror:4 row_mask:0xf bank_mask:0xf
    s_nop 0
    v_add_f32_dpp v11, v11, v11 row_ror:4 row_mask:0xf bank_mask:0xf
    v_add_f32_dpp v10, v10, v10 row_ror:8 row_mask:0xf bank_mask:0xf
    s_nop 0
    v_add_f32_dpp v11, v11, v11 row_ror:8 row_mask:0xf bank_mask:0xf
    v_lshlrev_b32 v6, 9, v4
    v_lshl_add_u32 v6, v1, 3, v6
    s_lshl_b32 s23, s22, 5
    v_add_u32 v6, s23, v6
    ds_write_b64 v6, v[10:11] offset:2048
    s_waitcnt lgkmcnt(0)
    s_barrier
    v_lshl_add_u32 v7, v1, 2, v5
    v_mul_u32_u24 v7, 24, v7
    v_lshl_add_u32 v7, v4, 9, v7
    ds_read_b64 v[16:17], v7 offset:2048
    ds_read_b64 v[18:19], v7 offset:2056
    ds_read_b64 v[20:21], v7 offset:2064
    s_waitcnt lgkmcnt(0)
    v_add_f32 v10, v16, v18
    v_add_f32 v10, v10, v20
    v_add_f32 v11, v17, v19
    v_add_f32 v11, v11, v21
    v_add_f32_dpp v10, v10, v10 row_ror:4 row_mask:0xf bank_mask:0xf
    s_nop 0
    v_add_f32_dpp v11, v11, v11 row_ror:4 row_mask:0xf bank_mask:0xf
    v_add_f32_dpp v10, v10, v10 row_ror:8 row_mask:0xf bank_mask:0xf
    s_nop 0
    v_add_f32_dpp v11, v11, v11 row_ror:8 row_mask:0xf bank_mask:0xf
    ds_swizzle_b32 v6, v10 offset:0x401F
    ds_swizzle_b32 v7, v11 offset:0x401F
    s_waitcnt lgkmcnt(0)
    v_add_f32 v10, v10, v6
    v_add_f32 v11, v11, v7
    v_mov_b32 v6, v10
    s_nop 1
    v_permlane32_swap_b32 v6, v10
    v_add_f32 v10, v10, v6
    v_mov_b32 v6, v11
    s_nop 1
    v_permlane32_swap_b32 v6, v11
    v_add_f32 v11, v11, v6
    v_mov_b32 v12, 0x3727c5ac
    v_fmac_f32 v12, 0x39e38e39, v10
    v_rsq_f32 v14, v12
    s_nop 0
    v_mul_f32 v6, v12, v14
    v_fma_f32 v6, -v6, v14, 1.0
    v_mul_f32 v7, 0.5, v14
    v_fmac_f32 v14, v6, v7
    v_mov_b32 v13, 0x3727c5ac
    v_fmac_f32 v13, 0x39e38e39, v11
    v_rsq_f32 v15, v13
    s_nop 0
    v_mul_f32 v6, v13, v15
    v_fma_f32 v6, -v6, v15, 1.0
    v_mul_f32 v7, 0.5, v15
    v_fmac_f32 v15, v6, v7
    s_mul_i32 s23, s22, 384
    s_add_u32 s23, s23, 4096
    v_mul_u32_u24 v7, 4672, v4
    v_lshl_add_u32 v7, v5, 3, v7
    v_lshl_add_u32 v7, v1, 5, v7
    v_add_u32 v7, s23, v7
    v_mul_f32 v28, v28, v14
    v_mul_f32 v29, v29, v14
    v_mul_f32 v30, v30, v14
    v_mul_f32 v31, v31, v14
    v_cvt_pk_bf16_f32 v28, v28, v29
    v_cvt_pk_bf16_f32 v29, v30, v31
    ds_write_b64 v7, v[28:29] offset:0
    v_mul_f32 v32, v32, v14
    v_mul_f32 v33, v33, v14
    v_mul_f32 v34, v34, v14
    v_mul_f32 v35, v35, v14
    v_cvt_pk_bf16_f32 v32, v32, v33
    v_cvt_pk_bf16_f32 v33, v34, v35
    ds_write_b64 v7, v[32:33] offset:128
    v_mul_f32 v36, v36, v14
    v_mul_f32 v37, v37, v14
    v_mul_f32 v38, v38, v14
    v_mul_f32 v39, v39, v14
    v_cvt_pk_bf16_f32 v36, v36, v37
    v_cvt_pk_bf16_f32 v37, v38, v39
    ds_write_b64 v7, v[36:37] offset:256
    v_mul_f32 v40, v40, v15
    v_mul_f32 v41, v41, v15
    v_mul_f32 v42, v42, v15
    v_mul_f32 v43, v43, v15
    v_cvt_pk_bf16_f32 v40, v40, v41
    v_cvt_pk_bf16_f32 v41, v42, v43
    ds_write_b64 v7, v[40:41] offset:18688
    v_mul_f32 v44, v44, v15
    v_mul_f32 v45, v45, v15
    v_mul_f32 v46, v46, v15
    v_mul_f32 v47, v47, v15
    v_cvt_pk_bf16_f32 v44, v44, v45
    v_cvt_pk_bf16_f32 v45, v46, v47
    ds_write_b64 v7, v[44:45] offset:18816
    v_mul_f32 v48, v48, v15
    v_mul_f32 v49, v49, v15
    v_mul_f32 v50, v50, v15
    v_mul_f32 v51, v51, v15
    v_cvt_pk_bf16_f32 v48, v48, v49
    v_cvt_pk_bf16_f32 v49, v50, v51
    ds_write_b64 v7, v[48:49] offset:18944
    v_mul_u32_u24 v6, 4672, v5
    v_lshl_add_u32 v6, v4, 3, v6
    v_lshl_add_u32 v6, v1, 5, v6
    v_add_u32 v6, s23, v6
    v_and_b32 v3, 15, v2
    v_lshlrev_b32 v3, 4, v3
    v_lshl_add_u32 v3, v1, 10, v3
    s_waitcnt lgkmcnt(0)
    ds_read_b64_tr_b16 v[16:17], v6 offset:0
    ds_read_b64_tr_b16 v[18:19], v6 offset:18688
    ds_read_b64_tr_b16 v[20:21], v6 offset:128
    ds_read_b64_tr_b16 v[22:23], v6 offset:18816
    ds_read_b64_tr_b16 v[24:25], v6 offset:256
    ds_read_b64_tr_b16 v[26:27], v6 offset:18944
    s_waitcnt lgkmcnt(0)
    buffer_store_dwordx4 v[16:19], v3, s[16:19], s24 offen sc0 sc1
    s_add_u32 s24, s24, 4096
    buffer_store_dwordx4 v[20:23], v3, s[16:19], s24 offen sc0 sc1
    s_add_u32 s24, s24, 4096
    buffer_store_dwordx4 v[24:27], v3, s[16:19], s24 offen sc0 sc1
    s_add_u32 s24, s24, 4096
lnz_kernel_done1:
    s_endpgm
.globl g4_kernel
.type g4_kernel,@function
.p2align 8
g4_kernel:
    s_cmp_ge_u32 s2, 256
    s_cbranch_scc1 g4_kernel_done1
    s_load_dwordx2 s[4:5], s[0:1], 112
    s_load_dwordx2 s[6:7], s[0:1], 64
    s_and_b32 s40, s2, 7
    s_lshr_b32 s41, s2, 3
    s_lshr_b32 s42, s40, 1
    s_lshl_b32 s42, s42, 2
    s_and_b32 s43, s41, 3
    s_add_u32 s42, s42, s43
    s_and_b32 s43, s40, 1
    s_lshl_b32 s43, s43, 3
    s_lshr_b32 s44, s41, 2
    s_add_u32 s43, s43, s44
    s_mov_b32 s44, 0
    v_lshrrev_b32 v1, 6, v0
    v_and_b32 v2, 63, v0
    v_readfirstlane_b32 s45, v1
    v_lshlrev_b32 v8, 4, v2
    s_lshr_b32 s60, s45, 2
    s_and_b32 s61, s45, 3
    s_lshl_b32 s46, s61, 5
    s_mov_b32 s47, 0
    s_lshl_b32 s48, s42, 7
    s_add_u32 s48, s48, s46
    s_mul_i32 s49, s43, 144
    s_lshr_b32 s50, s48, 4
    s_mul_i32 s50, s50, 65536
    v_add_u32 v9, s50, v8
    v_add_u32 v10, 65536, v9
    s_mul_i32 s51, s44, 65536
    s_lshl_b32 s53, s60, 10
    s_add_u32 s51, s51, s53
    s_mul_i32 s52, s44, 64
    s_add_u32 s52, s52, s60
    s_mul_i32 s52, s52, 147456
    s_mul_i32 s53, s43, 9216
    s_add_u32 s52, s52, s53
    s_mul_i32 s53, s61, 2304
    s_add_u32 s52, s52, s53
    s_mul_i32 s55, s60, 9216
    s_add_u32 s55, s55, s53
    s_mul_i32 s53, s60, 9216
    s_mul_i32 s54, s47, 9216
    s_add_u32 s53, s53, s54
    v_add_u32 v11, s53, v8
    v_add_u32 v12, 65536, v11
    s_mov_b32 s62, -1
    s_mov_b32 s63, 0xffff
    s_waitcnt lgkmcnt(0)
    s_add_u32 s12, s4, 0x8770000
    s_addc_u32 s13, s5, 0
    s_mov_b32 s14, 0x800000
    s_mov_b32 s15, 0x00020000
    s_add_u32 s16, s4, 0x3ad0000
    s_addc_u32 s17, s5, 0
    s_mov_b32 s18, 0x900000
    s_mov_b32 s19, 0x00020000
    buffer_load_dwordx4 v[40:43], v9, s[12:15], s51 offen
    buffer_load_dwordx4 v[44:47], v10, s[12:15], s51 offen
    s_add_u32 s51, s51, 2048
    s_add_u32 m0, s55, 0
    s_mov_b64 exec, s[62:63]
    buffer_load_dwordx4 v8, s[16:19], s52 offen offset:0 lds
    s_mov_b64 exec, -1
    s_mov_b64 exec, s[62:63]
    buffer_load_dwordx4 v8, s[16:19], s52 offen offset:768 lds
    s_mov_b64 exec, -1
    s_mov_b64 exec, s[62:63]
    buffer_load_dwordx4 v8, s[16:19], s52 offen offset:1536 lds
    s_mov_b64 exec, -1
    s_add_u32 s52, s52, 294912
    buffer_load_dwordx4 v[48:51], v9, s[12:15], s51 offen
    buffer_load_dwordx4 v[52:55], v10, s[12:15], s51 offen
    s_add_u32 s51, s51, 2048
    s_add_u32 m0, s55, 18432
    s_mov_b64 exec, s[62:63]
    buffer_load_dwordx4 v8, s[16:19], s52 offen offset:0 lds
    s_mov_b64 exec, -1
    s_mov_b64 exec, s[62:63]
    buffer_load_dwordx4 v8, s[16:19], s52 offen offset:768 lds
    s_mov_b64 exec, -1
    s_mov_b64 exec, s[62:63]
    buffer_load_dwordx4 v8, s[16:19], s52 offen offset:1536 lds
    s_mov_b64 exec, -1
    s_add_u32 s52, s52, 294912
    buffer_load_dwordx4 v[56:59], v9, s[12:15], s51 offen
    buffer_load_dwordx4 v[60:63], v10, s[12:15], s51 offen
    s_add_u32 s51, s51, 2048
    s_add_u32 m0, s55, 36864
    s_mov_b64 exec, s[62:63]
    buffer_load_dwordx4 v8, s[16:19], s52 offen offset:0 lds
    s_mov_b64 exec, -1
    s_mov_b64 exec, s[62:63]
    buffer_load_dwordx4 v8, s[16:19], s52 offen offset:768 lds
    s_mov_b64 exec, -1
    s_mov_b64 exec, s[62:63]
    buffer_load_dwordx4 v8, s[16:19], s52 offen offset:1536 lds
    s_mov_b64 exec, -1
    s_add_u32 s52, s52, 294912
    v_accvgpr_write_b32 a0, 0
    v_accvgpr_write_b32 a1, 0
    v_accvgpr_write_b32 a2, 0
    v_accvgpr_write_b32 a3, 0
    v_accvgpr_write_b32 a4, 0
    v_accvgpr_write_b32 a5, 0
    v_accvgpr_write_b32 a6, 0
    v_accvgpr_write_b32 a7, 0
    v_accvgpr_write_b32 a8, 0
    v_accvgpr_write_b32 a9, 0
    v_accvgpr_write_b32 a10, 0
    v_accvgpr_write_b32 a11, 0
    v_accvgpr_write_b32 a12, 0
    v_accvgpr_write_b32 a13, 0
    v_accvgpr_write_b32 a14, 0
    v_accvgpr_write_b32 a15, 0
    v_accvgpr_write_b32 a16, 0
    v_accvgpr_write_b32 a17, 0
    v_accvgpr_write_b32 a18, 0
    v_accvgpr_write_b32 a19, 0
    v_accvgpr_write_b32 a20, 0
    v_accvgpr_write_b32 a21, 0
    v_accvgpr_write_b32 a22, 0
    v_accvgpr_write_b32 a23, 0
    v_accvgpr_write_b32 a24, 0
    v_accvgpr_write_b32 a25, 0
    v_accvgpr_write_b32 a26, 0
    v_accvgpr_write_b32 a27, 0
    v_accvgpr_write_b32 a28, 0
    v_accvgpr_write_b32 a29, 0
    v_accvgpr_write_b32 a30, 0
    v_accvgpr_write_b32 a31, 0
    v_accvgpr_write_b32 a32, 0
    v_accvgpr_write_b32 a33, 0
    v_accvgpr_write_b32 a34, 0
    v_accvgpr_write_b32 a35, 0
    v_accvgpr_write_b32 a36, 0
    v_accvgpr_write_b32 a37, 0
    v_accvgpr_write_b32 a38, 0
    v_accvgpr_write_b32 a39, 0
    v_accvgpr_write_b32 a40, 0
    v_accvgpr_write_b32 a41, 0
    v_accvgpr_write_b32 a42, 0
    v_accvgpr_write_b32 a43, 0
    v_accvgpr_write_b32 a44, 0
    v_accvgpr_write_b32 a45, 0
    v_accvgpr_write_b32 a46, 0
    v_accvgpr_write_b32 a47, 0
    v_accvgpr_write_b32 a48, 0
    v_accvgpr_write_b32 a49, 0
    v_accvgpr_write_b32 a50, 0
    v_accvgpr_write_b32 a51, 0
    v_accvgpr_write_b32 a52, 0
    v_accvgpr_write_b32 a53, 0
    v_accvgpr_write_b32 a54, 0
    v_accvgpr_write_b32 a55, 0
    v_accvgpr_write_b32 a56, 0
    v_accvgpr_write_b32 a57, 0
    v_accvgpr_write_b32 a58, 0
    v_accvgpr_write_b32 a59, 0
    v_accvgpr_write_b32 a60, 0
    v_accvgpr_write_b32 a61, 0
    v_accvgpr_write_b32 a62, 0
    v_accvgpr_write_b32 a63, 0
    v_accvgpr_write_b32 a64, 0
    v_accvgpr_write_b32 a65, 0
    v_accvgpr_write_b32 a66, 0
    v_accvgpr_write_b32 a67, 0
    v_accvgpr_write_b32 a68, 0
    v_accvgpr_write_b32 a69, 0
    v_accvgpr_write_b32 a70, 0
    v_accvgpr_write_b32 a71, 0
    s_waitcnt vmcnt(10)
    s_barrier
    ds_read_b128 v[16:19], v11 offset:0
    ds_read_b128 v[20:23], v11 offset:1024
    ds_read_b128 v[24:27], v11 offset:2048
    ds_read_b128 v[28:31], v11 offset:3072
    ds_read_b128 v[32:35], v11 offset:4096
    s_mov_b32 s56, 7
g4_kernel_loop2:
    ds_read_b128 v[36:39], v11 offset:5120
    s_waitcnt lgkmcnt(5)
    v_mfma_f32_16x16x32_bf16 a[0:3], v[16:19], v[40:43], a[0:3]
    v_mfma_f32_16x16x32_bf16 a[36:39], v[16:19], v[44:47], a[36:39]
    ds_read_b128 v[16:19], v11 offset:6144
    s_waitcnt lgkmcnt(5)
    v_mfma_f32_16x16x32_bf16 a[4:7], v[20:23], v[40:43], a[4:7]
    v_mfma_f32_16x16x32_bf16 a[40:43], v[20:23], v[44:47], a[40:43]
    ds_read_b128 v[20:23], v11 offset:7168
    s_waitcnt lgkmcnt(5)
    v_mfma_f32_16x16x32_bf16 a[8:11], v[24:27], v[40:43], a[8:11]
    v_mfma_f32_16x16x32_bf16 a[44:47], v[24:27], v[44:47], a[44:47]
    s_waitcnt vmcnt(5)
    s_barrier
    ds_read_b128 v[24:27], v11 offset:8192
    s_waitcnt lgkmcnt(5)
    v_mfma_f32_16x16x32_bf16 a[12:15], v[28:31], v[40:43], a[12:15]
    v_mfma_f32_16x16x32_bf16 a[48:51], v[28:31], v[44:47], a[48:51]
    buffer_load_dwordx4 v[64:67], v9, s[12:15], s51 offen
    ds_read_b128 v[28:31], v11 offset:18432
    s_waitcnt lgkmcnt(5)
    v_mfma_f32_16x16x32_bf16 a[16:19], v[32:35], v[40:43], a[16:19]
    v_mfma_f32_16x16x32_bf16 a[52:55], v[32:35], v[44:47], a[52:55]
    buffer_load_dwordx4 v[68:71], v10, s[12:15], s51 offen
    s_add_u32 s51, s51, 2048
    ds_read_b128 v[32:35], v11 offset:19456
    s_waitcnt lgkmcnt(5)
    v_mfma_f32_16x16x32_bf16 a[20:23], v[36:39], v[40:43], a[20:23]
    v_mfma_f32_16x16x32_bf16 a[56:59], v[36:39], v[44:47], a[56:59]
    s_add_u32 m0, s55, 55296
    s_mov_b64 exec, s[62:63]
    buffer_load_dwordx4 v8, s[16:19], s52 offen offset:0 lds
    s_mov_b64 exec, -1
    ds_read_b128 v[36:39], v11 offset:20480
    s_waitcnt lgkmcnt(5)
    v_mfma_f32_16x16x32_bf16 a[24:27], v[16:19], v[40:43], a[24:27]
    v_mfma_f32_16x16x32_bf16 a[60:63], v[16:19], v[44:47], a[60:63]
    s_mov_b64 exec, s[62:63]
    buffer_load_dwordx4 v8, s[16:19], s52 offen offset:768 lds
    s_mov_b64 exec, -1
    ds_read_b128 v[16:19], v11 offset:21504
    s_waitcnt lgkmcnt(5)
    v_mfma_f32_16x16x32_bf16 a[28:31], v[20:23], v[40:43], a[28:31]
    v_mfma_f32_16x16x32_bf16 a[64:67], v[20:23], v[44:47], a[64:67]
    s_mov_b64 exec, s[62:63]
    buffer_load_dwordx4 v8, s[16:19], s52 offen offset:1536 lds
    s_mov_b64 exec, -1
    s_add_u32 s52, s52, 294912
    ds_read_b128 v[20:23], v11 offset:22528
    s_waitcnt lgkmcnt(5)
    v_mfma_f32_16x16x32_bf16 a[32:35], v[24:27], v[40:43], a[32:35]
    v_mfma_f32_16x16x32_bf16 a[68:71], v[24:27], v[44:47], a[68:71]
    ds_read_b128 v[24:27], v11 offset:23552
    s_waitcnt lgkmcnt(5)
    v_mfma_f32_16x16x32_bf16 a[0:3], v[28:31], v[48:51], a[0:3]
    v_mfma_f32_16x16x32_bf16 a[36:39], v[28:31], v[52:55], a[36:39]
    ds_read_b128 v[28:31], v11 offset:24576
    s_waitcnt lgkmcnt(5)
    v_mfma_f32_16x16x32_bf16 a[4:7], v[32:35], v[48:51], a[4:7]
    v_mfma_f32_16x16x32_bf16 a[40:43], v[32:35], v[52:55], a[40:43]
    ds_read_b128 v[32:35], v11 offset:25600
    s_waitcnt lgkmcnt(5)
    v_mfma_f32_16x16x32_bf16 a[8:11], v[36:39], v[48:51], a[8:11]
    v_mfma_f32_16x16x32_bf16 a[44:47], v[36:39], v[52:55], a[44:47]
    s_waitcnt vmcnt(5)
    s_barrier
    ds_read_b128 v[36:39], v11 offset:26624
    s_waitcnt lgkmcnt(5)
    v_mfma_f32_16x16x32_bf16 a[12:15], v[16:19], v[48:51], a[12:15]
    v_mfma_f32_16x16x32_bf16 a[48:51], v[16:19], v[52:55], a[48:51]
    buffer_load_dwordx4 v[40:43], v9, s[12:15], s51 offen
    ds_read_b128 v[16:19], v11 offset:36864
    s_waitcnt lgkmcnt(5)
    v_mfma_f32_16x16x32_bf16 a[16:19], v[20:23], v[48:51], a[16:19]
    v_mfma_f32_16x16x32_bf16 a[52:55], v[20:23], v[52:55], a[52:55]
    buffer_load_dwordx4 v[44:47], v10, s[12:15], s51 offen
    s_add_u32 s51, s51, 2048
    ds_read_b128 v[20:23], v11 offset:37888
    s_waitcnt lgkmcnt(5)
    v_mfma_f32_16x16x32_bf16 a[20:23], v[24:27], v[48:51], a[20:23]
    v_mfma_f32_16x16x32_bf16 a[56:59], v[24:27], v[52:55], a[56:59]
    s_add_u32 m0, s55, 0
    s_mov_b64 exec, s[62:63]
    buffer_load_dwordx4 v8, s[16:19], s52 offen offset:0 lds
    s_mov_b64 exec, -1
    ds_read_b128 v[24:27], v11 offset:38912
    s_waitcnt lgkmcnt(5)
    v_mfma_f32_16x16x32_bf16 a[24:27], v[28:31], v[48:51], a[24:27]
    v_mfma_f32_16x16x32_bf16 a[60:63], v[28:31], v[52:55], a[60:63]
    s_mov_b64 exec, s[62:63]
    buffer_load_dwordx4 v8, s[16:19], s52 offen offset:768 lds
    s_mov_b64 exec, -1
    ds_read_b128 v[28:31], v11 offset:39936
    s_waitcnt lgkmcnt(5)
    v_mfma_f32_16x16x32_bf16 a[28:31], v[32:35], v[48:51], a[28:31]
    v_mfma_f32_16x16x32_bf16 a[64:67], v[32:35], v[52:55], a[64:67]
    s_mov_b64 exec, s[62:63]
    buffer_load_dwordx4 v8, s[16:19], s52 offen offset:1536 lds
    s_mov_b64 exec, -1
    s_add_u32 s52, s52, 294912
    ds_read_b128 v[32:35], v11 offset:40960
    s_waitcnt lgkmcnt(5)
    v_mfma_f32_16x16x32_bf16 a[32:35], v[36:39], v[48:51], a[32:35]
    v_mfma_f32_16x16x32_bf16 a[68:71], v[36:39], v[52:55], a[68:71]
    ds_read_b128 v[36:39], v11 offset:41984
    s_waitcnt lgkmcnt(5)
    v_mfma_f32_16x16x32_bf16 a[0:3], v[16:19], v[56:59], a[0:3]
    v_mfma_f32_16x16x32_bf16 a[36:39], v[16:19], v[60:63], a[36:39]
    ds_read_b128 v[16:19], v11 offset:43008
    s_waitcnt lgkmcnt(5)
    v_mfma_f32_16x16x32_bf16 a[4:7], v[20:23], v[56:59], a[4:7]
    v_mfma_f32_16x16x32_bf16 a[40:43], v[20:23], v[60:63], a[40:43]
    ds_read_b128 v[20:23], v11 offset:44032
    s_waitcnt lgkmcnt(5)
    v_mfma_f32_16x16x32_bf16 a[8:11], v[24:27], v[56:59], a[8:11]
    v_mfma_f32_16x16x32_bf16 a[44:47], v[24:27], v[60:63], a[44:47]
    s_waitcnt vmcnt(5)
    s_barrier
    ds_read_b128 v[24:27], v11 offset:45056
    s_waitcnt lgkmcnt(5)
    v_mfma_f32_16x16x32_bf16 a[12:15], v[28:31], v[56:59], a[12:15]
    v_mfma_f32_16x16x32_bf16 a[48:51], v[28:31], v[60:63], a[48:51]
    buffer_load_dwordx4 v[48:51], v9, s[12:15], s51 offen
    ds_read_b128 v[28:31], v11 offset:55296
    s_waitcnt lgkmcnt(5)
    v_mfma_f32_16x16x32_bf16 a[16:19], v[32:35], v[56:59], a[16:19]
    v_mfma_f32_16x16x32_bf16 a[52:55], v[32:35], v[60:63], a[52:55]
    buffer_load_dwordx4 v[52:55], v10, s[12:15], s51 offen
    s_add_u32 s51, s51, 2048
    ds_read_b128 v[32:35], v11 offset:56320
    s_waitcnt lgkmcnt(5)
    v_mfma_f32_16x16x32_bf16 a[20:23], v[36:39], v[56:59], a[20:23]
    v_mfma_f32_16x16x32_bf16 a[56:59], v[36:39], v[60:63], a[56:59]
    s_add_u32 m0, s55, 18432
    s_mov_b64 exec, s[62:63]
    buffer_load_dwordx4 v8, s[16:19], s52 offen offset:0 lds
    s_mov_b64 exec, -1
    ds_read_b128 v[36:39], v11 offset:57344
    s_waitcnt lgkmcnt(5)
    v_mfma_f32_16x16x32_bf16 a[24:27], v[16:19], v[56:59], a[24:27]
    v_mfma_f32_16x16x32_bf16 a[60:63], v[16:19], v[60:63], a[60:63]
    s_mov_b64 exec, s[62:63]
    buffer_load_dwordx4 v8, s[16:19], s52 offen offset:768 lds
    s_mov_b64 exec, -1
    ds_read_b128 v[16:19], v11 offset:58368
    s_waitcnt lgkmcnt(5)
    v_mfma_f32_16x16x32_bf16 a[28:31], v[20:23], v[56:59], a[28:31]
    v_mfma_f32_16x16x32_bf16 a[64:67], v[20:23], v[60:63], a[64:67]
    s_mov_b64 exec, s[62:63]
    buffer_load_dwordx4 v8, s[16:19], s52 offen offset:1536 lds
    s_mov_b64 exec, -1
    s_add_u32 s52, s52, 294912
    ds_read_b128 v[20:23], v11 offset:59392
    s_waitcnt lgkmcnt(5)
    v_mfma_f32_16x16x32_bf16 a[32:35], v[24:27], v[56:59], a[32:35]
    v_mfma_f32_16x16x32_bf16 a[68:71], v[24:27], v[60:63], a[68:71]
    ds_read_b128 v[24:27], v11 offset:60416
    s_waitcnt lgkmcnt(5)
    v_mfma_f32_16x16x32_bf16 a[0:3], v[28:31], v[64:67], a[0:3]
    v_mfma_f32_16x16x32_bf16 a[36:39], v[28:31], v[68:71], a[36:39]
    ds_read_b128 v[28:31], v11 offset:61440
    s_waitcnt lgkmcnt(5)
    v_mfma_f32_16x16x32_bf16 a[4:7], v[32:35], v[64:67], a[4:7]
    v_mfma_f32_16x16x32_bf16 a[40:43], v[32:35], v[68:71], a[40:43]
    ds_read_b128 v[32:35], v11 offset:62464
    s_waitcnt lgkmcnt(5)
    v_mfma_f32_16x16x32_bf16 a[8:11], v[36:39], v[64:67], a[8:11]
    v_mfma_f32_16x16x32_bf16 a[44:47], v[36:39], v[68:71], a[44:47]
    s_waitcnt vmcnt(5)
    s_barrier
    ds_read_b128 v[36:39], v11 offset:63488
    s_waitcnt lgkmcnt(5)
    v_mfma_f32_16x16x32_bf16 a[12:15], v[16:19], v[64:67], a[12:15]
    v_mfma_f32_16x16x32_bf16 a[48:51], v[16:19], v[68:71], a[48:51]
    buffer_load_dwordx4 v[56:59], v9, s[12:15], s51 offen
    ds_read_b128 v[16:19], v11 offset:0
    s_waitcnt lgkmcnt(5)
    v_mfma_f32_16x16x32_bf16 a[16:19], v[20:23], v[64:67], a[16:19]
    v_mfma_f32_16x16x32_bf16 a[52:55], v[20:23], v[68:71], a[52:55]
    buffer_load_dwordx4 v[60:63], v10, s[12:15], s51 offen
    s_add_u32 s51, s51, 2048
    ds_read_b128 v[20:23], v11 offset:1024
    s_waitcnt lgkmcnt(5)
    v_mfma_f32_16x16x32_bf16 a[20:23], v[24:27], v[64:67], a[20:23]
    v_mfma_f32_16x16x32_bf16 a[56:59], v[24:27], v[68:71], a[56:59]
    s_add_u32 m0, s55, 36864
    s_mov_b64 exec, s[62:63]
    buffer_load_dwordx4 v8, s[16:19], s52 offen offset:0 lds
    s_mov_b64 exec, -1
    ds_read_b128 v[24:27], v11 offset:2048
    s_waitcnt lgkmcnt(5)
    v_mfma_f32_16x16x32_bf16 a[24:27], v[28:31], v[64:67], a[24:27]
    v_mfma_f32_16x16x32_bf16 a[60:63], v[28:31], v[68:71], a[60:63]
    s_mov_b64 exec, s[62:63]
    buffer_load_dwordx4 v8, s[16:19], s52 offen offset:768 lds
    s_mov_b64 exec, -1
    ds_read_b128 v[28:31], v11 offset:3072
    s_waitcnt lgkmcnt(5)
    v_mfma_f32_16x16x32_bf16 a[28:31], v[32:35], v[64:67], a[28:31]
    v_mfma_f32_16x16x32_bf16 a[64:67], v[32:35], v[68:71], a[64:67]
    s_mov_b64 exec, s[62:63]
    buffer_load_dwordx4 v8, s[16:19], s52 offen offset:1536 lds
    s_mov_b64 exec, -1
    s_add_u32 s52, s52, 294912
    ds_read_b128 v[32:35], v11 offset:4096
    s_waitcnt lgkmcnt(5)
    v_mfma_f32_16x16x32_bf16 a[32:35], v[36:39], v[64:67], a[32:35]
    v_mfma_f32_16x16x32_bf16 a[68:71], v[36:39], v[68:71], a[68:71]
    s_sub_u32 s56, s56, 1
    s_cmp_lg_u32 s56, 0
    s_cbranch_scc1 g4_kernel_loop2
    s_mul_i32 s64, s60, 16
    s_add_u32 s48, s48, s64
    v_and_b32 v3, 15, v2
    v_lshrrev_b32 v5, 4, v2
    v_add_u32 v3, s48, v3
    s_mul_i32 s53, s47, 144
    s_add_u32 s53, s53, s49
    v_lshl_add_u32 v5, v5, 2, s53
    s_add_u32 s20, s4, 0x43d0000
    s_addc_u32 s21, s5, 0
    s_mov_b32 s22, 0x900000
    s_mov_b32 s23, 0x00020000
    s_add_u32 s24, s4, 0x28d0000
    s_addc_u32 s25, s5, 0
    s_mov_b32 s26, 0x1200000
    s_mov_b32 s27, 0x00020000
    s_mov_b32 s28, s6
    s_mov_b32 s29, s7
    s_mov_b32 s30, 0x1000
    s_mov_b32 s31, 0x00020000
    s_lshr_b32 s65, s48, 5
    s_mul_i32 s65, s65, 294912
    s_lshl_b32 s64, s53, 6
    s_add_u32 s65, s65, s64
    s_lshr_b32 s64, s48, 1
    s_and_b32 s64, s64, 8
    s_add_u32 s65, s65, s64
    s_add_u32 s66, s65, 4096
    s_add_u32 s67, s65, 8192
    v_lshlrev_b32 v7, 1, v3
    ds_read_b128 v[36:39], v11 offset:5120
    s_waitcnt lgkmcnt(5)
    v_mfma_f32_16x16x32_bf16 a[0:3], v[16:19], v[40:43], a[0:3]
    v_mfma_f32_16x16x32_bf16 a[36:39], v[16:19], v[44:47], a[36:39]
    ds_read_b128 v[16:19], v11 offset:6144
    s_waitcnt lgkmcnt(5)
    v_mfma_f32_16x16x32_bf16 a[4:7], v[20:23], v[40:43], a[4:7]
    v_mfma_f32_16x16x32_bf16 a[40:43], v[20:23], v[44:47], a[40:43]
    ds_read_b128 v[20:23], v11 offset:7168
    s_waitcnt lgkmcnt(5)
    v_mfma_f32_16x16x32_bf16 a[8:11], v[24:27], v[40:43], a[8:11]
    v_mfma_f32_16x16x32_bf16 a[44:47], v[24:27], v[44:47], a[44:47]
    s_waitcnt vmcnt(5)
    s_barrier
    ds_read_b128 v[24:27], v11 offset:8192
    s_waitcnt lgkmcnt(5)
    v_mfma_f32_16x16x32_bf16 a[12:15], v[28:31], v[40:43], a[12:15]
    v_mfma_f32_16x16x32_bf16 a[48:51], v[28:31], v[44:47], a[48:51]
    buffer_load_dwordx4 v[64:67], v9, s[12:15], s51 offen
    ds_read_b128 v[28:31], v11 offset:18432
    s_waitcnt lgkmcnt(5)
    v_mfma_f32_16x16x32_bf16 a[16:19], v[32:35], v[40:43], a[16:19]
    v_mfma_f32_16x16x32_bf16 a[52:55], v[32:35], v[44:47], a[52:55]
    buffer_load_dwordx4 v[68:71], v10, s[12:15], s51 offen
    s_add_u32 s51, s51, 2048
    ds_read_b128 v[32:35], v11 offset:19456
    s_waitcnt lgkmcnt(5)
    v_mfma_f32_16x16x32_bf16 a[20:23], v[36:39], v[40:43], a[20:23]
    v_mfma_f32_16x16x32_bf16 a[56:59], v[36:39], v[44:47], a[56:59]
    s_add_u32 m0, s55, 55296
    s_mov_b64 exec, s[62:63]
    buffer_load_dwordx4 v8, s[16:19], s52 offen offset:0 lds
    s_mov_b64 exec, -1
    ds_read_b128 v[36:39], v11 offset:20480
    s_waitcnt lgkmcnt(5)
    v_mfma_f32_16x16x32_bf16 a[24:27], v[16:19], v[40:43], a[24:27]
    v_mfma_f32_16x16x32_bf16 a[60:63], v[16:19], v[44:47], a[60:63]
    s_mov_b64 exec, s[62:63]
    buffer_load_dwordx4 v8, s[16:19], s52 offen offset:768 lds
    s_mov_b64 exec, -1
    ds_read_b128 v[16:19], v11 offset:21504
    s_waitcnt lgkmcnt(5)
    v_mfma_f32_16x16x32_bf16 a[28:31], v[20:23], v[40:43], a[28:31]
    v_mfma_f32_16x16x32_bf16 a[64:67], v[20:23], v[44:47], a[64:67]
    s_mov_b64 exec, s[62:63]
    buffer_load_dwordx4 v8, s[16:19], s52 offen offset:1536 lds
    s_mov_b64 exec, -1
    s_add_u32 s52, s52, 294912
    ds_read_b128 v[20:23], v11 offset:22528
    s_waitcnt lgkmcnt(5)
    v_mfma_f32_16x16x32_bf16 a[32:35], v[24:27], v[40:43], a[32:35]
    v_mfma_f32_16x16x32_bf16 a[68:71], v[24:27], v[44:47], a[68:71]
    ds_read_b128 v[24:27], v11 offset:23552
    s_waitcnt lgkmcnt(5)
    v_mfma_f32_16x16x32_bf16 a[0:3], v[28:31], v[48:51], a[0:3]
    v_mfma_f32_16x16x32_bf16 a[36:39], v[28:31], v[52:55], a[36:39]
    ds_read_b128 v[28:31], v11 offset:24576
    s_waitcnt lgkmcnt(5)
    v_mfma_f32_16x16x32_bf16 a[4:7], v[32:35], v[48:51], a[4:7]
    v_mfma_f32_16x16x32_bf16 a[40:43], v[32:35], v[52:55], a[40:43]
    ds_read_b128 v[32:35], v11 offset:25600
    s_waitcnt lgkmcnt(5)
    v_mfma_f32_16x16x32_bf16 a[8:11], v[36:39], v[48:51], a[8:11]
    v_mfma_f32_16x16x32_bf16 a[44:47], v[36:39], v[52:55], a[44:47]
    s_waitcnt vmcnt(5)
    s_barrier
    ds_read_b128 v[36:39], v11 offset:26624
    s_waitcnt lgkmcnt(5)
    v_mfma_f32_16x16x32_bf16 a[12:15], v[16:19], v[48:51], a[12:15]
    v_mfma_f32_16x16x32_bf16 a[48:51], v[16:19], v[52:55], a[48:51]
    ds_read_b128 v[16:19], v11 offset:36864
    s_waitcnt lgkmcnt(5)
    v_mfma_f32_16x16x32_bf16 a[16:19], v[20:23], v[48:51], a[16:19]
    v_mfma_f32_16x16x32_bf16 a[52:55], v[20:23], v[52:55], a[52:55]
    ds_read_b128 v[20:23], v11 offset:37888
    s_waitcnt lgkmcnt(5)
    v_mfma_f32_16x16x32_bf16 a[20:23], v[24:27], v[48:51], a[20:23]
    v_mfma_f32_16x16x32_bf16 a[56:59], v[24:27], v[52:55], a[56:59]
    ds_read_b128 v[24:27], v11 offset:38912
    s_waitcnt lgkmcnt(5)
    v_mfma_f32_16x16x32_bf16 a[24:27], v[28:31], v[48:51], a[24:27]
    v_mfma_f32_16x16x32_bf16 a[60:63], v[28:31], v[52:55], a[60:63]
    ds_read_b128 v[28:31], v11 offset:39936
    s_waitcnt lgkmcnt(5)
    v_mfma_f32_16x16x32_bf16 a[28:31], v[32:35], v[48:51], a[28:31]
    v_mfma_f32_16x16x32_bf16 a[64:67], v[32:35], v[52:55], a[64:67]
    ds_read_b128 v[32:35], v11 offset:40960
    s_waitcnt lgkmcnt(5)
    v_mfma_f32_16x16x32_bf16 a[32:35], v[36:39], v[48:51], a[32:35]
    v_mfma_f32_16x16x32_bf16 a[68:71], v[36:39], v[52:55], a[68:71]
    ds_read_b128 v[36:39], v11 offset:41984
    s_waitcnt lgkmcnt(5)
    v_mfma_f32_16x16x32_bf16 a[0:3], v[16:19], v[56:59], a[0:3]
    v_mfma_f32_16x16x32_bf16 a[36:39], v[16:19], v[60:63], a[36:39]
    ds_read_b128 v[16:19], v11 offset:43008
    s_waitcnt lgkmcnt(5)
    v_mfma_f32_16x16x32_bf16 a[4:7], v[20:23], v[56:59], a[4:7]
    v_mfma_f32_16x16x32_bf16 a[40:43], v[20:23], v[60:63], a[40:43]
    ds_read_b128 v[20:23], v11 offset:44032
    s_waitcnt lgkmcnt(5)
    v_mfma_f32_16x16x32_bf16 a[8:11], v[24:27], v[56:59], a[8:11]
    v_mfma_f32_16x16x32_bf16 a[44:47], v[24:27], v[60:63], a[44:47]
    s_waitcnt vmcnt(0)
    s_barrier
    ds_read_b128 v[24:27], v11 offset:45056
    s_waitcnt lgkmcnt(5)
    v_mfma_f32_16x16x32_bf16 a[12:15], v[28:31], v[56:59], a[12:15]
    v_mfma_f32_16x16x32_bf16 a[48:51], v[28:31], v[60:63], a[48:51]
    ds_read_b128 v[28:31], v11 offset:55296
    s_waitcnt lgkmcnt(5)
    v_mfma_f32_16x16x32_bf16 a[16:19], v[32:35], v[56:59], a[16:19]
    v_mfma_f32_16x16x32_bf16 a[52:55], v[32:35], v[60:63], a[52:55]
    ds_read_b128 v[32:35], v11 offset:56320
    s_waitcnt lgkmcnt(5)
    v_mfma_f32_16x16x32_bf16 a[20:23], v[36:39], v[56:59], a[20:23]
    v_mfma_f32_16x16x32_bf16 a[56:59], v[36:39], v[60:63], a[56:59]
    ds_read_b128 v[36:39], v11 offset:57344
    s_waitcnt lgkmcnt(5)
    v_mfma_f32_16x16x32_bf16 a[24:27], v[16:19], v[56:59], a[24:27]
    v_mfma_f32_16x16x32_bf16 a[60:63], v[16:19], v[60:63], a[60:63]
    ds_read_b128 v[16:19], v11 offset:58368
    s_waitcnt lgkmcnt(5)
    v_mfma_f32_16x16x32_bf16 a[28:31], v[20:23], v[56:59], a[28:31]
    v_mfma_f32_16x16x32_bf16 a[64:67], v[20:23], v[60:63], a[64:67]
    ds_read_b128 v[20:23], v11 offset:59392
    s_waitcnt lgkmcnt(5)
    v_mfma_f32_16x16x32_bf16 a[32:35], v[24:27], v[56:59], a[32:35]
    v_mfma_f32_16x16x32_bf16 a[68:71], v[24:27], v[60:63], a[68:71]
    buffer_load_ushort v90, v7, s[28:31], 0 offen
    buffer_load_dwordx2 v[72:73], v8, s[24:27], s65 offen offset:0
    buffer_load_dwordx2 v[74:75], v8, s[24:27], s65 offen offset:1024
    buffer_load_dwordx2 v[76:77], v8, s[24:27], s65 offen offset:2048
    buffer_load_dwordx2 v[78:79], v8, s[24:27], s65 offen offset:3072
    buffer_load_dwordx2 v[80:81], v8, s[24:27], s66 offen offset:0
    buffer_load_dwordx2 v[82:83], v8, s[24:27], s66 offen offset:1024
    buffer_load_dwordx2 v[84:85], v8, s[24:27], s66 offen offset:2048
    buffer_load_dwordx2 v[86:87], v8, s[24:27], s66 offen offset:3072
    buffer_load_dwordx2 v[88:89], v8, s[24:27], s67 offen offset:0
    ds_read_b128 v[24:27], v11 offset:60416
    s_waitcnt lgkmcnt(5)
    v_mfma_f32_16x16x32_bf16 a[0:3], v[28:31], v[64:67], a[0:3]
    v_mfma_f32_16x16x32_bf16 a[36:39], v[28:31], v[68:71], a[36:39]
    ds_read_b128 v[28:31], v11 offset:61440
    s_waitcnt lgkmcnt(5)
    v_mfma_f32_16x16x32_bf16 a[4:7], v[32:35], v[64:67], a[4:7]
    v_mfma_f32_16x16x32_bf16 a[40:43], v[32:35], v[68:71], a[40:43]
    ds_read_b128 v[32:35], v11 offset:62464
    s_waitcnt lgkmcnt(5)
    v_mfma_f32_16x16x32_bf16 a[8:11], v[36:39], v[64:67], a[8:11]
    v_mfma_f32_16x16x32_bf16 a[44:47], v[36:39], v[68:71], a[44:47]
    ds_read_b128 v[36:39], v11 offset:63488
    s_waitcnt lgkmcnt(5)
    v_mfma_f32_16x16x32_bf16 a[12:15], v[16:19], v[64:67], a[12:15]
    v_mfma_f32_16x16x32_bf16 a[48:51], v[16:19], v[68:71], a[48:51]
    s_waitcnt lgkmcnt(4)
    v_mfma_f32_16x16x32_bf16 a[16:19], v[20:23], v[64:67], a[16:19]
    v_mfma_f32_16x16x32_bf16 a[52:55], v[20:23], v[68:71], a[52:55]
    s_waitcnt lgkmcnt(3)
    v_mfma_f32_16x16x32_bf16 a[20:23], v[24:27], v[64:67], a[20:23]
    v_mfma_f32_16x16x32_bf16 a[56:59], v[24:27], v[68:71], a[56:59]
    s_waitcnt lgkmcnt(2)
    v_mfma_f32_16x16x32_bf16 a[24:27], v[28:31], v[64:67], a[24:27]
    v_mfma_f32_16x16x32_bf16 a[60:63], v[28:31], v[68:71], a[60:63]
    s_waitcnt lgkmcnt(1)
    v_mfma_f32_16x16x32_bf16 a[28:31], v[32:35], v[64:67], a[28:31]
    v_mfma_f32_16x16x32_bf16 a[64:67], v[32:35], v[68:71], a[64:67]
    s_waitcnt lgkmcnt(0)
    v_mfma_f32_16x16x32_bf16 a[32:35], v[36:39], v[64:67], a[32:35]
    v_mfma_f32_16x16x32_bf16 a[68:71], v[36:39], v[68:71], a[68:71]
    s_barrier
    s_mul_i32 s64, s45, 9216
    v_add_u32 v1, s64, v8
    s_xor_b32 s64, s45, 4
    s_mul_i32 s64, s64, 9216
    v_add_u32 v4, s64, v8
    s_cmp_eq_u32 s60, 1
    s_cbranch_scc1 g4_kernel_hi3
    s_nop 7
    v_accvgpr_read_b32 v16, a36
    v_accvgpr_read_b32 v17, a37
    v_accvgpr_read_b32 v18, a38
    v_accvgpr_read_b32 v19, a39
    ds_write_b128 v1, v[16:19] offset:0
    v_accvgpr_read_b32 v20, a40
    v_accvgpr_read_b32 v21, a41
    v_accvgpr_read_b32 v22, a42
    v_accvgpr_read_b32 v23, a43
    ds_write_b128 v1, v[20:23] offset:1024
    v_accvgpr_read_b32 v24, a44
    v_accvgpr_read_b32 v25, a45
    v_accvgpr_read_b32 v26, a46
    v_accvgpr_read_b32 v27, a47
    ds_write_b128 v1, v[24:27] offset:2048
    v_accvgpr_read_b32 v28, a48
    v_accvgpr_read_b32 v29, a49
    v_accvgpr_read_b32 v30, a50
    v_accvgpr_read_b32 v31, a51
    ds_write_b128 v1, v[28:31] offset:3072
    v_accvgpr_read_b32 v32, a52
    v_accvgpr_read_b32 v33, a53
    v_accvgpr_read_b32 v34, a54
    v_accvgpr_read_b32 v35, a55
    ds_write_b128 v1, v[32:35] offset:4096
    v_accvgpr_read_b32 v36, a56
    v_accvgpr_read_b32 v37, a57
    v_accvgpr_read_b32 v38, a58
    v_accvgpr_read_b32 v39, a59
    ds_write_b128 v1, v[36:39] offset:5120
    v_accvgpr_read_b32 v40, a60
    v_accvgpr_read_b32 v41, a61
    v_accvgpr_read_b32 v42, a62
    v_accvgpr_read_b32 v43, a63
    ds_write_b128 v1, v[40:43] offset:6144
    v_accvgpr_read_b32 v44, a64
    v_accvgpr_read_b32 v45, a65
    v_accvgpr_read_b32 v46, a66
    v_accvgpr_read_b32 v47, a67
    ds_write_b128 v1, v[44:47] offset:7168
    v_accvgpr_read_b32 v48, a68
    v_accvgpr_read_b32 v49, a69
    v_accvgpr_read_b32 v50, a70
    v_accvgpr_read_b32 v51, a71
    ds_write_b128 v1, v[48:51] offset:8192
    s_waitcnt lgkmcnt(0)
    s_barrier
    s_lshr_b32 s57, s48, 4
    s_mul_i32 s57, s57, 73728
    s_lshr_b32 s58, s53, 4
    s_waitcnt vmcnt(0)
    v_lshlrev_b32 v90, 16, v90
    ds_read_b128 v[16:19], v4 offset:0
    ds_read_b128 v[20:23], v4 offset:1024
    ds_read_b128 v[24:27], v4 offset:2048
    ds_read_b128 v[28:31], v4 offset:3072
    ds_read_b128 v[32:35], v4 offset:4096
    ds_read_b128 v[36:39], v4 offset:5120
    ds_read_b128 v[40:43], v4 offset:6144
    ds_read_b128 v[44:47], v4 offset:7168
    ds_read_b128 v[48:51], v4 offset:8192
    v_accvgpr_read_b32 v52, a0
    v_accvgpr_read_b32 v53, a1
    v_accvgpr_read_b32 v54, a2
    v_accvgpr_read_b32 v55, a3
    s_waitcnt lgkmcnt(8)
    v_add_f32 v16, v16, v52
    v_add_f32 v17, v17, v53
    v_add_f32 v18, v18, v54
    v_add_f32 v19, v19, v55
    v_add_f32 v16, v16, v90
    v_add_f32 v17, v17, v90
    v_add_f32 v18, v18, v90
    v_add_f32 v19, v19, v90
    v_lshlrev_b32 v52, 16, v72
    v_and_b32 v53, 0xffff0000, v72
    v_lshlrev_b32 v54, 16, v73
    v_and_b32 v55, 0xffff0000, v73
    v_mul_f32 v16, v16, v52
    v_mul_f32 v17, v17, v53
    v_mul_f32 v18, v18, v54
    v_mul_f32 v19, v19, v55
    v_cvt_pk_bf16_f32 v16, v16, v17
    v_cvt_pk_bf16_f32 v17, v18, v19
    s_add_u32 s59, s58, 0
    s_lshr_b32 s64, s59, 1
    s_lshl_b32 s64, s64, 10
    s_and_b32 s59, s59, 1
    s_lshl_b32 s59, s59, 3
    s_add_u32 s59, s59, s64
    s_add_u32 s59, s59, s57
    buffer_store_dwordx2 v[16:17], v8, s[20:23], s59 offen
    v_accvgpr_read_b32 v60, a4
    v_accvgpr_read_b32 v61, a5
    v_accvgpr_read_b32 v62, a6
    v_accvgpr_read_b32 v63, a7
    s_waitcnt lgkmcnt(7)
    v_add_f32 v20, v20, v60
    v_add_f32 v21, v21, v61
    v_add_f32 v22, v22, v62
    v_add_f32 v23, v23, v63
    v_add_f32 v20, v20, v90
    v_add_f32 v21, v21, v90
    v_add_f32 v22, v22, v90
    v_add_f32 v23, v23, v90
    v_lshlrev_b32 v60, 16, v74
    v_and_b32 v61, 0xffff0000, v74
    v_lshlrev_b32 v62, 16, v75
    v_and_b32 v63, 0xffff0000, v75
    v_mul_f32 v20, v20, v60
    v_mul_f32 v21, v21, v61
    v_mul_f32 v22, v22, v62
    v_mul_f32 v23, v23, v63
    v_cvt_pk_bf16_f32 v20, v20, v21
    v_cvt_pk_bf16_f32 v21, v22, v23
    s_add_u32 s59, s58, 1
    s_lshr_b32 s64, s59, 1
    s_lshl_b32 s64, s64, 10
    s_and_b32 s59, s59, 1
    s_lshl_b32 s59, s59, 3
    s_add_u32 s59, s59, s64
    s_add_u32 s59, s59, s57
    buffer_store_dwordx2 v[20:21], v8, s[20:23], s59 offen
    v_accvgpr_read_b32 v52, a8
    v_accvgpr_read_b32 v53, a9
    v_accvgpr_read_b32 v54, a10
    v_accvgpr_read_b32 v55, a11
    s_waitcnt lgkmcnt(6)
    v_add_f32 v24, v24, v52
    v_add_f32 v25, v25, v53
    v_add_f32 v26, v26, v54
    v_add_f32 v27, v27, v55
    v_add_f32 v24, v24, v90
    v_add_f32 v25, v25, v90
    v_add_f32 v26, v26, v90
    v_add_f32 v27, v27, v90
    v_lshlrev_b32 v52, 16, v76
    v_and_b32 v53, 0xffff0000, v76
    v_lshlrev_b32 v54, 16, v77
    v_and_b32 v55, 0xffff0000, v77
    v_mul_f32 v24, v24, v52
    v_mul_f32 v25, v25, v53
    v_mul_f32 v26, v26, v54
    v_mul_f32 v27, v27, v55
    v_cvt_pk_bf16_f32 v24, v24, v25
    v_cvt_pk_bf16_f32 v25, v26, v27
    s_add_u32 s59, s58, 2
    s_lshr_b32 s64, s59, 1
    s_lshl_b32 s64, s64, 10
    s_and_b32 s59, s59, 1
    s_lshl_b32 s59, s59, 3
    s_add_u32 s59, s59, s64
    s_add_u32 s59, s59, s57
    buffer_store_dwordx2 v[24:25], v8, s[20:23], s59 offen
    v_accvgpr_read_b32 v60, a12
    v_accvgpr_read_b32 v61, a13
    v_accvgpr_read_b32 v62, a14
    v_accvgpr_read_b32 v63, a15
    s_waitcnt lgkmcnt(5)
    v_add_f32 v28, v28, v60
    v_add_f32 v29, v29, v61
    v_add_f32 v30, v30, v62
    v_add_f32 v31, v31, v63
    v_add_f32 v28, v28, v90
    v_add_f32 v29, v29, v90
    v_add_f32 v30, v30, v90
    v_add_f32 v31, v31, v90
    v_lshlrev_b32 v60, 16, v78
    v_and_b32 v61, 0xffff0000, v78
    v_lshlrev_b32 v62, 16, v79
    v_and_b32 v63, 0xffff0000, v79
    v_mul_f32 v28, v28, v60
    v_mul_f32 v29, v29, v61
    v_mul_f32 v30, v30, v62
    v_mul_f32 v31, v31, v63
    v_cvt_pk_bf16_f32 v28, v28, v29
    v_cvt_pk_bf16_f32 v29, v30, v31
    s_add_u32 s59, s58, 3
    s_lshr_b32 s64, s59, 1
    s_lshl_b32 s64, s64, 10
    s_and_b32 s59, s59, 1
    s_lshl_b32 s59, s59, 3
    s_add_u32 s59, s59, s64
    s_add_u32 s59, s59, s57
    buffer_store_dwordx2 v[28:29], v8, s[20:23], s59 offen
    v_accvgpr_read_b32 v52, a16
    v_accvgpr_read_b32 v53, a17
    v_accvgpr_read_b32 v54, a18
    v_accvgpr_read_b32 v55, a19
    s_waitcnt lgkmcnt(4)
    v_add_f32 v32, v32, v52
    v_add_f32 v33, v33, v53
    v_add_f32 v34, v34, v54
    v_add_f32 v35, v35, v55
    v_add_f32 v32, v32, v90
    v_add_f32 v33, v33, v90
    v_add_f32 v34, v34, v90
    v_add_f32 v35, v35, v90
    v_lshlrev_b32 v52, 16, v80
    v_and_b32 v53, 0xffff0000, v80
    v_lshlrev_b32 v54, 16, v81
    v_and_b32 v55, 0xffff0000, v81
    v_mul_f32 v32, v32, v52
    v_mul_f32 v33, v33, v53
    v_mul_f32 v34, v34, v54
    v_mul_f32 v35, v35, v55
    v_cvt_pk_bf16_f32 v32, v32, v33
    v_cvt_pk_bf16_f32 v33, v34, v35
    s_add_u32 s59, s58, 4
    s_lshr_b32 s64, s59, 1
    s_lshl_b32 s64, s64, 10
    s_and_b32 s59, s59, 1
    s_lshl_b32 s59, s59, 3
    s_add_u32 s59, s59, s64
    s_add_u32 s59, s59, s57
    buffer_store_dwordx2 v[32:33], v8, s[20:23], s59 offen
    v_accvgpr_read_b32 v60, a20
    v_accvgpr_read_b32 v61, a21
    v_accvgpr_read_b32 v62, a22
    v_accvgpr_read_b32 v63, a23
    s_waitcnt lgkmcnt(3)
    v_add_f32 v36, v36, v60
    v_add_f32 v37, v37, v61
    v_add_f32 v38, v38, v62
    v_add_f32 v39, v39, v63
    v_add_f32 v36, v36, v90
    v_add_f32 v37, v37, v90
    v_add_f32 v38, v38, v90
    v_add_f32 v39, v39, v90
    v_lshlrev_b32 v60, 16, v82
    v_and_b32 v61, 0xffff0000, v82
    v_lshlrev_b32 v62, 16, v83
    v_and_b32 v63, 0xffff0000, v83
    v_mul_f32 v36, v36, v60
    v_mul_f32 v37, v37, v61
    v_mul_f32 v38, v38, v62
    v_mul_f32 v39, v39, v63
    v_cvt_pk_bf16_f32 v36, v36, v37
    v_cvt_pk_bf16_f32 v37, v38, v39
    s_add_u32 s59, s58, 5
    s_lshr_b32 s64, s59, 1
    s_lshl_b32 s64, s64, 10
    s_and_b32 s59, s59, 1
    s_lshl_b32 s59, s59, 3
    s_add_u32 s59, s59, s64
    s_add_u32 s59, s59, s57
    buffer_store_dwordx2 v[36:37], v8, s[20:23], s59 offen
    v_accvgpr_read_b32 v52, a24
    v_accvgpr_read_b32 v53, a25
    v_accvgpr_read_b32 v54, a26
    v_accvgpr_read_b32 v55, a27
    s_waitcnt lgkmcnt(2)
    v_add_f32 v40, v40, v52
    v_add_f32 v41, v41, v53
    v_add_f32 v42, v42, v54
    v_add_f32 v43, v43, v55
    v_add_f32 v40, v40, v90
    v_add_f32 v41, v41, v90
    v_add_f32 v42, v42, v90
    v_add_f32 v43, v43, v90
    v_lshlrev_b32 v52, 16, v84
    v_and_b32 v53, 0xffff0000, v84
    v_lshlrev_b32 v54, 16, v85
    v_and_b32 v55, 0xffff0000, v85
    v_mul_f32 v40, v40, v52
    v_mul_f32 v41, v41, v53
    v_mul_f32 v42, v42, v54
    v_mul_f32 v43, v43, v55
    v_cvt_pk_bf16_f32 v40, v40, v41
    v_cvt_pk_bf16_f32 v41, v42, v43
    s_add_u32 s59, s58, 6
    s_lshr_b32 s64, s59, 1
    s_lshl_b32 s64, s64, 10
    s_and_b32 s59, s59, 1
    s_lshl_b32 s59, s59, 3
    s_add_u32 s59, s59, s64
    s_add_u32 s59, s59, s57
    buffer_store_dwordx2 v[40:41], v8, s[20:23], s59 offen
    v_accvgpr_read_b32 v60, a28
    v_accvgpr_read_b32 v61, a29
    v_accvgpr_read_b32 v62, a30
    v_accvgpr_read_b32 v63, a31
    s_waitcnt lgkmcnt(1)
    v_add_f32 v44, v44, v60
    v_add_f32 v45, v45, v61
    v_add_f32 v46, v46, v62
    v_add_f32 v47, v47, v63
    v_add_f32 v44, v44, v90
    v_add_f32 v45, v45, v90
    v_add_f32 v46, v46, v90
    v_add_f32 v47, v47, v90
    v_lshlrev_b32 v60, 16, v86
    v_and_b32 v61, 0xffff0000, v86
    v_lshlrev_b32 v62, 16, v87
    v_and_b32 v63, 0xffff0000, v87
    v_mul_f32 v44, v44, v60
    v_mul_f32 v45, v45, v61
    v_mul_f32 v46, v46, v62
    v_mul_f32 v47, v47, v63
    v_cvt_pk_bf16_f32 v44, v44, v45
    v_cvt_pk_bf16_f32 v45, v46, v47
    s_add_u32 s59, s58, 7
    s_lshr_b32 s64, s59, 1
    s_lshl_b32 s64, s64, 10
    s_and_b32 s59, s59, 1
    s_lshl_b32 s59, s59, 3
    s_add_u32 s59, s59, s64
    s_add_u32 s59, s59, s57
    buffer_store_dwordx2 v[44:45], v8, s[20:23], s59 offen
    v_accvgpr_read_b32 v52, a32
    v_accvgpr_read_b32 v53, a33
    v_accvgpr_read_b32 v54, a34
    v_accvgpr_read_b32 v55, a35
    s_waitcnt lgkmcnt(0)
    v_add_f32 v48, v48, v52
    v_add_f32 v49, v49, v53
    v_add_f32 v50, v50, v54
    v_add_f32 v51, v51, v55
    v_add_f32 v48, v48, v90
    v_add_f32 v49, v49, v90
    v_add_f32 v50, v50, v90
    v_add_f32 v51, v51, v90
    v_lshlrev_b32 v52, 16, v88
    v_and_b32 v53, 0xffff0000, v88
    v_lshlrev_b32 v54, 16, v89
    v_and_b32 v55, 0xffff0000, v89
    v_mul_f32 v48, v48, v52
    v_mul_f32 v49, v49, v53
    v_mul_f32 v50, v50, v54
    v_mul_f32 v51, v51, v55
    v_cvt_pk_bf16_f32 v48, v48, v49
    v_cvt_pk_bf16_f32 v49, v50, v51
    s_add_u32 s59, s58, 8
    s_lshr_b32 s64, s59, 1
    s_lshl_b32 s64, s64, 10
    s_and_b32 s59, s59, 1
    s_lshl_b32 s59, s59, 3
    s_add_u32 s59, s59, s64
    s_add_u32 s59, s59, s57
    buffer_store_dwordx2 v[48:49], v8, s[20:23], s59 offen
    s_branch g4_kernel_end4
g4_kernel_hi3:
    s_nop 7
    v_accvgpr_read_b32 v16, a0
    v_accvgpr_read_b32 v17, a1
    v_accvgpr_read_b32 v18, a2
    v_accvgpr_read_b32 v19, a3
    ds_write_b128 v1, v[16:19] offset:0
    v_accvgpr_read_b32 v20, a4
    v_accvgpr_read_b32 v21, a5
    v_accvgpr_read_b32 v22, a6
    v_accvgpr_read_b32 v23, a7
    ds_write_b128 v1, v[20:23] offset:1024
    v_accvgpr_read_b32 v24, a8
    v_accvgpr_read_b32 v25, a9
    v_accvgpr_read_b32 v26, a10
    v_accvgpr_read_b32 v27, a11
    ds_write_b128 v1, v[24:27] offset:2048
    v_accvgpr_read_b32 v28, a12
    v_accvgpr_read_b32 v29, a13
    v_accvgpr_read_b32 v30, a14
    v_accvgpr_read_b32 v31, a15
    ds_write_b128 v1, v[28:31] offset:3072
    v_accvgpr_read_b32 v32, a16
    v_accvgpr_read_b32 v33, a17
    v_accvgpr_read_b32 v34, a18
    v_accvgpr_read_b32 v35, a19
    ds_write_b128 v1, v[32:35] offset:4096
    v_accvgpr_read_b32 v36, a20
    v_accvgpr_read_b32 v37, a21
    v_accvgpr_read_b32 v38, a22
    v_accvgpr_read_b32 v39, a23
    ds_write_b128 v1, v[36:39] offset:5120
    v_accvgpr_read_b32 v40, a24
    v_accvgpr_read_b32 v41, a25
    v_accvgpr_read_b32 v42, a26
    v_accvgpr_read_b32 v43, a27
    ds_write_b128 v1, v[40:43] offset:6144
    v_accvgpr_read_b32 v44, a28
    v_accvgpr_read_b32 v45, a29
    v_accvgpr_read_b32 v46, a30
    v_accvgpr_read_b32 v47, a31
    ds_write_b128 v1, v[44:47] offset:7168
    v_accvgpr_read_b32 v48, a32
    v_accvgpr_read_b32 v49, a33
    v_accvgpr_read_b32 v50, a34
    v_accvgpr_read_b32 v51, a35
    ds_write_b128 v1, v[48:51] offset:8192
    s_waitcnt lgkmcnt(0)
    s_barrier
    s_lshr_b32 s57, s48, 4
    s_mul_i32 s57, s57, 73728
    s_lshr_b32 s58, s53, 4
    s_waitcnt vmcnt(0)
    v_lshlrev_b32 v90, 16, v90
    ds_read_b128 v[16:19], v4 offset:0
    ds_read_b128 v[20:23], v4 offset:1024
    ds_read_b128 v[24:27], v4 offset:2048
    ds_read_b128 v[28:31], v4 offset:3072
    ds_read_b128 v[32:35], v4 offset:4096
    ds_read_b128 v[36:39], v4 offset:5120
    ds_read_b128 v[40:43], v4 offset:6144
    ds_read_b128 v[44:47], v4 offset:7168
    ds_read_b128 v[48:51], v4 offset:8192
    v_accvgpr_read_b32 v52, a36
    v_accvgpr_read_b32 v53, a37
    v_accvgpr_read_b32 v54, a38
    v_accvgpr_read_b32 v55, a39
    s_waitcnt lgkmcnt(8)
    v_add_f32 v16, v16, v52
    v_add_f32 v17, v17, v53
    v_add_f32 v18, v18, v54
    v_add_f32 v19, v19, v55
    v_add_f32 v16, v16, v90
    v_add_f32 v17, v17, v90
    v_add_f32 v18, v18, v90
    v_add_f32 v19, v19, v90
    v_lshlrev_b32 v52, 16, v72
    v_and_b32 v53, 0xffff0000, v72
    v_lshlrev_b32 v54, 16, v73
    v_and_b32 v55, 0xffff0000, v73
    v_mul_f32 v16, v16, v52
    v_mul_f32 v17, v17, v53
    v_mul_f32 v18, v18, v54
    v_mul_f32 v19, v19, v55
    v_cvt_pk_bf16_f32 v16, v16, v17
    v_cvt_pk_bf16_f32 v17, v18, v19
    s_add_u32 s59, s58, 0
    s_lshr_b32 s64, s59, 1
    s_lshl_b32 s64, s64, 10
    s_and_b32 s59, s59, 1
    s_lshl_b32 s59, s59, 3
    s_add_u32 s59, s59, s64
    s_add_u32 s59, s59, s57
    buffer_store_dwordx2 v[16:17], v8, s[20:23], s59 offen
    v_accvgpr_read_b32 v60, a40
    v_accvgpr_read_b32 v61, a41
    v_accvgpr_read_b32 v62, a42
    v_accvgpr_read_b32 v63, a43
    s_waitcnt lgkmcnt(7)
    v_add_f32 v20, v20, v60
    v_add_f32 v21, v21, v61
    v_add_f32 v22, v22, v62
    v_add_f32 v23, v23, v63
    v_add_f32 v20, v20, v90
    v_add_f32 v21, v21, v90
    v_add_f32 v22, v22, v90
    v_add_f32 v23, v23, v90
    v_lshlrev_b32 v60, 16, v74
    v_and_b32 v61, 0xffff0000, v74
    v_lshlrev_b32 v62, 16, v75
    v_and_b32 v63, 0xffff0000, v75
    v_mul_f32 v20, v20, v60
    v_mul_f32 v21, v21, v61
    v_mul_f32 v22, v22, v62
    v_mul_f32 v23, v23, v63
    v_cvt_pk_bf16_f32 v20, v20, v21
    v_cvt_pk_bf16_f32 v21, v22, v23
    s_add_u32 s59, s58, 1
    s_lshr_b32 s64, s59, 1
    s_lshl_b32 s64, s64, 10
    s_and_b32 s59, s59, 1
    s_lshl_b32 s59, s59, 3
    s_add_u32 s59, s59, s64
    s_add_u32 s59, s59, s57
    buffer_store_dwordx2 v[20:21], v8, s[20:23], s59 offen
    v_accvgpr_read_b32 v52, a44
    v_accvgpr_read_b32 v53, a45
    v_accvgpr_read_b32 v54, a46
    v_accvgpr_read_b32 v55, a47
    s_waitcnt lgkmcnt(6)
    v_add_f32 v24, v24, v52
    v_add_f32 v25, v25, v53
    v_add_f32 v26, v26, v54
    v_add_f32 v27, v27, v55
    v_add_f32 v24, v24, v90
    v_add_f32 v25, v25, v90
    v_add_f32 v26, v26, v90
    v_add_f32 v27, v27, v90
    v_lshlrev_b32 v52, 16, v76
    v_and_b32 v53, 0xffff0000, v76
    v_lshlrev_b32 v54, 16, v77
    v_and_b32 v55, 0xffff0000, v77
    v_mul_f32 v24, v24, v52
    v_mul_f32 v25, v25, v53
    v_mul_f32 v26, v26, v54
    v_mul_f32 v27, v27, v55
    v_cvt_pk_bf16_f32 v24, v24, v25
    v_cvt_pk_bf16_f32 v25, v26, v27
    s_add_u32 s59, s58, 2
    s_lshr_b32 s64, s59, 1
    s_lshl_b32 s64, s64, 10
    s_and_b32 s59, s59, 1
    s_lshl_b32 s59, s59, 3
    s_add_u32 s59, s59, s64
    s_add_u32 s59, s59, s57
    buffer_store_dwordx2 v[24:25], v8, s[20:23], s59 offen
    v_accvgpr_read_b32 v60, a48
    v_accvgpr_read_b32 v61, a49
    v_accvgpr_read_b32 v62, a50
    v_accvgpr_read_b32 v63, a51
    s_waitcnt lgkmcnt(5)
    v_add_f32 v28, v28, v60
    v_add_f32 v29, v29, v61
    v_add_f32 v30, v30, v62
    v_add_f32 v31, v31, v63
    v_add_f32 v28, v28, v90
    v_add_f32 v29, v29, v90
    v_add_f32 v30, v30, v90
    v_add_f32 v31, v31, v90
    v_lshlrev_b32 v60, 16, v78
    v_and_b32 v61, 0xffff0000, v78
    v_lshlrev_b32 v62, 16, v79
    v_and_b32 v63, 0xffff0000, v79
    v_mul_f32 v28, v28, v60
    v_mul_f32 v29, v29, v61
    v_mul_f32 v30, v30, v62
    v_mul_f32 v31, v31, v63
    v_cvt_pk_bf16_f32 v28, v28, v29
    v_cvt_pk_bf16_f32 v29, v30, v31
    s_add_u32 s59, s58, 3
    s_lshr_b32 s64, s59, 1
    s_lshl_b32 s64, s64, 10
    s_and_b32 s59, s59, 1
    s_lshl_b32 s59, s59, 3
    s_add_u32 s59, s59, s64
    s_add_u32 s59, s59, s57
    buffer_store_dwordx2 v[28:29], v8, s[20:23], s59 offen
    v_accvgpr_read_b32 v52, a52
    v_accvgpr_read_b32 v53, a53
    v_accvgpr_read_b32 v54, a54
    v_accvgpr_read_b32 v55, a55
    s_waitcnt lgkmcnt(4)
    v_add_f32 v32, v32, v52
    v_add_f32 v33, v33, v53
    v_add_f32 v34, v34, v54
    v_add_f32 v35, v35, v55
    v_add_f32 v32, v32, v90
    v_add_f32 v33, v33, v90
    v_add_f32 v34, v34, v90
    v_add_f32 v35, v35, v90
    v_lshlrev_b32 v52, 16, v80
    v_and_b32 v53, 0xffff0000, v80
    v_lshlrev_b32 v54, 16, v81
    v_and_b32 v55, 0xffff0000, v81
    v_mul_f32 v32, v32, v52
    v_mul_f32 v33, v33, v53
    v_mul_f32 v34, v34, v54
    v_mul_f32 v35, v35, v55
    v_cvt_pk_bf16_f32 v32, v32, v33
    v_cvt_pk_bf16_f32 v33, v34, v35
    s_add_u32 s59, s58, 4
    s_lshr_b32 s64, s59, 1
    s_lshl_b32 s64, s64, 10
    s_and_b32 s59, s59, 1
    s_lshl_b32 s59, s59, 3
    s_add_u32 s59, s59, s64
    s_add_u32 s59, s59, s57
    buffer_store_dwordx2 v[32:33], v8, s[20:23], s59 offen
    v_accvgpr_read_b32 v60, a56
    v_accvgpr_read_b32 v61, a57
    v_accvgpr_read_b32 v62, a58
    v_accvgpr_read_b32 v63, a59
    s_waitcnt lgkmcnt(3)
    v_add_f32 v36, v36, v60
    v_add_f32 v37, v37, v61
    v_add_f32 v38, v38, v62
    v_add_f32 v39, v39, v63
    v_add_f32 v36, v36, v90
    v_add_f32 v37, v37, v90
    v_add_f32 v38, v38, v90
    v_add_f32 v39, v39, v90
    v_lshlrev_b32 v60, 16, v82
    v_and_b32 v61, 0xffff0000, v82
    v_lshlrev_b32 v62, 16, v83
    v_and_b32 v63, 0xffff0000, v83
    v_mul_f32 v36, v36, v60
    v_mul_f32 v37, v37, v61
    v_mul_f32 v38, v38, v62
    v_mul_f32 v39, v39, v63
    v_cvt_pk_bf16_f32 v36, v36, v37
    v_cvt_pk_bf16_f32 v37, v38, v39
    s_add_u32 s59, s58, 5
    s_lshr_b32 s64, s59, 1
    s_lshl_b32 s64, s64, 10
    s_and_b32 s59, s59, 1
    s_lshl_b32 s59, s59, 3
    s_add_u32 s59, s59, s64
    s_add_u32 s59, s59, s57
    buffer_store_dwordx2 v[36:37], v8, s[20:23], s59 offen
    v_accvgpr_read_b32 v52, a60
    v_accvgpr_read_b32 v53, a61
    v_accvgpr_read_b32 v54, a62
    v_accvgpr_read_b32 v55, a63
    s_waitcnt lgkmcnt(2)
    v_add_f32 v40, v40, v52
    v_add_f32 v41, v41, v53
    v_add_f32 v42, v42, v54
    v_add_f32 v43, v43, v55
    v_add_f32 v40, v40, v90
    v_add_f32 v41, v41, v90
    v_add_f32 v42, v42, v90
    v_add_f32 v43, v43, v90
    v_lshlrev_b32 v52, 16, v84
    v_and_b32 v53, 0xffff0000, v84
    v_lshlrev_b32 v54, 16, v85
    v_and_b32 v55, 0xffff0000, v85
    v_mul_f32 v40, v40, v52
    v_mul_f32 v41, v41, v53
    v_mul_f32 v42, v42, v54
    v_mul_f32 v43, v43, v55
    v_cvt_pk_bf16_f32 v40, v40, v41
    v_cvt_pk_bf16_f32 v41, v42, v43
    s_add_u32 s59, s58, 6
    s_lshr_b32 s64, s59, 1
    s_lshl_b32 s64, s64, 10
    s_and_b32 s59, s59, 1
    s_lshl_b32 s59, s59, 3
    s_add_u32 s59, s59, s64
    s_add_u32 s59, s59, s57
    buffer_store_dwordx2 v[40:41], v8, s[20:23], s59 offen
    v_accvgpr_read_b32 v60, a64
    v_accvgpr_read_b32 v61, a65
    v_accvgpr_read_b32 v62, a66
    v_accvgpr_read_b32 v63, a67
    s_waitcnt lgkmcnt(1)
    v_add_f32 v44, v44, v60
    v_add_f32 v45, v45, v61
    v_add_f32 v46, v46, v62
    v_add_f32 v47, v47, v63
    v_add_f32 v44, v44, v90
    v_add_f32 v45, v45, v90
    v_add_f32 v46, v46, v90
    v_add_f32 v47, v47, v90
    v_lshlrev_b32 v60, 16, v86
    v_and_b32 v61, 0xffff0000, v86
    v_lshlrev_b32 v62, 16, v87
    v_and_b32 v63, 0xffff0000, v87
    v_mul_f32 v44, v44, v60
    v_mul_f32 v45, v45, v61
    v_mul_f32 v46, v46, v62
    v_mul_f32 v47, v47, v63
    v_cvt_pk_bf16_f32 v44, v44, v45
    v_cvt_pk_bf16_f32 v45, v46, v47
    s_add_u32 s59, s58, 7
    s_lshr_b32 s64, s59, 1
    s_lshl_b32 s64, s64, 10
    s_and_b32 s59, s59, 1
    s_lshl_b32 s59, s59, 3
    s_add_u32 s59, s59, s64
    s_add_u32 s59, s59, s57
    buffer_store_dwordx2 v[44:45], v8, s[20:23], s59 offen
    v_accvgpr_read_b32 v52, a68
    v_accvgpr_read_b32 v53, a69
    v_accvgpr_read_b32 v54, a70
    v_accvgpr_read_b32 v55, a71
    s_waitcnt lgkmcnt(0)
    v_add_f32 v48, v48, v52
    v_add_f32 v49, v49, v53
    v_add_f32 v50, v50, v54
    v_add_f32 v51, v51, v55
    v_add_f32 v48, v48, v90
    v_add_f32 v49, v49, v90
    v_add_f32 v50, v50, v90
    v_add_f32 v51, v51, v90
    v_lshlrev_b32 v52, 16, v88
    v_and_b32 v53, 0xffff0000, v88
    v_lshlrev_b32 v54, 16, v89
    v_and_b32 v55, 0xffff0000, v89
    v_mul_f32 v48, v48, v52
    v_mul_f32 v49, v49, v53
    v_mul_f32 v50, v50, v54
    v_mul_f32 v51, v51, v55
    v_cvt_pk_bf16_f32 v48, v48, v49
    v_cvt_pk_bf16_f32 v49, v50, v51
    s_add_u32 s59, s58, 8
    s_lshr_b32 s64, s59, 1
    s_lshl_b32 s64, s64, 10
    s_and_b32 s59, s59, 1
    s_lshl_b32 s59, s59, 3
    s_add_u32 s59, s59, s64
    s_add_u32 s59, s59, s57
    buffer_store_dwordx2 v[48:49], v8, s[20:23], s59 offen
g4_kernel_end4:
g4_kernel_done1:
    s_endpgm
.globl g5_kernel
.type g5_kernel,@function
.p2align 8
g5_kernel:
    s_cmp_ge_u32 s2, 256
    s_cbranch_scc1 g5_kernel_done1
    s_load_dwordx2 s[4:5], s[0:1], 112
    s_load_dwordx2 s[6:7], s[0:1], 96
    s_and_b32 s40, s2, 7
    s_lshr_b32 s41, s2, 3
    s_lshl_b32 s42, s40, 2
    s_and_b32 s43, s41, 3
    s_add_u32 s42, s42, s43
    s_lshr_b32 s43, s41, 2
    s_mul_i32 s44, s43, 5
    s_lshl_b32 s46, s43, 2
    s_add_u32 s46, s46, 4
    s_cmp_lt_u32 s43, 4
    s_cselect_b32 s44, s44, s46
    s_cselect_b32 s47, 5, 4
    v_lshrrev_b32 v1, 6, v0
    v_and_b32 v2, 63, v0
    v_readfirstlane_b32 s45, v1
    v_lshlrev_b32 v8, 4, v2
    v_add_u32 v9, 73728, v8
    v_add_u32 v10, 147456, v8
    v_add_u32 v11, 221184, v8
    v_add_u32 v12, 4096, v8
    s_mul_i32 s51, s42, 294912
    s_lshl_b32 s53, s45, 10
    s_add_u32 s51, s51, s53
    s_mul_i32 s52, s45, 36864
    s_lshl_b32 s53, s44, 10
    s_add_u32 s52, s52, s53
    s_waitcnt lgkmcnt(0)
    s_add_u32 s12, s4, 0x43d0000
    s_addc_u32 s13, s5, 0
    s_mov_b32 s14, 0x900000
    s_mov_b32 s15, 0x00020000
    s_add_u32 s16, s4, 0x84e0000
    s_addc_u32 s17, s5, 0
    s_mov_b32 s18, 0x288000
    s_mov_b32 s19, 0x00020000
    buffer_load_dwordx4 v[16:19], v8, s[12:15], s51 offen
    buffer_load_dwordx4 v[20:23], v9, s[12:15], s51 offen
    buffer_load_dwordx4 v[24:27], v10, s[12:15], s51 offen
    buffer_load_dwordx4 v[28:31], v11, s[12:15], s51 offen
    s_add_u32 s51, s51, 8192
    buffer_load_dwordx4 v[32:35], v8, s[16:19], s52 offen offset:0
    buffer_load_dwordx4 v[36:39], v8, s[16:19], s52 offen offset:1024
    buffer_load_dwordx4 v[40:43], v8, s[16:19], s52 offen offset:2048
    buffer_load_dwordx4 v[44:47], v8, s[16:19], s52 offen offset:3072
    buffer_load_dwordx4 v[48:51], v12, s[16:19], s52 offen offset:0
    s_add_u32 s52, s52, 294912
    buffer_load_dwordx4 v[52:55], v8, s[12:15], s51 offen
    buffer_load_dwordx4 v[56:59], v9, s[12:15], s51 offen
    buffer_load_dwordx4 v[60:63], v10, s[12:15], s51 offen
    buffer_load_dwordx4 v[64:67], v11, s[12:15], s51 offen
    s_add_u32 s51, s51, 8192
    buffer_load_dwordx4 v[68:71], v8, s[16:19], s52 offen offset:0
    buffer_load_dwordx4 v[72:75], v8, s[16:19], s52 offen offset:1024
    buffer_load_dwordx4 v[76:79], v8, s[16:19], s52 offen offset:2048
    buffer_load_dwordx4 v[80:83], v8, s[16:19], s52 offen offset:3072
    buffer_load_dwordx4 v[84:87], v12, s[16:19], s52 offen offset:0
    s_add_u32 s52, s52, 294912
    v_accvgpr_write_b32 a0, 0
    v_accvgpr_write_b32 a1, 0
    v_accvgpr_write_b32 a2, 0
    v_accvgpr_write_b32 a3, 0
    v_accvgpr_write_b32 a4, 0
    v_accvgpr_write_b32 a5, 0
    v_accvgpr_write_b32 a6, 0
    v_accvgpr_write_b32 a7, 0
    v_accvgpr_write_b32 a8, 0
    v_accvgpr_write_b32 a9, 0
    v_accvgpr_write_b32 a10, 0
    v_accvgpr_write_b32 a11, 0
    v_accvgpr_write_b32 a12, 0
    v_accvgpr_write_b32 a13, 0
    v_accvgpr_write_b32 a14, 0
    v_accvgpr_write_b32 a15, 0
    v_accvgpr_write_b32 a16, 0
    v_accvgpr_write_b32 a17, 0
    v_accvgpr_write_b32 a18, 0
    v_accvgpr_write_b32 a19, 0
    v_accvgpr_write_b32 a20, 0
    v_accvgpr_write_b32 a21, 0
    v_accvgpr_write_b32 a22, 0
    v_accvgpr_write_b32 a23, 0
    v_accvgpr_write_b32 a24, 0
    v_accvgpr_write_b32 a25, 0
    v_accvgpr_write_b32 a26, 0
    v_accvgpr_write_b32 a27, 0
    v_accvgpr_write_b32 a28, 0
    v_accvgpr_write_b32 a29, 0
    v_accvgpr_write_b32 a30, 0
    v_accvgpr_write_b32 a31, 0
    v_accvgpr_write_b32 a32, 0
    v_accvgpr_write_b32 a33, 0
    v_accvgpr_write_b32 a34, 0
    v_accvgpr_write_b32 a35, 0
    v_accvgpr_write_b32 a36, 0
    v_accvgpr_write_b32 a37, 0
    v_accvgpr_write_b32 a38, 0
    v_accvgpr_write_b32 a39, 0
    v_accvgpr_write_b32 a40, 0
    v_accvgpr_write_b32 a41, 0
    v_accvgpr_write_b32 a42, 0
    v_accvgpr_write_b32 a43, 0
    v_accvgpr_write_b32 a44, 0
    v_accvgpr_write_b32 a45, 0
    v_accvgpr_write_b32 a46, 0
    v_accvgpr_write_b32 a47, 0
    v_accvgpr_write_b32 a48, 0
    v_accvgpr_write_b32 a49, 0
    v_accvgpr_write_b32 a50, 0
    v_accvgpr_write_b32 a51, 0
    v_accvgpr_write_b32 a52, 0
    v_accvgpr_write_b32 a53, 0
    v_accvgpr_write_b32 a54, 0
    v_accvgpr_write_b32 a55, 0
    v_accvgpr_write_b32 a56, 0
    v_accvgpr_write_b32 a57, 0
    v_accvgpr_write_b32 a58, 0
    v_accvgpr_write_b32 a59, 0
    v_accvgpr_write_b32 a60, 0
    v_accvgpr_write_b32 a61, 0
    v_accvgpr_write_b32 a62, 0
    v_accvgpr_write_b32 a63, 0
    v_accvgpr_write_b32 a64, 0
    v_accvgpr_write_b32 a65, 0
    v_accvgpr_write_b32 a66, 0
    v_accvgpr_write_b32 a67, 0
    v_accvgpr_write_b32 a68, 0
    v_accvgpr_write_b32 a69, 0
    v_accvgpr_write_b32 a70, 0
    v_accvgpr_write_b32 a71, 0
    v_accvgpr_write_b32 a72, 0
    v_accvgpr_write_b32 a73, 0
    v_accvgpr_write_b32 a74, 0
    v_accvgpr_write_b32 a75, 0
    v_accvgpr_write_b32 a76, 0
    v_accvgpr_write_b32 a77, 0
    v_accvgpr_write_b32 a78, 0
    v_accvgpr_write_b32 a79, 0
    s_add_u32 s20, s4, 0x2450000
    s_addc_u32 s21, s5, 0
    s_mov_b32 s22, 0x240000
    s_mov_b32 s23, 0x00020000
    s_add_u32 s24, s4, 0x0
    s_addc_u32 s25, s5, 0
    s_mov_b32 s26, 0x8000
    s_mov_b32 s27, 0x00020000
    s_mov_b32 s28, s6
    s_mov_b32 s29, s7
    s_mov_b32 s30, 0x240000
    s_mov_b32 s31, 0x00020000
    s_waitcnt vmcnt(13)
    v_mfma_f32_16x16x32_bf16 a[0:3], v[32:35], v[16:19], a[0:3]
    v_mfma_f32_16x16x32_bf16 a[20:23], v[32:35], v[20:23], a[20:23]
    buffer_load_dwordx4 v[88:91], v8, s[12:15], s51 offen
    v_mfma_f32_16x16x32_bf16 a[40:43], v[32:35], v[24:27], a[40:43]
    v_mfma_f32_16x16x32_bf16 a[60:63], v[32:35], v[28:31], a[60:63]
    buffer_load_dwordx4 v[92:95], v9, s[12:15], s51 offen
    s_waitcnt vmcnt(14)
    v_mfma_f32_16x16x32_bf16 a[4:7], v[36:39], v[16:19], a[4:7]
    v_mfma_f32_16x16x32_bf16 a[24:27], v[36:39], v[20:23], a[24:27]
    buffer_load_dwordx4 v[96:99], v10, s[12:15], s51 offen
    v_mfma_f32_16x16x32_bf16 a[44:47], v[36:39], v[24:27], a[44:47]
    v_mfma_f32_16x16x32_bf16 a[64:67], v[36:39], v[28:31], a[64:67]
    buffer_load_dwordx4 v[100:103], v11, s[12:15], s51 offen
    s_add_u32 s51, s51, 8192
    s_waitcnt vmcnt(15)
    v_mfma_f32_16x16x32_bf16 a[8:11], v[40:43], v[16:19], a[8:11]
    v_mfma_f32_16x16x32_bf16 a[28:31], v[40:43], v[20:23], a[28:31]
    buffer_load_dwordx4 v[104:107], v8, s[16:19], s52 offen offset:0
    v_mfma_f32_16x16x32_bf16 a[48:51], v[40:43], v[24:27], a[48:51]
    v_mfma_f32_16x16x32_bf16 a[68:71], v[40:43], v[28:31], a[68:71]
    buffer_load_dwordx4 v[108:111], v8, s[16:19], s52 offen offset:1024
    s_waitcnt vmcnt(16)
    v_mfma_f32_16x16x32_bf16 a[12:15], v[44:47], v[16:19], a[12:15]
    v_mfma_f32_16x16x32_bf16 a[32:35], v[44:47], v[20:23], a[32:35]
    buffer_load_dwordx4 v[112:115], v8, s[16:19], s52 offen offset:2048
    v_mfma_f32_16x16x32_bf16 a[52:55], v[44:47], v[24:27], a[52:55]
    v_mfma_f32_16x16x32_bf16 a[72:75], v[44:47], v[28:31], a[72:75]
    buffer_load_dwordx4 v[116:119], v8, s[16:19], s52 offen offset:3072
    s_waitcnt vmcnt(17)
    v_mfma_f32_16x16x32_bf16 a[16:19], v[48:51], v[16:19], a[16:19]
    v_mfma_f32_16x16x32_bf16 a[36:39], v[48:51], v[20:23], a[36:39]
    buffer_load_dwordx4 v[120:123], v12, s[16:19], s52 offen offset:0
    s_add_u32 s52, s52, 294912
    v_mfma_f32_16x16x32_bf16 a[56:59], v[48:51], v[24:27], a[56:59]
    v_mfma_f32_16x16x32_bf16 a[76:79], v[48:51], v[28:31], a[76:79]
    s_waitcnt vmcnt(13)
    v_mfma_f32_16x16x32_bf16 a[0:3], v[68:71], v[52:55], a[0:3]
    v_mfma_f32_16x16x32_bf16 a[20:23], v[68:71], v[56:59], a[20:23]
    buffer_load_dwordx4 v[16:19], v8, s[12:15], s51 offen
    v_mfma_f32_16x16x32_bf16 a[40:43], v[68:71], v[60:63], a[40:43]
    v_mfma_f32_16x16x32_bf16 a[60:63], v[68:71], v[64:67], a[60:63]
    buffer_load_dwordx4 v[20:23], v9, s[12:15], s51 offen
    s_waitcnt vmcnt(14)
    v_mfma_f32_16x16x32_bf16 a[4:7], v[72:75], v[52:55], a[4:7]
    v_mfma_f32_16x16x32_bf16 a[24:27], v[72:75], v[56:59], a[24:27]
    buffer_load_dwordx4 v[24:27], v10, s[12:15], s51 offen
    v_mfma_f32_16x16x32_bf16 a[44:47], v[72:75], v[60:63], a[44:47]
    v_mfma_f32_16x16x32_bf16 a[64:67], v[72:75], v[64:67], a[64:67]
    buffer_load_dwordx4 v[28:31], v11, s[12:15], s51 offen
    s_add_u32 s51, s51, 8192
    s_waitcnt vmcnt(15)
    v_mfma_f32_16x16x32_bf16 a[8:11], v[76:79], v[52:55], a[8:11]
    v_mfma_f32_16x16x32_bf16 a[28:31], v[76:79], v[56:59], a[28:31]
    buffer_load_dwordx4 v[32:35], v8, s[16:19], s52 offen offset:0
    v_mfma_f32_16x16x32_bf16 a[48:51], v[76:79], v[60:63], a[48:51]
    v_mfma_f32_16x16x32_bf16 a[68:71], v[76:79], v[64:67], a[68:71]
    buffer_load_dwordx4 v[36:39], v8, s[16:19], s52 offen offset:1024
    s_waitcnt vmcnt(16)
    v_mfma_f32_16x16x32_bf16 a[12:15], v[80:83], v[52:55], a[12:15]
    v_mfma_f32_16x16x32_bf16 a[32:35], v[80:83], v[56:59], a[32:35]
    buffer_load_dwordx4 v[40:43], v8, s[16:19], s52 offen offset:2048
    v_mfma_f32_16x16x32_bf16 a[52:55], v[80:83], v[60:63], a[52:55]
    v_mfma_f32_16x16x32_bf16 a[72:75], v[80:83], v[64:67], a[72:75]
    buffer_load_dwordx4 v[44:47], v8, s[16:19], s52 offen offset:3072
    s_waitcnt vmcnt(17)
    v_mfma_f32_16x16x32_bf16 a[16:19], v[84:87], v[52:55], a[16:19]
    v_mfma_f32_16x16x32_bf16 a[36:39], v[84:87], v[56:59], a[36:39]
    buffer_load_dwordx4 v[48:51], v12, s[16:19], s52 offen offset:0
    s_add_u32 s52, s52, 294912
    v_mfma_f32_16x16x32_bf16 a[56:59], v[84:87], v[60:63], a[56:59]
    v_mfma_f32_16x16x32_bf16 a[76:79], v[84:87], v[64:67], a[76:79]
    s_waitcnt vmcnt(13)
    v_mfma_f32_16x16x32_bf16 a[0:3], v[104:107], v[88:91], a[0:3]
    v_mfma_f32_16x16x32_bf16 a[20:23], v[104:107], v[92:95], a[20:23]
    buffer_load_dwordx4 v[52:55], v8, s[12:15], s51 offen
    v_mfma_f32_16x16x32_bf16 a[40:43], v[104:107], v[96:99], a[40:43]
    v_mfma_f32_16x16x32_bf16 a[60:63], v[104:107], v[100:103], a[60:63]
    buffer_load_dwordx4 v[56:59], v9, s[12:15], s51 offen
    s_waitcnt vmcnt(14)
    v_mfma_f32_16x16x32_bf16 a[4:7], v[108:111], v[88:91], a[4:7]
    v_mfma_f32_16x16x32_bf16 a[24:27], v[108:111], v[92:95], a[24:27]
    buffer_load_dwordx4 v[60:63], v10, s[12:15], s51 offen
    v_mfma_f32_16x16x32_bf16 a[44:47], v[108:111], v[96:99], a[44:47]
    v_mfma_f32_16x16x32_bf16 a[64:67], v[108:111], v[100:103], a[64:67]
    buffer_load_dwordx4 v[64:67], v11, s[12:15], s51 offen
    s_add_u32 s51, s51, 8192
    s_waitcnt vmcnt(15)
    v_mfma_f32_16x16x32_bf16 a[8:11], v[112:115], v[88:91], a[8:11]
    v_mfma_f32_16x16x32_bf16 a[28:31], v[112:115], v[92:95], a[28:31]
    buffer_load_dwordx4 v[68:71], v8, s[16:19], s52 offen offset:0
    v_mfma_f32_16x16x32_bf16 a[48:51], v[112:115], v[96:99], a[48:51]
    v_mfma_f32_16x16x32_bf16 a[68:71], v[112:115], v[100:103], a[68:71]
    buffer_load_dwordx4 v[72:75], v8, s[16:19], s52 offen offset:1024
    s_waitcnt vmcnt(16)
    v_mfma_f32_16x16x32_bf16 a[12:15], v[116:119], v[88:91], a[12:15]
    v_mfma_f32_16x16x32_bf16 a[32:35], v[116:119], v[92:95], a[32:35]
    buffer_load_dwordx4 v[76:79], v8, s[16:19], s52 offen offset:2048
    v_mfma_f32_16x16x32_bf16 a[52:55], v[116:119], v[96:99], a[52:55]
    v_mfma_f32_16x16x32_bf16 a[72:75], v[116:119], v[100:103], a[72:75]
    buffer_load_dwordx4 v[80:83], v8, s[16:19], s52 offen offset:3072
    s_waitcnt vmcnt(17)
    v_mfma_f32_16x16x32_bf16 a[16:19], v[120:123], v[88:91], a[16:19]
    v_mfma_f32_16x16x32_bf16 a[36:39], v[120:123], v[92:95], a[36:39]
    buffer_load_dwordx4 v[84:87], v12, s[16:19], s52 offen offset:0
    s_add_u32 s52, s52, 294912
    v_mfma_f32_16x16x32_bf16 a[56:59], v[120:123], v[96:99], a[56:59]
    v_mfma_f32_16x16x32_bf16 a[76:79], v[120:123], v[100:103], a[76:79]
    s_waitcnt vmcnt(13)
    v_mfma_f32_16x16x32_bf16 a[0:3], v[32:35], v[16:19], a[0:3]
    v_mfma_f32_16x16x32_bf16 a[20:23], v[32:35], v[20:23], a[20:23]
    buffer_load_dwordx4 v[88:91], v8, s[12:15], s51 offen
    v_mfma_f32_16x16x32_bf16 a[40:43], v[32:35], v[24:27], a[40:43]
    v_mfma_f32_16x16x32_bf16 a[60:63], v[32:35], v[28:31], a[60:63]
    buffer_load_dwordx4 v[92:95], v9, s[12:15], s51 offen
    s_waitcnt vmcnt(14)
    v_mfma_f32_16x16x32_bf16 a[4:7], v[36:39], v[16:19], a[4:7]
    v_mfma_f32_16x16x32_bf16 a[24:27], v[36:39], v[20:23], a[24:27]
    buffer_load_dwordx4 v[96:99], v10, s[12:15], s51 offen
    v_mfma_f32_16x16x32_bf16 a[44:47], v[36:39], v[24:27], a[44:47]
    v_mfma_f32_16x16x32_bf16 a[64:67], v[36:39], v[28:31], a[64:67]
    buffer_load_dwordx4 v[100:103], v11, s[12:15], s51 offen
    s_add_u32 s51, s51, 8192
    s_waitcnt vmcnt(15)
    v_mfma_f32_16x16x32_bf16 a[8:11], v[40:43], v[16:19], a[8:11]
    v_mfma_f32_16x16x32_bf16 a[28:31], v[40:43], v[20:23], a[28:31]
    buffer_load_dwordx4 v[104:107], v8, s[16:19], s52 offen offset:0
    v_mfma_f32_16x16x32_bf16 a[48:51], v[40:43], v[24:27], a[48:51]
    v_mfma_f32_16x16x32_bf16 a[68:71], v[40:43], v[28:31], a[68:71]
    buffer_load_dwordx4 v[108:111], v8, s[16:19], s52 offen offset:1024
    s_waitcnt vmcnt(16)
    v_mfma_f32_16x16x32_bf16 a[12:15], v[44:47], v[16:19], a[12:15]
    v_mfma_f32_16x16x32_bf16 a[32:35], v[44:47], v[20:23], a[32:35]
    buffer_load_dwordx4 v[112:115], v8, s[16:19], s52 offen offset:2048
    v_mfma_f32_16x16x32_bf16 a[52:55], v[44:47], v[24:27], a[52:55]
    v_mfma_f32_16x16x32_bf16 a[72:75], v[44:47], v[28:31], a[72:75]
    buffer_load_dwordx4 v[116:119], v8, s[16:19], s52 offen offset:3072
    s_waitcnt vmcnt(17)
    v_mfma_f32_16x16x32_bf16 a[16:19], v[48:51], v[16:19], a[16:19]
    v_mfma_f32_16x16x32_bf16 a[36:39], v[48:51], v[20:23], a[36:39]
    buffer_load_dwordx4 v[120:123], v12, s[16:19], s52 offen offset:0
    s_add_u32 s52, s52, 294912
    v_mfma_f32_16x16x32_bf16 a[56:59], v[48:51], v[24:27], a[56:59]
    v_mfma_f32_16x16x32_bf16 a[76:79], v[48:51], v[28:31], a[76:79]
    s_waitcnt vmcnt(13)
    v_mfma_f32_16x16x32_bf16 a[0:3], v[68:71], v[52:55], a[0:3]
    v_mfma_f32_16x16x32_bf16 a[20:23], v[68:71], v[56:59], a[20:23]
    buffer_load_dwordx4 v[16:19], v8, s[12:15], s51 offen
    v_mfma_f32_16x16x32_bf16 a[40:43], v[68:71], v[60:63], a[40:43]
    v_mfma_f32_16x16x32_bf16 a[60:63], v[68:71], v[64:67], a[60:63]
    buffer_load_dwordx4 v[20:23], v9, s[12:15], s51 offen
    s_waitcnt vmcnt(14)
    v_mfma_f32_16x16x32_bf16 a[4:7], v[72:75], v[52:55], a[4:7]
    v_mfma_f32_16x16x32_bf16 a[24:27], v[72:75], v[56:59], a[24:27]
    buffer_load_dwordx4 v[24:27], v10, s[12:15], s51 offen
    v_mfma_f32_16x16x32_bf16 a[44:47], v[72:75], v[60:63], a[44:47]
    v_mfma_f32_16x16x32_bf16 a[64:67], v[72:75], v[64:67], a[64:67]
    buffer_load_dwordx4 v[28:31], v11, s[12:15], s51 offen
    s_add_u32 s51, s51, 8192
    s_waitcnt vmcnt(15)
    v_mfma_f32_16x16x32_bf16 a[8:11], v[76:79], v[52:55], a[8:11]
    v_mfma_f32_16x16x32_bf16 a[28:31], v[76:79], v[56:59], a[28:31]
    buffer_load_dwordx4 v[32:35], v8, s[16:19], s52 offen offset:0
    v_mfma_f32_16x16x32_bf16 a[48:51], v[76:79], v[60:63], a[48:51]
    v_mfma_f32_16x16x32_bf16 a[68:71], v[76:79], v[64:67], a[68:71]
    buffer_load_dwordx4 v[36:39], v8, s[16:19], s52 offen offset:1024
    s_waitcnt vmcnt(16)
    v_mfma_f32_16x16x32_bf16 a[12:15], v[80:83], v[52:55], a[12:15]
    v_mfma_f32_16x16x32_bf16 a[32:35], v[80:83], v[56:59], a[32:35]
    buffer_load_dwordx4 v[40:43], v8, s[16:19], s52 offen offset:2048
    v_mfma_f32_16x16x32_bf16 a[52:55], v[80:83], v[60:63], a[52:55]
    v_mfma_f32_16x16x32_bf16 a[72:75], v[80:83], v[64:67], a[72:75]
    buffer_load_dwordx4 v[44:47], v8, s[16:19], s52 offen offset:3072
    s_waitcnt vmcnt(17)
    v_mfma_f32_16x16x32_bf16 a[16:19], v[84:87], v[52:55], a[16:19]
    v_mfma_f32_16x16x32_bf16 a[36:39], v[84:87], v[56:59], a[36:39]
    buffer_load_dwordx4 v[48:51], v12, s[16:19], s52 offen offset:0
    s_add_u32 s52, s52, 294912
    v_mfma_f32_16x16x32_bf16 a[56:59], v[84:87], v[60:63], a[56:59]
    v_mfma_f32_16x16x32_bf16 a[76:79], v[84:87], v[64:67], a[76:79]
    s_waitcnt vmcnt(13)
    v_mfma_f32_16x16x32_bf16 a[0:3], v[104:107], v[88:91], a[0:3]
    v_mfma_f32_16x16x32_bf16 a[20:23], v[104:107], v[92:95], a[20:23]
    buffer_load_dwordx4 v[52:55], v8, s[12:15], s51 offen
    v_mfma_f32_16x16x32_bf16 a[40:43], v[104:107], v[96:99], a[40:43]
    v_mfma_f32_16x16x32_bf16 a[60:63], v[104:107], v[100:103], a[60:63]
    buffer_load_dwordx4 v[56:59], v9, s[12:15], s51 offen
    s_waitcnt vmcnt(14)
    v_mfma_f32_16x16x32_bf16 a[4:7], v[108:111], v[88:91], a[4:7]
    v_mfma_f32_16x16x32_bf16 a[24:27], v[108:111], v[92:95], a[24:27]
    buffer_load_dwordx4 v[60:63], v10, s[12:15], s51 offen
    v_mfma_f32_16x16x32_bf16 a[44:47], v[108:111], v[96:99], a[44:47]
    v_mfma_f32_16x16x32_bf16 a[64:67], v[108:111], v[100:103], a[64:67]
    buffer_load_dwordx4 v[64:67], v11, s[12:15], s51 offen
    s_add_u32 s51, s51, 8192
    s_waitcnt vmcnt(15)
    v_mfma_f32_16x16x32_bf16 a[8:11], v[112:115], v[88:91], a[8:11]
    v_mfma_f32_16x16x32_bf16 a[28:31], v[112:115], v[92:95], a[28:31]
    buffer_load_dwordx4 v[68:71], v8, s[16:19], s52 offen offset:0
    v_mfma_f32_16x16x32_bf16 a[48:51], v[112:115], v[96:99], a[48:51]
    v_mfma_f32_16x16x32_bf16 a[68:71], v[112:115], v[100:103], a[68:71]
    buffer_load_dwordx4 v[72:75], v8, s[16:19], s52 offen offset:1024
    s_waitcnt vmcnt(16)
    v_mfma_f32_16x16x32_bf16 a[12:15], v[116:119], v[88:91], a[12:15]
    v_mfma_f32_16x16x32_bf16 a[32:35], v[116:119], v[92:95], a[32:35]
    buffer_load_dwordx4 v[76:79], v8, s[16:19], s52 offen offset:2048
    v_mfma_f32_16x16x32_bf16 a[52:55], v[116:119], v[96:99], a[52:55]
    v_mfma_f32_16x16x32_bf16 a[72:75], v[116:119], v[100:103], a[72:75]
    buffer_load_dwordx4 v[80:83], v8, s[16:19], s52 offen offset:3072
    s_waitcnt vmcnt(17)
    v_mfma_f32_16x16x32_bf16 a[16:19], v[120:123], v[88:91], a[16:19]
    v_mfma_f32_16x16x32_bf16 a[36:39], v[120:123], v[92:95], a[36:39]
    buffer_load_dwordx4 v[84:87], v12, s[16:19], s52 offen offset:0
    s_add_u32 s52, s52, 294912
    v_mfma_f32_16x16x32_bf16 a[56:59], v[120:123], v[96:99], a[56:59]
    v_mfma_f32_16x16x32_bf16 a[76:79], v[120:123], v[100:103], a[76:79]
    s_waitcnt vmcnt(13)
    v_mfma_f32_16x16x32_bf16 a[0:3], v[32:35], v[16:19], a[0:3]
    v_mfma_f32_16x16x32_bf16 a[20:23], v[32:35], v[20:23], a[20:23]
    buffer_load_dwordx4 v[88:91], v8, s[12:15], s51 offen
    v_mfma_f32_16x16x32_bf16 a[40:43], v[32:35], v[24:27], a[40:43]
    v_mfma_f32_16x16x32_bf16 a[60:63], v[32:35], v[28:31], a[60:63]
    buffer_load_dwordx4 v[92:95], v9, s[12:15], s51 offen
    s_waitcnt vmcnt(14)
    v_mfma_f32_16x16x32_bf16 a[4:7], v[36:39], v[16:19], a[4:7]
    v_mfma_f32_16x16x32_bf16 a[24:27], v[36:39], v[20:23], a[24:27]
    buffer_load_dwordx4 v[96:99], v10, s[12:15], s51 offen
    v_mfma_f32_16x16x32_bf16 a[44:47], v[36:39], v[24:27], a[44:47]
    v_mfma_f32_16x16x32_bf16 a[64:67], v[36:39], v[28:31], a[64:67]
    buffer_load_dwordx4 v[100:103], v11, s[12:15], s51 offen
    s_add_u32 s51, s51, 8192
    s_waitcnt vmcnt(15)
    v_mfma_f32_16x16x32_bf16 a[8:11], v[40:43], v[16:19], a[8:11]
    v_mfma_f32_16x16x32_bf16 a[28:31], v[40:43], v[20:23], a[28:31]
    buffer_load_dwordx4 v[104:107], v8, s[16:19], s52 offen offset:0
    v_mfma_f32_16x16x32_bf16 a[48:51], v[40:43], v[24:27], a[48:51]
    v_mfma_f32_16x16x32_bf16 a[68:71], v[40:43], v[28:31], a[68:71]
    buffer_load_dwordx4 v[108:111], v8, s[16:19], s52 offen offset:1024
    s_waitcnt vmcnt(16)
    v_mfma_f32_16x16x32_bf16 a[12:15], v[44:47], v[16:19], a[12:15]
    v_mfma_f32_16x16x32_bf16 a[32:35], v[44:47], v[20:23], a[32:35]
    buffer_load_dwordx4 v[112:115], v8, s[16:19], s52 offen offset:2048
    v_mfma_f32_16x16x32_bf16 a[52:55], v[44:47], v[24:27], a[52:55]
    v_mfma_f32_16x16x32_bf16 a[72:75], v[44:47], v[28:31], a[72:75]
    buffer_load_dwordx4 v[116:119], v8, s[16:19], s52 offen offset:3072
    s_waitcnt vmcnt(17)
    v_mfma_f32_16x16x32_bf16 a[16:19], v[48:51], v[16:19], a[16:19]
    v_mfma_f32_16x16x32_bf16 a[36:39], v[48:51], v[20:23], a[36:39]
    buffer_load_dwordx4 v[120:123], v12, s[16:19], s52 offen offset:0
    s_add_u32 s52, s52, 294912
    v_mfma_f32_16x16x32_bf16 a[56:59], v[48:51], v[24:27], a[56:59]
    v_mfma_f32_16x16x32_bf16 a[76:79], v[48:51], v[28:31], a[76:79]
    s_waitcnt vmcnt(13)
    v_mfma_f32_16x16x32_bf16 a[0:3], v[68:71], v[52:55], a[0:3]
    v_mfma_f32_16x16x32_bf16 a[20:23], v[68:71], v[56:59], a[20:23]
    v_mfma_f32_16x16x32_bf16 a[40:43], v[68:71], v[60:63], a[40:43]
    v_mfma_f32_16x16x32_bf16 a[60:63], v[68:71], v[64:67], a[60:63]
    s_waitcnt vmcnt(12)
    v_mfma_f32_16x16x32_bf16 a[4:7], v[72:75], v[52:55], a[4:7]
    v_mfma_f32_16x16x32_bf16 a[24:27], v[72:75], v[56:59], a[24:27]
    v_mfma_f32_16x16x32_bf16 a[44:47], v[72:75], v[60:63], a[44:47]
    v_mfma_f32_16x16x32_bf16 a[64:67], v[72:75], v[64:67], a[64:67]
    s_waitcnt vmcnt(11)
    v_mfma_f32_16x16x32_bf16 a[8:11], v[76:79], v[52:55], a[8:11]
    v_mfma_f32_16x16x32_bf16 a[28:31], v[76:79], v[56:59], a[28:31]
    v_mfma_f32_16x16x32_bf16 a[48:51], v[76:79], v[60:63], a[48:51]
    v_mfma_f32_16x16x32_bf16 a[68:71], v[76:79], v[64:67], a[68:71]
    s_waitcnt vmcnt(10)
    v_mfma_f32_16x16x32_bf16 a[12:15], v[80:83], v[52:55], a[12:15]
    v_mfma_f32_16x16x32_bf16 a[32:35], v[80:83], v[56:59], a[32:35]
    v_mfma_f32_16x16x32_bf16 a[52:55], v[80:83], v[60:63], a[52:55]
    v_mfma_f32_16x16x32_bf16 a[72:75], v[80:83], v[64:67], a[72:75]
    s_waitcnt vmcnt(9)
    v_mfma_f32_16x16x32_bf16 a[16:19], v[84:87], v[52:55], a[16:19]
    v_mfma_f32_16x16x32_bf16 a[36:39], v[84:87], v[56:59], a[36:39]
    v_mfma_f32_16x16x32_bf16 a[56:59], v[84:87], v[60:63], a[56:59]
    v_mfma_f32_16x16x32_bf16 a[76:79], v[84:87], v[64:67], a[76:79]
    s_waitcnt vmcnt(4)
    v_mfma_f32_16x16x32_bf16 a[0:3], v[104:107], v[88:91], a[0:3]
    v_mfma_f32_16x16x32_bf16 a[20:23], v[104:107], v[92:95], a[20:23]
    v_mfma_f32_16x16x32_bf16 a[40:43], v[104:107], v[96:99], a[40:43]
    v_mfma_f32_16x16x32_bf16 a[60:63], v[104:107], v[100:103], a[60:63]
    s_waitcnt vmcnt(3)
    v_mfma_f32_16x16x32_bf16 a[4:7], v[108:111], v[88:91], a[4:7]
    v_mfma_f32_16x16x32_bf16 a[24:27], v[108:111], v[92:95], a[24:27]
    v_mfma_f32_16x16x32_bf16 a[44:47], v[108:111], v[96:99], a[44:47]
    v_mfma_f32_16x16x32_bf16 a[64:67], v[108:111], v[100:103], a[64:67]
    s_waitcnt vmcnt(2)
    v_mfma_f32_16x16x32_bf16 a[8:11], v[112:115], v[88:91], a[8:11]
    v_mfma_f32_16x16x32_bf16 a[28:31], v[112:115], v[92:95], a[28:31]
    v_mfma_f32_16x16x32_bf16 a[48:51], v[112:115], v[96:99], a[48:51]
    v_mfma_f32_16x16x32_bf16 a[68:71], v[112:115], v[100:103], a[68:71]
    s_waitcnt vmcnt(1)
    v_mfma_f32_16x16x32_bf16 a[12:15], v[116:119], v[88:91], a[12:15]
    v_mfma_f32_16x16x32_bf16 a[32:35], v[116:119], v[92:95], a[32:35]
    v_mfma_f32_16x16x32_bf16 a[52:55], v[116:119], v[96:99], a[52:55]
    v_mfma_f32_16x16x32_bf16 a[72:75], v[116:119], v[100:103], a[72:75]
    s_waitcnt vmcnt(0)
    v_mfma_f32_16x16x32_bf16 a[16:19], v[120:123], v[88:91], a[16:19]
    v_mfma_f32_16x16x32_bf16 a[36:39], v[120:123], v[92:95], a[36:39]
    v_mfma_f32_16x16x32_bf16 a[56:59], v[120:123], v[96:99], a[56:59]
    v_mfma_f32_16x16x32_bf16 a[76:79], v[120:123], v[100:103], a[76:79]
    s_nop 7
    s_mul_i32 s53, s45, 20480
    v_add_u32 v1, s53, v8
    v_accvgpr_read_b32 v16, a0
    v_accvgpr_read_b32 v17, a1
    v_accvgpr_read_b32 v18, a2
    v_accvgpr_read_b32 v19, a3
    ds_write_b128 v1, v[16:19] offset:0
    v_accvgpr_read_b32 v20, a4
    v_accvgpr_read_b32 v21, a5
    v_accvgpr_read_b32 v22, a6
    v_accvgpr_read_b32 v23, a7
    ds_write_b128 v1, v[20:23] offset:1024
    v_accvgpr_read_b32 v24, a8
    v_accvgpr_read_b32 v25, a9
    v_accvgpr_read_b32 v26, a10
    v_accvgpr_read_b32 v27, a11
    ds_write_b128 v1, v[24:27] offset:2048
    v_accvgpr_read_b32 v28, a12
    v_accvgpr_read_b32 v29, a13
    v_accvgpr_read_b32 v30, a14
    v_accvgpr_read_b32 v31, a15
    ds_write_b128 v1, v[28:31] offset:3072
    v_accvgpr_read_b32 v32, a16
    v_accvgpr_read_b32 v33, a17
    v_accvgpr_read_b32 v34, a18
    v_accvgpr_read_b32 v35, a19
    ds_write_b128 v1, v[32:35] offset:4096
    v_accvgpr_read_b32 v36, a20
    v_accvgpr_read_b32 v37, a21
    v_accvgpr_read_b32 v38, a22
    v_accvgpr_read_b32 v39, a23
    ds_write_b128 v1, v[36:39] offset:5120
    v_accvgpr_read_b32 v40, a24
    v_accvgpr_read_b32 v41, a25
    v_accvgpr_read_b32 v42, a26
    v_accvgpr_read_b32 v43, a27
    ds_write_b128 v1, v[40:43] offset:6144
    v_accvgpr_read_b32 v44, a28
    v_accvgpr_read_b32 v45, a29
    v_accvgpr_read_b32 v46, a30
    v_accvgpr_read_b32 v47, a31
    ds_write_b128 v1, v[44:47] offset:7168
    v_accvgpr_read_b32 v48, a32
    v_accvgpr_read_b32 v49, a33
    v_accvgpr_read_b32 v50, a34
    v_accvgpr_read_b32 v51, a35
    ds_write_b128 v1, v[48:51] offset:8192
    v_accvgpr_read_b32 v52, a36
    v_accvgpr_read_b32 v53, a37
    v_accvgpr_read_b32 v54, a38
    v_accvgpr_read_b32 v55, a39
    ds_write_b128 v1, v[52:55] offset:9216
    v_accvgpr_read_b32 v56, a40
    v_accvgpr_read_b32 v57, a41
    v_accvgpr_read_b32 v58, a42
    v_accvgpr_read_b32 v59, a43
    ds_write_b128 v1, v[56:59] offset:10240
    v_accvgpr_read_b32 v60, a44
    v_accvgpr_read_b32 v61, a45
    v_accvgpr_read_b32 v62, a46
    v_accvgpr_read_b32 v63, a47
    ds_write_b128 v1, v[60:63] offset:11264
    v_accvgpr_read_b32 v64, a48
    v_accvgpr_read_b32 v65, a49
    v_accvgpr_read_b32 v66, a50
    v_accvgpr_read_b32 v67, a51
    ds_write_b128 v1, v[64:67] offset:12288
    v_accvgpr_read_b32 v68, a52
    v_accvgpr_read_b32 v69, a53
    v_accvgpr_read_b32 v70, a54
    v_accvgpr_read_b32 v71, a55
    ds_write_b128 v1, v[68:71] offset:13312
    v_accvgpr_read_b32 v72, a56
    v_accvgpr_read_b32 v73, a57
    v_accvgpr_read_b32 v74, a58
    v_accvgpr_read_b32 v75, a59
    ds_write_b128 v1, v[72:75] offset:14336
    v_accvgpr_read_b32 v76, a60
    v_accvgpr_read_b32 v77, a61
    v_accvgpr_read_b32 v78, a62
    v_accvgpr_read_b32 v79, a63
    ds_write_b128 v1, v[76:79] offset:15360
    v_accvgpr_read_b32 v80, a64
    v_accvgpr_read_b32 v81, a65
    v_accvgpr_read_b32 v82, a66
    v_accvgpr_read_b32 v83, a67
    ds_write_b128 v1, v[80:83] offset:16384
    v_accvgpr_read_b32 v84, a68
    v_accvgpr_read_b32 v85, a69
    v_accvgpr_read_b32 v86, a70
    v_accvgpr_read_b32 v87, a71
    ds_write_b128 v1, v[84:87] offset:17408
    v_accvgpr_read_b32 v88, a72
    v_accvgpr_read_b32 v89, a73
    v_accvgpr_read_b32 v90, a74
    v_accvgpr_read_b32 v91, a75
    ds_write_b128 v1, v[88:91] offset:18432
    v_accvgpr_read_b32 v92, a76
    v_accvgpr_read_b32 v93, a77
    v_accvgpr_read_b32 v94, a78
    v_accvgpr_read_b32 v95, a79
    ds_write_b128 v1, v[92:95] offset:19456
    v_and_b32 v3, 15, v2
    v_lshrrev_b32 v4, 4, v2
    s_lshl_b32 s53, s45, 10
    v_add_u32 v1, s53, v8
    v_add_u32 v5, 61440, v1
    v_add_u32 v13, 122880, v1
    v_lshlrev_b32 v9, 3, v2
    s_waitcnt lgkmcnt(0)
    s_barrier
    s_add_u32 s54, s45, 0
    s_mul_i32 s55, s54, 52
    s_lshr_b32 s55, s55, 8
    s_mul_i32 s56, s55, 5
    s_sub_u32 s56, s54, s56
    s_cmp_ge_u32 s56, s47
    s_cbranch_scc1 g5_kernel_nx2
    s_lshl_b32 s57, s42, 2
    s_add_u32 s57, s57, s55
    s_add_u32 s58, s44, s56
    s_lshl_b32 s59, s57, 4
    v_add_u32 v6, s59, v3
    v_mul_u32_u24 v6, 1152, v6
    s_lshl_b32 s60, s58, 4
    v_lshl_add_u32 v7, v4, 2, s60
    v_lshl_add_u32 v6, v7, 1, v6
    v_lshlrev_b32 v7, 2, v7
    s_mul_i32 s59, s57, 18432
    s_lshl_b32 s60, s58, 9
    s_add_u32 s59, s59, s60
    buffer_load_dwordx2 v[48:49], v9, s[20:23], s59 offen
    s_mov_b32 s59, 11520
    buffer_load_dwordx4 v[52:55], v7, s[24:27], s59 offen
    ds_read_b128 v[16:19], v1 offset:0
    ds_read_b128 v[20:23], v1 offset:20480
    ds_read_b128 v[24:27], v1 offset:40960
    ds_read_b128 v[28:31], v5 offset:0
    ds_read_b128 v[32:35], v5 offset:20480
    ds_read_b128 v[36:39], v5 offset:40960
    ds_read_b128 v[40:43], v13 offset:0
    ds_read_b128 v[44:47], v13 offset:20480
    s_waitcnt lgkmcnt(0)
    v_add_f32 v16, v16, v32
    v_add_f32 v17, v17, v33
    v_add_f32 v18, v18, v34
    v_add_f32 v19, v19, v35
    v_add_f32 v20, v20, v36
    v_add_f32 v21, v21, v37
    v_add_f32 v22, v22, v38
    v_add_f32 v23, v23, v39
    v_add_f32 v24, v24, v40
    v_add_f32 v25, v25, v41
    v_add_f32 v26, v26, v42
    v_add_f32 v27, v27, v43
    v_add_f32 v28, v28, v44
    v_add_f32 v29, v29, v45
    v_add_f32 v30, v30, v46
    v_add_f32 v31, v31, v47
    v_add_f32 v16, v16, v24
    v_add_f32 v17, v17, v25
    v_add_f32 v18, v18, v26
    v_add_f32 v19, v19, v27
    v_add_f32 v20, v20, v28
    v_add_f32 v21, v21, v29
    v_add_f32 v22, v22, v30
    v_add_f32 v23, v23, v31
    v_add_f32 v16, v16, v20
    v_add_f32 v17, v17, v21
    v_add_f32 v18, v18, v22
    v_add_f32 v19, v19, v23
    s_waitcnt vmcnt(0)
    v_lshlrev_b32 v20, 16, v48
    v_and_b32 v21, 0xffff0000, v48
    v_lshlrev_b32 v22, 16, v49
    v_and_b32 v23, 0xffff0000, v49
    v_fma_f32 v16, v52, v16, v20
    v_fma_f32 v17, v53, v17, v21
    v_fma_f32 v18, v54, v18, v22
    v_fma_f32 v19, v55, v19, v23
    v_cvt_pk_bf16_f32 v16, v16, v17
    v_cvt_pk_bf16_f32 v17, v18, v19
    buffer_store_dwordx2 v[16:17], v6, s[28:31], 0 offen
g5_kernel_nx2:
    s_add_u32 s54, s45, 8
    s_mul_i32 s55, s54, 52
    s_lshr_b32 s55, s55, 8
    s_mul_i32 s56, s55, 5
    s_sub_u32 s56, s54, s56
    s_cmp_ge_u32 s56, s47
    s_cbranch_scc1 g5_kernel_nx3
    s_lshl_b32 s57, s42, 2
    s_add_u32 s57, s57, s55
    s_add_u32 s58, s44, s56
    s_lshl_b32 s59, s57, 4
    v_add_u32 v6, s59, v3
    v_mul_u32_u24 v6, 1152, v6
    s_lshl_b32 s60, s58, 4
    v_lshl_add_u32 v7, v4, 2, s60
    v_lshl_add_u32 v6, v7, 1, v6
    v_lshlrev_b32 v7, 2, v7
    s_mul_i32 s59, s57, 18432
    s_lshl_b32 s60, s58, 9
    s_add_u32 s59, s59, s60
    buffer_load_dwordx2 v[88:89], v9, s[20:23], s59 offen
    s_mov_b32 s59, 11520
    buffer_load_dwordx4 v[92:95], v7, s[24:27], s59 offen
    ds_read_b128 v[56:59], v1 offset:8192
    ds_read_b128 v[60:63], v1 offset:28672
    ds_read_b128 v[64:67], v1 offset:49152
    ds_read_b128 v[68:71], v5 offset:8192
    ds_read_b128 v[72:75], v5 offset:28672
    ds_read_b128 v[76:79], v5 offset:49152
    ds_read_b128 v[80:83], v13 offset:8192
    ds_read_b128 v[84:87], v13 offset:28672
    s_waitcnt lgkmcnt(0)
    v_add_f32 v56, v56, v72
    v_add_f32 v57, v57, v73
    v_add_f32 v58, v58, v74
    v_add_f32 v59, v59, v75
    v_add_f32 v60, v60, v76
    v_add_f32 v61, v61, v77
    v_add_f32 v62, v62, v78
    v_add_f32 v63, v63, v79
    v_add_f32 v64, v64, v80
    v_add_f32 v65, v65, v81
    v_add_f32 v66, v66, v82
    v_add_f32 v67, v67, v83
    v_add_f32 v68, v68, v84
    v_add_f32 v69, v69, v85
    v_add_f32 v70, v70, v86
    v_add_f32 v71, v71, v87
    v_add_f32 v56, v56, v64
    v_add_f32 v57, v57, v65
    v_add_f32 v58, v58, v66
    v_add_f32 v59, v59, v67
    v_add_f32 v60, v60, v68
    v_add_f32 v61, v61, v69
    v_add_f32 v62, v62, v70
    v_add_f32 v63, v63, v71
    v_add_f32 v56, v56, v60
    v_add_f32 v57, v57, v61
    v_add_f32 v58, v58, v62
    v_add_f32 v59, v59, v63
    s_waitcnt vmcnt(0)
    v_lshlrev_b32 v60, 16, v88
    v_and_b32 v61, 0xffff0000, v88
    v_lshlrev_b32 v62, 16, v89
    v_and_b32 v63, 0xffff0000, v89
    v_fma_f32 v56, v92, v56, v60
    v_fma_f32 v57, v93, v57, v61
    v_fma_f32 v58, v94, v58, v62
    v_fma_f32 v59, v95, v59, v63
    v_cvt_pk_bf16_f32 v56, v56, v57
    v_cvt_pk_bf16_f32 v57, v58, v59
    buffer_store_dwordx2 v[56:57], v6, s[28:31], 0 offen
g5_kernel_nx3:
    s_cmp_ge_u32 s45, 4
    s_cbranch_scc1 g5_kernel_done1
    s_add_u32 s54, s45, 16
    s_mul_i32 s55, s54, 52
    s_lshr_b32 s55, s55, 8
    s_mul_i32 s56, s55, 5
    s_sub_u32 s56, s54, s56
    s_cmp_ge_u32 s56, s47
    s_cbranch_scc1 g5_kernel_nx4
    s_lshl_b32 s57, s42, 2
    s_add_u32 s57, s57, s55
    s_add_u32 s58, s44, s56
    s_lshl_b32 s59, s57, 4
    v_add_u32 v6, s59, v3
    v_mul_u32_u24 v6, 1152, v6
    s_lshl_b32 s60, s58, 4
    v_lshl_add_u32 v7, v4, 2, s60
    v_lshl_add_u32 v6, v7, 1, v6
    v_lshlrev_b32 v7, 2, v7
    s_mul_i32 s59, s57, 18432
    s_lshl_b32 s60, s58, 9
    s_add_u32 s59, s59, s60
    buffer_load_dwordx2 v[128:129], v9, s[20:23], s59 offen
    s_mov_b32 s59, 11520
    buffer_load_dwordx4 v[132:135], v7, s[24:27], s59 offen
    ds_read_b128 v[96:99], v1 offset:16384
    ds_read_b128 v[100:103], v1 offset:36864
    ds_read_b128 v[104:107], v1 offset:57344
    ds_read_b128 v[108:111], v5 offset:16384
    ds_read_b128 v[112:115], v5 offset:36864
    ds_read_b128 v[116:119], v5 offset:57344
    ds_read_b128 v[120:123], v13 offset:16384
    ds_read_b128 v[124:127], v13 offset:36864
    s_waitcnt lgkmcnt(0)
    v_add_f32 v96, v96, v112
    v_add_f32 v97, v97, v113
    v_add_f32 v98, v98, v114
    v_add_f32 v99, v99, v115
    v_add_f32 v100, v100, v116
    v_add_f32 v101, v101, v117
    v_add_f32 v102, v102, v118
    v_add_f32 v103, v103, v119
    v_add_f32 v104, v104, v120
    v_add_f32 v105, v105, v121
    v_add_f32 v106, v106, v122
    v_add_f32 v107, v107, v123
    v_add_f32 v108, v108, v124
    v_add_f32 v109, v109, v125
    v_add_f32 v110, v110, v126
    v_add_f32 v111, v111, v127
    v_add_f32 v96, v96, v104
    v_add_f32 v97, v97, v105
    v_add_f32 v98, v98, v106
    v_add_f32 v99, v99, v107
    v_add_f32 v100, v100, v108
    v_add_f32 v101, v101, v109
    v_add_f32 v102, v102, v110
    v_add_f32 v103, v103, v111
    v_add_f32 v96, v96, v100
    v_add_f32 v97, v97, v101
    v_add_f32 v98, v98, v102
    v_add_f32 v99, v99, v103
    s_waitcnt vmcnt(0)
    v_lshlrev_b32 v100, 16, v128
    v_and_b32 v101, 0xffff0000, v128
    v_lshlrev_b32 v102, 16, v129
    v_and_b32 v103, 0xffff0000, v129
    v_fma_f32 v96, v132, v96, v100
    v_fma_f32 v97, v133, v97, v101
    v_fma_f32 v98, v134, v98, v102
    v_fma_f32 v99, v135, v99, v103
    v_cvt_pk_bf16_f32 v96, v96, v97
    v_cvt_pk_bf16_f32 v97, v98, v99
    buffer_store_dwordx2 v[96:97], v6, s[28:31], 0 offen
g5_kernel_nx4:
g5_kernel_done1:
    s_endpgm
code_end_label:
    s_endpgm
.section .rodata,"a"
.p2align 6
.amdhsa_kernel mod_kernel
  .amdhsa_next_free_vgpr 96
  .amdhsa_next_free_sgpr 37
  .amdhsa_accum_offset 96
  .amdhsa_group_segment_fixed_size 0
  .amdhsa_kernarg_size 120
  .amdhsa_user_sgpr_count 2
  .amdhsa_user_sgpr_kernarg_segment_ptr 1
  .amdhsa_system_sgpr_workgroup_id_x 1
  .amdhsa_float_denorm_mode_32 3
.end_amdhsa_kernel
.p2align 6
.amdhsa_kernel attn_kernel
  .amdhsa_next_free_vgpr 256
  .amdhsa_next_free_sgpr 92
  .amdhsa_accum_offset 256
  .amdhsa_group_segment_fixed_size 0
  .amdhsa_kernarg_size 120
  .amdhsa_user_sgpr_count 2
  .amdhsa_user_sgpr_kernarg_segment_ptr 1
  .amdhsa_system_sgpr_workgroup_id_x 1
  .amdhsa_float_denorm_mode_32 3
.end_amdhsa_kernel
.p2align 6
.amdhsa_kernel g2_kernel
  .amdhsa_next_free_vgpr 144
  .amdhsa_next_free_sgpr 65
  .amdhsa_accum_offset 72
  .amdhsa_group_segment_fixed_size 0
  .amdhsa_kernarg_size 120
  .amdhsa_user_sgpr_count 2
  .amdhsa_user_sgpr_kernarg_segment_ptr 1
  .amdhsa_system_sgpr_workgroup_id_x 1
  .amdhsa_float_denorm_mode_32 3
.end_amdhsa_kernel
.p2align 6
.amdhsa_kernel ln2_kernel
  .amdhsa_next_free_vgpr 256
  .amdhsa_next_free_sgpr 40
  .amdhsa_accum_offset 256
  .amdhsa_group_segment_fixed_size 0
  .amdhsa_kernarg_size 120
  .amdhsa_user_sgpr_count 2
  .amdhsa_user_sgpr_kernarg_segment_ptr 1
  .amdhsa_system_sgpr_workgroup_id_x 1
  .amdhsa_float_denorm_mode_32 3
.end_amdhsa_kernel
.p2align 6
.amdhsa_kernel g3_kernel
  .amdhsa_next_free_vgpr 176
  .amdhsa_next_free_sgpr 65
  .amdhsa_accum_offset 104
  .amdhsa_group_segment_fixed_size 0
  .amdhsa_kernarg_size 120
  .amdhsa_user_sgpr_count 2
  .amdhsa_user_sgpr_kernarg_segment_ptr 1
  .amdhsa_system_sgpr_workgroup_id_x 1
  .amdhsa_float_denorm_mode_32 3
.end_amdhsa_kernel
.p2align 6
.amdhsa_kernel lnz_kernel
  .amdhsa_next_free_vgpr 56
  .amdhsa_next_free_sgpr 30
  .amdhsa_accum_offset 56
  .amdhsa_group_segment_fixed_size 0
  .amdhsa_kernarg_size 120
  .amdhsa_user_sgpr_count 2
  .amdhsa_user_sgpr_kernarg_segment_ptr 1
  .amdhsa_system_sgpr_workgroup_id_x 1
  .amdhsa_float_denorm_mode_32 3
.end_amdhsa_kernel
.p2align 6
.amdhsa_kernel g4_kernel
  .amdhsa_next_free_vgpr 168
  .amdhsa_next_free_sgpr 68
  .amdhsa_accum_offset 96
  .amdhsa_group_segment_fixed_size 0
  .amdhsa_kernarg_size 120
  .amdhsa_user_sgpr_count 2
  .amdhsa_user_sgpr_kernarg_segment_ptr 1
  .amdhsa_system_sgpr_workgroup_id_x 1
  .amdhsa_float_denorm_mode_32 3
.end_amdhsa_kernel
.p2align 6
.amdhsa_kernel g5_kernel
  .amdhsa_next_free_vgpr 216
  .amdhsa_next_free_sgpr 61
  .amdhsa_accum_offset 136
  .amdhsa_group_segment_fixed_size 0
  .amdhsa_kernarg_size 120
  .amdhsa_user_sgpr_count 2
  .amdhsa_user_sgpr_kernarg_segment_ptr 1
  .amdhsa_system_sgpr_workgroup_id_x 1
  .amdhsa_float_denorm_mode_32 3
.end_amdhsa_kernel
```
